```python
import torch

def _softmax(x, axis=-1):
    return torch.softmax(x, dim=axis)

def _gelu(x):
    return torch.nn.functional.gelu(x, approximate='tanh')

def _silu(x):
    return torch.nn.functional.silu(x)

def _sigmoid(x):
    return torch.sigmoid(x)

def _layernorm(x, axis=-1, eps=1e-05):
    m = x.mean(dim=axis, keepdim=True)
    v = x.var(dim=axis, keepdim=True, unbiased=False)
    return (x - m) / torch.sqrt(v + eps)

def _scatter_add(tgt, idx, src, axis=0):
    return tgt.clone().index_add_(axis, idx, src)

def _segment_sum(src, seg, n):
    out = torch.zeros((n,) + src.shape[1:], dtype=src.dtype)
    return out.index_add_(0, seg, src)

def _pad(x, pw):
    flat = tuple((v for pair in reversed(pw) for v in pair))
    return torch.nn.functional.pad(x, flat)
kernel_name = 'standalone__autoregressive_conv_wavenet__speech'

def setup_inputs():

    _w = lambda a: (lambda t: t.to(torch.bfloat16) if t.is_floating_point() else t)(torch.as_tensor(a))
    B, T, D, K = (2, 4000, 512, 15)
    return {'x': _w((lambda *s: torch.randn(*s, dtype=torch.bfloat16) * 0.1)(B, T, D)), 'w': _w((lambda *s: torch.randn(*s, dtype=torch.bfloat16) * 0.1)(K, D, 2 * D)), 'w_o': _w((lambda *s: torch.randn(*s, dtype=torch.bfloat16) * 0.05)(D, D))}

def reference(x, w, w_o):
    B, T, D = x.shape
    K = w.shape[0]
    dil = 2
    pad = (K - 1) * dil
    xp = _pad(x, ((0, 0), (pad, 0), (0, 0)))
    h = torch.einsum('btc,cd->btd', xp[:, pad:pad + T, :], w[0])
    for i in range(1, K):
        off = pad - i * dil
        h = h + torch.einsum('btc,cd->btd', xp[:, off:off + T, :], w[i])
    f = h[..., :D].clone()
    g = h[..., D:].clone()
    z = torch.tanh(f) * _sigmoid(g)
    return z @ w_o
```

```asm
; @launch grid=(256,1,1) block=(256,1,1) lds=163840
.amdgcn_target "amdgcn-amd-amdhsa--gfx950"
.text
.p2align 12
.globl standalone__autoregressive_conv_wavenet__speech_kernel
.p2align 8
.type standalone__autoregressive_conv_wavenet__speech_kernel,@function
standalone__autoregressive_conv_wavenet__speech_kernel:
    s_cmp_ge_u32 s2, 256
    s_cbranch_scc1 L_end
    s_load_dwordx4 s[4:7], s[0:1], 0
    s_load_dwordx4 s[20:23], s[0:1], 16
    s_load_dwordx4 s[24:27], s[0:1], 32
    v_lshrrev_b32 v12, 6, v0
    v_lshrrev_b32 v1, 3, v0
    v_and_b32 v0, 63, v0
    v_readfirstlane_b32 s36, v12
    s_lshr_b32 s30, s2, 3
    s_and_b32 s29, s2, 7
    s_mov_b32 s81, 0
    s_cmp_ge_u32 s2, 160
    s_cbranch_scc1 L_pre_other
    s_add_u32 s31, s29, s30
    s_and_b32 s31, s31, 7
    s_lshl_b32 s37, s30, 2
    s_add_u32 s37, s37, s36
    s_cmp_ge_u32 s37, 40
    s_cselect_b32 s38, 40, 0
    s_cselect_b32 s39, 4096000, 0
    s_sub_u32 s37, s37, s38
    s_mul_i32 s37, s37, 102400
    s_lshl_b32 s38, s31, 7
    s_add_u32 s37, s37, s38
    s_sub_u32 s37, s37, 28672
    v_lshrrev_b32 v20, 3, v0
    v_lshlrev_b32 v16, 11, v20
    v_and_b32 v20, 6, v20
    v_and_b32 v21, 7, v0
    v_xor_b32 v20, v20, v21
    v_lshl_add_u32 v16, v20, 4, v16
    v_add_u32 v16, s37, v16
    s_lshl_b32 s49, s36, 14
    s_add_u32 s49, s49, 98304
    v_and_b32 v20, 15, v0
    v_or_b32 v20, 1, v20
    v_cvt_f32_u32 v20, v20
    v_add_f32 v21, 0x41800000, v20
    v_add_f32 v22, 0x42000000, v20
    v_add_f32 v23, 0x42400000, v20
    v_and_b32 v24, 1, v0
    v_cvt_f32_u32 v24, v24
    v_mul_f32 v24, 0x3e800000, v24
    v_lshrrev_b32 v25, 4, v0
    v_cvt_f32_u32 v25, v25
    v_mul_f32 v25, 0x3d000000, v25
    v_add_f32 v72, 0x00000000, v25
    v_add_f32 v73, 0x3c000000, v25
    v_add_f32 v74, 0x3c800000, v25
    v_add_f32 v75, 0x3cc00000, v25
    v_add_f32 v76, 0x3e000000, v25
    v_add_f32 v77, 0x3e080000, v25
    v_add_f32 v78, 0x3e100000, v25
    v_add_f32 v79, 0x3e180000, v25
    v_fma_f32 v104, v20, v72, v24
    v_fma_f32 v105, v20, v73, v24
    v_fma_f32 v106, v20, v74, v24
    v_fma_f32 v107, v20, v75, v24
    v_fma_f32 v108, v20, v76, v24
    v_fma_f32 v109, v20, v77, v24
    v_fma_f32 v110, v20, v78, v24
    v_fma_f32 v111, v20, v79, v24
    v_cos_f32 v104, v104
    v_cos_f32 v105, v105
    v_cos_f32 v106, v106
    v_cos_f32 v107, v107
    v_cos_f32 v108, v108
    v_cos_f32 v109, v109
    v_cos_f32 v110, v110
    v_cos_f32 v111, v111
    v_cvt_pk_bf16_f32 v40, v104, v105
    v_cvt_pk_bf16_f32 v41, v106, v107
    v_cvt_pk_bf16_f32 v42, v108, v109
    v_cvt_pk_bf16_f32 v43, v110, v111
    v_fma_f32 v104, v21, v72, v24
    v_fma_f32 v105, v21, v73, v24
    v_fma_f32 v106, v21, v74, v24
    v_fma_f32 v107, v21, v75, v24
    v_fma_f32 v108, v21, v76, v24
    v_fma_f32 v109, v21, v77, v24
    v_fma_f32 v110, v21, v78, v24
    v_fma_f32 v111, v21, v79, v24
    v_cos_f32 v104, v104
    v_cos_f32 v105, v105
    v_cos_f32 v106, v106
    v_cos_f32 v107, v107
    v_cos_f32 v108, v108
    v_cos_f32 v109, v109
    v_cos_f32 v110, v110
    v_cos_f32 v111, v111
    v_cvt_pk_bf16_f32 v48, v104, v105
    v_cvt_pk_bf16_f32 v49, v106, v107
    v_cvt_pk_bf16_f32 v50, v108, v109
    v_cvt_pk_bf16_f32 v51, v110, v111
    v_fma_f32 v104, v22, v72, v24
    v_fma_f32 v105, v22, v73, v24
    v_fma_f32 v106, v22, v74, v24
    v_fma_f32 v107, v22, v75, v24
    v_fma_f32 v108, v22, v76, v24
    v_fma_f32 v109, v22, v77, v24
    v_fma_f32 v110, v22, v78, v24
    v_fma_f32 v111, v22, v79, v24
    v_cos_f32 v104, v104
    v_cos_f32 v105, v105
    v_cos_f32 v106, v106
    v_cos_f32 v107, v107
    v_cos_f32 v108, v108
    v_cos_f32 v109, v109
    v_cos_f32 v110, v110
    v_cos_f32 v111, v111
    v_cvt_pk_bf16_f32 v56, v104, v105
    v_cvt_pk_bf16_f32 v57, v106, v107
    v_cvt_pk_bf16_f32 v58, v108, v109
    v_cvt_pk_bf16_f32 v59, v110, v111
    v_fma_f32 v104, v23, v72, v24
    v_fma_f32 v105, v23, v73, v24
    v_fma_f32 v106, v23, v74, v24
    v_fma_f32 v107, v23, v75, v24
    v_fma_f32 v108, v23, v76, v24
    v_fma_f32 v109, v23, v77, v24
    v_fma_f32 v110, v23, v78, v24
    v_fma_f32 v111, v23, v79, v24
    v_cos_f32 v104, v104
    v_cos_f32 v105, v105
    v_cos_f32 v106, v106
    v_cos_f32 v107, v107
    v_cos_f32 v108, v108
    v_cos_f32 v109, v109
    v_cos_f32 v110, v110
    v_cos_f32 v111, v111
    v_cvt_pk_bf16_f32 v64, v104, v105
    v_cvt_pk_bf16_f32 v65, v106, v107
    v_cvt_pk_bf16_f32 v66, v108, v109
    v_cvt_pk_bf16_f32 v67, v110, v111
    v_add_f32 v72, 0x3e800000, v25
    v_add_f32 v73, 0x3e840000, v25
    v_add_f32 v74, 0x3e880000, v25
    v_add_f32 v75, 0x3e8c0000, v25
    v_add_f32 v76, 0x3ec00000, v25
    v_add_f32 v77, 0x3ec40000, v25
    v_add_f32 v78, 0x3ec80000, v25
    v_add_f32 v79, 0x3ecc0000, v25
    v_fma_f32 v104, v20, v72, v24
    v_fma_f32 v105, v20, v73, v24
    v_fma_f32 v106, v20, v74, v24
    v_fma_f32 v107, v20, v75, v24
    v_fma_f32 v108, v20, v76, v24
    v_fma_f32 v109, v20, v77, v24
    v_fma_f32 v110, v20, v78, v24
    v_fma_f32 v111, v20, v79, v24
    v_cos_f32 v104, v104
    v_cos_f32 v105, v105
    v_cos_f32 v106, v106
    v_cos_f32 v107, v107
    v_cos_f32 v108, v108
    v_cos_f32 v109, v109
    v_cos_f32 v110, v110
    v_cos_f32 v111, v111
    v_cvt_pk_bf16_f32 v44, v104, v105
    v_cvt_pk_bf16_f32 v45, v106, v107
    v_cvt_pk_bf16_f32 v46, v108, v109
    v_cvt_pk_bf16_f32 v47, v110, v111
    s_waitcnt lgkmcnt(0)
    s_add_u32 s16, s4, s39
    s_addc_u32 s17, s5, 0
    s_mov_b32 s18, 4096000
    s_mov_b32 s19, 0x20000
    s_add_u32 m0, s49, 0
    v_add_u32 v26, 0, v16
    buffer_load_dwordx4 v26, s[16:19], 0 offen lds
    s_add_u32 m0, s49, 1024
    v_add_u32 v27, 16384, v16
    buffer_load_dwordx4 v27, s[16:19], 0 offen lds
    s_add_u32 m0, s49, 2048
    v_add_u32 v26, 32768, v16
    buffer_load_dwordx4 v26, s[16:19], 0 offen lds
    s_add_u32 m0, s49, 3072
    v_add_u32 v27, 49152, v16
    buffer_load_dwordx4 v27, s[16:19], 0 offen lds
    s_add_u32 m0, s49, 4096
    v_add_u32 v26, 65536, v16
    buffer_load_dwordx4 v26, s[16:19], 0 offen lds
    s_add_u32 m0, s49, 5120
    v_add_u32 v27, 81920, v16
    buffer_load_dwordx4 v27, s[16:19], 0 offen lds
    s_add_u32 m0, s49, 6144
    v_add_u32 v26, 98304, v16
    buffer_load_dwordx4 v26, s[16:19], 0 offen lds
    s_add_u32 m0, s49, 7168
    v_add_u32 v27, 114688, v16
    buffer_load_dwordx4 v27, s[16:19], 0 offen lds
    s_add_u32 m0, s49, 8192
    v_add_u32 v26, 1024, v16
    buffer_load_dwordx4 v26, s[16:19], 0 offen lds
    s_add_u32 m0, s49, 9216
    v_add_u32 v27, 17408, v16
    buffer_load_dwordx4 v27, s[16:19], 0 offen lds
    s_add_u32 m0, s49, 10240
    v_add_u32 v26, 33792, v16
    buffer_load_dwordx4 v26, s[16:19], 0 offen lds
    s_add_u32 m0, s49, 11264
    v_add_u32 v27, 50176, v16
    buffer_load_dwordx4 v27, s[16:19], 0 offen lds
    v_fma_f32 v104, v21, v72, v24
    v_fma_f32 v105, v21, v73, v24
    v_fma_f32 v106, v21, v74, v24
    v_fma_f32 v107, v21, v75, v24
    v_fma_f32 v108, v21, v76, v24
    v_fma_f32 v109, v21, v77, v24
    v_fma_f32 v110, v21, v78, v24
    v_fma_f32 v111, v21, v79, v24
    v_cos_f32 v104, v104
    v_cos_f32 v105, v105
    v_cos_f32 v106, v106
    v_cos_f32 v107, v107
    v_cos_f32 v108, v108
    v_cos_f32 v109, v109
    v_cos_f32 v110, v110
    v_cos_f32 v111, v111
    v_cvt_pk_bf16_f32 v52, v104, v105
    v_cvt_pk_bf16_f32 v53, v106, v107
    v_cvt_pk_bf16_f32 v54, v108, v109
    v_cvt_pk_bf16_f32 v55, v110, v111
    v_fma_f32 v104, v22, v72, v24
    v_fma_f32 v105, v22, v73, v24
    v_fma_f32 v106, v22, v74, v24
    v_fma_f32 v107, v22, v75, v24
    v_fma_f32 v108, v22, v76, v24
    v_fma_f32 v109, v22, v77, v24
    v_fma_f32 v110, v22, v78, v24
    v_fma_f32 v111, v22, v79, v24
    v_cos_f32 v104, v104
    v_cos_f32 v105, v105
    v_cos_f32 v106, v106
    v_cos_f32 v107, v107
    v_cos_f32 v108, v108
    v_cos_f32 v109, v109
    v_cos_f32 v110, v110
    v_cos_f32 v111, v111
    v_cvt_pk_bf16_f32 v60, v104, v105
    v_cvt_pk_bf16_f32 v61, v106, v107
    v_cvt_pk_bf16_f32 v62, v108, v109
    v_cvt_pk_bf16_f32 v63, v110, v111
    v_fma_f32 v104, v23, v72, v24
    v_fma_f32 v105, v23, v73, v24
    v_fma_f32 v106, v23, v74, v24
    v_fma_f32 v107, v23, v75, v24
    v_fma_f32 v108, v23, v76, v24
    v_fma_f32 v109, v23, v77, v24
    v_fma_f32 v110, v23, v78, v24
    v_fma_f32 v111, v23, v79, v24
    v_cos_f32 v104, v104
    v_cos_f32 v105, v105
    v_cos_f32 v106, v106
    v_cos_f32 v107, v107
    v_cos_f32 v108, v108
    v_cos_f32 v109, v109
    v_cos_f32 v110, v110
    v_cos_f32 v111, v111
    v_cvt_pk_bf16_f32 v68, v104, v105
    v_cvt_pk_bf16_f32 v69, v106, v107
    v_cvt_pk_bf16_f32 v70, v108, v109
    v_cvt_pk_bf16_f32 v71, v110, v111
    v_lshrrev_b32 v20, 2, v0
    v_lshlrev_b32 v21, 7, v20
    v_add_u32 v21, s49, v21
    v_and_b32 v22, 3, v0
    v_lshl_add_u32 v21, v22, 3, v21
    v_bfe_u32 v20, v0, 3, 2
    v_xor_b32 v22, 0, v20
    v_lshl_add_u32 v28, v22, 5, v21
    v_xor_b32 v22, 1, v20
    v_lshl_add_u32 v29, v22, 5, v21
    v_xor_b32 v22, 2, v20
    v_lshl_add_u32 v30, v22, 5, v21
    v_xor_b32 v22, 3, v20
    v_lshl_add_u32 v31, v22, 5, v21
    v_and_b32 v20, 15, v0
    v_lshlrev_b32 v21, 9, v20
    v_lshrrev_b32 v22, 4, v0
    v_lshl_add_u32 v21, v22, 7, v21
    v_and_b32 v20, 7, v0
    s_lshl_b32 s38, s36, 1
    v_xor_b32 v20, s38, v20
    v_lshl_add_u32 v32, v20, 4, v21
    v_xor_b32 v33, 16, v32
    v_add_u32 v32, 61920, v32
    v_add_u32 v33, 61920, v33
    v_lshrrev_b32 v20, 3, v0
    v_lshlrev_b32 v21, 7, v20
    s_lshl_b32 s38, s36, 13
    s_add_u32 s38, s38, 61920
    v_add_u32 v21, s38, v21
    v_and_b32 v20, 7, v0
    v_lshrrev_b32 v22, 5, v0
    v_xor_b32 v20, v20, v22
    v_xor_b32 v22, 0, v20
    v_lshl_add_u32 v36, v22, 4, v21
    v_xor_b32 v22, 2, v20
    v_lshl_add_u32 v37, v22, 4, v21
    v_xor_b32 v22, 4, v20
    v_lshl_add_u32 v38, v22, 4, v21
    v_xor_b32 v22, 6, v20
    v_lshl_add_u32 v39, v22, 4, v21
    v_lshrrev_b32 v20, 3, v0
    v_lshlrev_b32 v17, 8, v20
    v_and_b32 v20, 7, v0
    v_lshl_add_u32 v17, v20, 4, v17
    s_lshr_b32 s38, s30, 1
    s_cmp_ge_u32 s38, 5
    s_cselect_b32 s28, 153600, 0
    s_lshl_b32 s38, s38, 11
    s_add_u32 s28, s28, s38
    s_and_b32 s38, s30, 1
    s_lshl_b32 s38, s38, 7
    s_add_u32 s28, s28, s38
    s_mul_i32 s38, s31, 20480
    s_add_u32 s28, s28, s38
    s_mul_i32 s38, s36, 2621440
    s_add_u32 s28, s28, s38
    s_add_u32 m0, s49, 12288
    v_add_u32 v26, 66560, v16
    buffer_load_dwordx4 v26, s[16:19], 0 offen lds
    s_add_u32 m0, s49, 13312
    v_add_u32 v27, 82944, v16
    buffer_load_dwordx4 v27, s[16:19], 0 offen lds
    s_add_u32 m0, s49, 14336
    v_add_u32 v26, 99328, v16
    buffer_load_dwordx4 v26, s[16:19], 0 offen lds
    s_add_u32 m0, s49, 15360
    v_add_u32 v27, 115712, v16
    buffer_load_dwordx4 v27, s[16:19], 0 offen lds
    s_xor_b32 s31, s28, 128
    s_branch L_common1
L_back:
    s_add_u32 s86, s86, s87
L_hop:
    s_mov_b64 exec, 0
    s_cmp_ge_u32 s86, s88
    s_cbranch_scc1 L_hopx
    s_cmp_eq_u32 s86, 1
    s_cbranch_scc1 L_pad1
    s_cmp_eq_u32 s86, 2
    s_cbranch_scc1 L_pad2
    s_cmp_eq_u32 s86, 3
    s_cbranch_scc1 L_pad3
    s_cmp_eq_u32 s86, 4
    s_cbranch_scc1 L_pad4
    s_cmp_eq_u32 s86, 5
    s_cbranch_scc1 L_pad5
    s_cmp_eq_u32 s86, 6
    s_cbranch_scc1 L_pad6
    s_cmp_eq_u32 s86, 7
    s_cbranch_scc1 L_pad7
    s_cmp_eq_u32 s86, 8
    s_cbranch_scc1 L_pad8
    s_cmp_eq_u32 s86, 9
    s_cbranch_scc1 L_pad9
    s_cmp_eq_u32 s86, 10
    s_cbranch_scc1 L_pad10
    s_cmp_eq_u32 s86, 11
    s_cbranch_scc1 L_pad11
L_hopx:
    s_mov_b64 exec, -1
    s_cmp_eq_u32 s81, 1
    s_cbranch_scc1 L_ret1
    s_cmp_eq_u32 s81, 3
    s_cbranch_scc1 L_ret3
    s_branch L_common1
L_pre_other:
    v_mov_b32 v16, 0
    v_mov_b32 v17, 0
    s_sub_u32 s30, s30, 20
    s_lshl_b32 s37, s30, 2
    s_add_u32 s37, s37, s36
    s_cmp_lt_u32 s30, 4
    s_cbranch_scc1 L_nocpf
    s_cmp_lg_u32 s36, 1
    s_cbranch_scc1 L_nocpf
    s_getpc_b64 s[98:99]
L_pc:
    s_add_u32 s98, s98, L_common1-L_pc
    s_addc_u32 s99, s99, 0
    s_sub_u32 s38, s30, 4
    s_lshl_b32 s38, s38, 13
    v_lshl_add_u32 v20, v0, 7, s38
    v_min_u32 v20, L_end-L_common1, v20
    v_mov_b32 v23, s99
    v_add_co_u32 v22, vcc, s98, v20
    s_nop 1
    v_addc_co_u32 v23, vcc, 0, v23, vcc
    global_load_dword v24, v[22:23], off
L_nocpf:
    s_waitcnt lgkmcnt(0)
    s_mov_b32 s16, s4
    s_mov_b32 s17, s5
    s_mov_b32 s18, 8192000
    s_mov_b32 s19, 0x20000
    s_mul_i32 s38, s37, 43
    s_lshr_b32 s38, s38, 7
    s_mul_i32 s39, s38, 3
    s_sub_u32 s39, s37, s39
    s_sub_u32 s48, 3, s29
    s_and_b32 s48, s48, 7
    s_lshl_b32 s39, s39, 3
    s_add_u32 s39, s39, s48
    s_mul_i32 s39, s39, 400
    s_mul_i32 s38, s38, 27
    s_add_u32 s38, s38, s39
    s_lshl_b32 s38, s38, 10
    s_sub_u32 s38, s38, 28288
    v_lshrrev_b32 v20, 3, v0
    v_lshlrev_b32 v17, 10, v20
    v_and_b32 v20, 7, v0
    v_lshl_add_u32 v17, v20, 4, v17
    v_add_u32 v17, s38, v17
    buffer_load_dwordx4 v[40:43], v17, s[16:19], 0 offen
    v_add_u32 v17, 8192, v17
    buffer_load_dwordx4 v[44:47], v17, s[16:19], 0 offen
    v_add_u32 v17, 8192, v17
    buffer_load_dwordx4 v[48:51], v17, s[16:19], 0 offen
    v_add_u32 v17, 8192, v17
    buffer_load_dwordx4 v[52:55], v17, s[16:19], 0 offen
L_pre_zero:
    s_cmp_lg_u32 s2, 163
    s_cbranch_scc1 L_common1
    s_cmp_lg_u32 s36, 0
    s_cbranch_scc1 L_common1
    s_add_u32 s40, s26, 50331648
    s_addc_u32 s41, s27, 0
    s_mov_b32 s42, 81920
    s_mov_b32 s43, 0x20000
    v_lshlrev_b32 v16, 8, v0
    v_mov_b32 v20, 0
    s_mov_b32 s38, 16384
    buffer_store_dword v20, v16, s[40:43], 0 offen sc1
    buffer_store_dword v20, v16, s[40:43], s38 offen sc1
    s_mov_b32 s38, 32768
    buffer_store_dword v20, v16, s[40:43], s38 offen sc1
    s_mov_b32 s38, 49152
    buffer_store_dword v20, v16, s[40:43], s38 offen sc1
    s_mov_b32 s38, 65536
    buffer_store_dword v20, v16, s[40:43], s38 offen sc1
    s_branch L_common1
.p2align 12
L_common1:
    s_lshr_b32 s38, s2, 3
    s_and_b32 s35, s38, 3
    s_lshr_b32 s34, s38, 2
    s_mul_i32 s50, s38, 43
    s_lshr_b32 s50, s50, 7
    s_mul_i32 s51, s50, 3
    s_sub_u32 s51, s38, s51
    s_sub_u32 s52, s38, 24
    s_cmp_lt_u32 s38, 24
    s_cselect_b32 s50, s50, s52
    s_cselect_b32 s51, s51, 3
    s_bitcmp0_b32 s29, 1
    s_cselect_b32 s34, s50, s34
    s_cselect_b32 s35, s51, s35
    s_and_b32 s32, s29, 1
    s_lshl_b32 s32, s32, 3
    s_add_u32 s32, s32, s34
    s_lshr_b32 s33, s29, 1
    s_lshl_b32 s33, s33, 2
    s_add_u32 s33, s33, s35
    v_lshlrev_b32 v1, 11, v1
    v_and_b32 v12, 7, v0
    v_lshl_add_u32 v1, v12, 4, v1
    s_lshl_b32 s38, s33, 7
    v_add_u32 v1, s38, v1
    s_mov_b32 s8, s6
    s_mov_b32 s9, s7
    s_mov_b32 s10, 15728640
    s_mov_b32 s11, 0x20000
    s_lshl_b32 s39, s36, 10
    s_mul_i32 s48, s34, 2
    s_lshl_b32 s50, s48, 20
    s_mul_i32 s65, s48, 4128
    s_add_u32 s65, s65, s39
    s_add_u32 s48, s48, 1
    s_cmp_eq_u32 s48, 15
    s_cselect_b32 s48, 0, s48
    s_lshl_b32 s51, s48, 20
    s_mul_i32 s66, s48, 4128
    s_add_u32 s66, s66, s39
    s_add_u32 s48, s48, 1
    s_cmp_eq_u32 s48, 15
    s_cselect_b32 s48, 0, s48
    s_lshl_b32 s52, s48, 20
    s_mul_i32 s67, s48, 4128
    s_add_u32 s67, s67, s39
    s_add_u32 s48, s48, 1
    s_cmp_eq_u32 s48, 15
    s_cselect_b32 s48, 0, s48
    s_lshl_b32 s53, s48, 20
    s_mul_i32 s68, s48, 4128
    s_add_u32 s68, s68, s39
    s_add_u32 s48, s48, 1
    s_cmp_eq_u32 s48, 15
    s_cselect_b32 s48, 0, s48
    s_lshl_b32 s54, s48, 20
    s_mul_i32 s69, s48, 4128
    s_add_u32 s69, s69, s39
    s_add_u32 s48, s48, 1
    s_cmp_eq_u32 s48, 15
    s_cselect_b32 s48, 0, s48
    s_lshl_b32 s55, s48, 20
    s_mul_i32 s70, s48, 4128
    s_add_u32 s70, s70, s39
    s_add_u32 s48, s48, 1
    s_cmp_eq_u32 s48, 15
    s_cselect_b32 s48, 0, s48
    s_lshl_b32 s56, s48, 20
    s_mul_i32 s71, s48, 4128
    s_add_u32 s71, s71, s39
    s_add_u32 s48, s48, 1
    s_cmp_eq_u32 s48, 15
    s_cselect_b32 s48, 0, s48
    s_lshl_b32 s57, s48, 20
    s_mul_i32 s72, s48, 4128
    s_add_u32 s72, s72, s39
    s_add_u32 s48, s48, 1
    s_cmp_eq_u32 s48, 15
    s_cselect_b32 s48, 0, s48
    s_lshl_b32 s58, s48, 20
    s_mul_i32 s73, s48, 4128
    s_add_u32 s73, s73, s39
    s_add_u32 s48, s48, 1
    s_cmp_eq_u32 s48, 15
    s_cselect_b32 s48, 0, s48
    s_lshl_b32 s59, s48, 20
    s_mul_i32 s74, s48, 4128
    s_add_u32 s74, s74, s39
    s_add_u32 s48, s48, 1
    s_cmp_eq_u32 s48, 15
    s_cselect_b32 s48, 0, s48
    s_lshl_b32 s60, s48, 20
    s_mul_i32 s75, s48, 4128
    s_add_u32 s75, s75, s39
    s_add_u32 s48, s48, 1
    s_cmp_eq_u32 s48, 15
    s_cselect_b32 s48, 0, s48
    s_lshl_b32 s61, s48, 20
    s_mul_i32 s76, s48, 4128
    s_add_u32 s76, s76, s39
    s_add_u32 s48, s48, 1
    s_cmp_eq_u32 s48, 15
    s_cselect_b32 s48, 0, s48
    s_lshl_b32 s62, s48, 20
    s_mul_i32 s77, s48, 4128
    s_add_u32 s77, s77, s39
    s_add_u32 s48, s48, 1
    s_cmp_eq_u32 s48, 15
    s_cselect_b32 s48, 0, s48
    s_lshl_b32 s63, s48, 20
    s_mul_i32 s78, s48, 4128
    s_add_u32 s78, s78, s39
    s_add_u32 s48, s48, 1
    s_cmp_eq_u32 s48, 15
    s_cselect_b32 s48, 0, s48
    s_lshl_b32 s64, s48, 20
    s_mul_i32 s79, s48, 4128
    s_add_u32 s79, s79, s39
    s_mov_b32 s12, s26
    s_mov_b32 s13, s27
    s_mov_b32 s14, 10485760
    s_mov_b32 s15, 0x20000
    s_add_u32 s40, s26, 50331648
    s_addc_u32 s41, s27, 0
    s_mov_b32 s42, 81920
    s_mov_b32 s43, 0x20000
    s_cmp_ge_u32 s2, 160
    s_cbranch_scc0 L_body_x
    s_and_b32 s38, s29, 1
    s_mul_i32 s38, s38, 48
    s_add_u32 s37, s37, s38
    s_mul_i32 s38, s37, 43
    s_lshr_b32 s38, s38, 7
    s_mul_i32 s39, s38, 3
    s_sub_u32 s39, s37, s39
    s_lshl_b32 s38, s38, 12
    s_mul_i32 s39, s39, 5242880
    s_add_u32 s38, s38, s39
    s_lshr_b32 s39, s29, 1
    s_lshl_b32 s39, s39, 9
    s_add_u32 s38, s38, s39
    v_lshrrev_b32 v20, 5, v0
    v_lshlrev_b32 v16, 11, v20
    v_and_b32 v20, 31, v0
    v_lshl_add_u32 v16, v20, 4, v16
    v_add_u32 v16, s38, v16
    s_mov_b32 s97, 0
    buffer_load_dwordx4 v[40:43], v16, s[8:11], s97 offen
    s_mov_b32 s97, 1048576
    buffer_load_dwordx4 v[44:47], v16, s[8:11], s97 offen
    s_mov_b32 s97, 2097152
    buffer_load_dwordx4 v[48:51], v16, s[8:11], s97 offen
    s_mov_b32 s97, 3145728
    buffer_load_dwordx4 v[52:55], v16, s[8:11], s97 offen
    s_mov_b32 s97, 4194304
    buffer_load_dwordx4 v[56:59], v16, s[8:11], s97 offen
    s_mov_b32 s97, 131072
    buffer_load_dwordx4 v[40:43], v16, s[8:11], s97 offen
    s_mov_b32 s97, 1179648
    buffer_load_dwordx4 v[44:47], v16, s[8:11], s97 offen
    s_mov_b32 s97, 2228224
    buffer_load_dwordx4 v[48:51], v16, s[8:11], s97 offen
    s_mov_b32 s97, 3276800
    buffer_load_dwordx4 v[52:55], v16, s[8:11], s97 offen
    s_mov_b32 s97, 4325376
    buffer_load_dwordx4 v[56:59], v16, s[8:11], s97 offen
    s_mov_b32 s97, 262144
    buffer_load_dwordx4 v[40:43], v16, s[8:11], s97 offen
    s_mov_b32 s97, 1310720
    buffer_load_dwordx4 v[44:47], v16, s[8:11], s97 offen
    s_mov_b32 s97, 2359296
    buffer_load_dwordx4 v[48:51], v16, s[8:11], s97 offen
    s_mov_b32 s97, 3407872
    buffer_load_dwordx4 v[52:55], v16, s[8:11], s97 offen
    s_mov_b32 s97, 4456448
    buffer_load_dwordx4 v[56:59], v16, s[8:11], s97 offen
    s_cmp_lg_u32 s2, 163
    s_cbranch_scc1 L_noz
    s_cmp_lg_u32 s36, 0
    s_cbranch_scc1 L_noz
    s_mov_b32 s16, s24
    s_mov_b32 s17, s25
    s_mov_b32 s18, 256
    s_mov_b32 s19, 0x20000
    v_lshlrev_b32 v20, 8, v0
    v_mov_b32 v21, 1
    s_waitcnt vmcnt(15)
    buffer_store_dword v21, v20, s[16:19], 0 offen sc1
L_noz:
    s_mul_i32 s48, s35, 0
    s_lshl_b32 s44, s48, 11
    s_add_u32 s48, s48, 1
    s_cmp_eq_u32 s48, 5
    s_cselect_b32 s48, 0, s48
    s_lshl_b32 s45, s48, 11
    s_add_u32 s48, s48, 1
    s_cmp_eq_u32 s48, 5
    s_cselect_b32 s48, 0, s48
    s_lshl_b32 s46, s48, 11
    s_add_u32 s48, s48, 1
    s_cmp_eq_u32 s48, 5
    s_cselect_b32 s48, 0, s48
    s_lshl_b32 s47, s48, 11
    s_add_u32 s48, s48, 1
    s_cmp_eq_u32 s48, 5
    s_cselect_b32 s48, 0, s48
    s_lshl_b32 s48, s48, 11
    s_mul_i32 s38, s32, 655360
    s_mul_i32 s39, s36, 163840
    s_add_u32 s38, s38, s39
    s_add_u32 s38, s38, 30720
    v_lshlrev_b32 v2, 4, v0
    v_add_u32 v2, s38, v2
    v_bfe_u32 v13, v0, 3, 1
    v_lshrrev_b32 v12, 5, v0
    v_xor_b32 v12, v12, v13
    v_bfe_u32 v14, v0, 4, 1
    v_lshl_add_u32 v12, v12, 1, v14
    v_bfe_u32 v14, v0, 2, 1
    v_lshl_add_u32 v12, v12, 1, v14
    v_mul_u32_u24 v3, 4128, v12
    v_lshl_add_u32 v3, v13, 9, v3
    v_and_b32 v13, 3, v0
    v_lshl_add_u32 v3, v13, 3, v3
    s_lshl_b32 s38, s36, 5
    v_add_u32 v3, s38, v3
    v_add_u32 v4, 33024, v3
    v_cmp_eq_u32 vcc, 7, v12
    s_lshl_b32 s38, s36, 12
    s_add_u32 s38, s38, 123840
    v_cndmask_b32 v4, v4, v3, vcc
    v_lshlrev_b32 v5, 4, v0
    v_add_u32 v5, s38, v5
    s_lshr_b32 s38, s36, 1
    s_lshl_b32 s38, s38, 11
    s_add_u32 s38, s38, 123840
    v_lshlrev_b32 v6, 4, v0
    v_add_u32 v6, s38, v6
    s_and_b32 s38, s36, 2
    v_lshrrev_b32 v13, 4, v0
    v_xor_b32 v13, s38, v13
    v_mul_u32_u24 v7, 541696, v13
    v_and_b32 v13, 15, v0
    v_lshl_add_u32 v7, v13, 4, v7
    s_lshl_b32 s38, s29, 8
    v_lshlrev_b32 v8, 11, v0
    v_add_u32 v8, s38, v8
    s_lshl_b32 s38, s29, 11
    v_lshlrev_b32 v9, 8, v0
    v_add_u32 v9, s38, v9
    v_mov_b32 v11, 1
    v_lshrrev_b32 v12, 3, v0
    v_add_u32 v12, s36, v12
    v_lshl_add_u32 v9, v12, 20, v9
    v_and_b32 v12, 2, v0
    s_lshl_b32 s38, s32, 2
    s_add_u32 s38, s38, 1
    v_add_u32 v12, s38, v12
    v_cvt_f32_u32 v12, v12
    v_mul_f32 v12, 0x3c000000, v12
    v_and_b32 v13, 1, v0
    v_cvt_f32_u32 v13, v13
    v_mul_f32 v13, 0x3e800000, v13
    v_bfe_u32 v14, v0, 4, 1
    v_bfe_u32 v15, v0, 2, 1
    v_xor_b32 v14, v14, v15
    v_lshlrev_b32 v15, 2, v14
    v_cvt_f32_u32 v15, v15
    v_fma_f32 v13, v15, v12, v13
    s_cmp_lt_u32 s33, 8
    s_cselect_b32 s38, 0x40000000, 1.0
    s_mov_b32 s39, 0x00000000
    v_fma_f32 v104, v12, s39, v13
    v_cos_f32 v104, v104
    s_mov_b32 s39, 0x3f800000
    v_fma_f32 v105, v12, s39, v13
    v_cos_f32 v105, v105
    s_mov_b32 s39, 0x41000000
    v_fma_f32 v106, v12, s39, v13
    v_cos_f32 v106, v106
    s_mov_b32 s39, 0x41100000
    v_fma_f32 v107, v12, s39, v13
    v_cos_f32 v107, v107
    s_mov_b32 s39, 0x40000000
    v_fma_f32 v108, v12, s39, v13
    v_cos_f32 v108, v108
    s_mov_b32 s39, 0x40400000
    v_fma_f32 v109, v12, s39, v13
    v_cos_f32 v109, v109
    s_mov_b32 s39, 0x41200000
    v_fma_f32 v110, v12, s39, v13
    v_cos_f32 v110, v110
    s_mov_b32 s39, 0x41300000
    v_fma_f32 v111, v12, s39, v13
    v_cos_f32 v111, v111
    v_mul_f32 v104, s38, v104
    v_mul_f32 v105, s38, v105
    v_mul_f32 v106, s38, v106
    v_mul_f32 v107, s38, v107
    v_mul_f32 v108, s38, v108
    v_mul_f32 v109, s38, v109
    v_mul_f32 v110, s38, v110
    v_mul_f32 v111, s38, v111
    v_cmp_eq_u32 vcc, 0, v14
    s_nop 1
    v_cndmask_b32 v111, 0, v111, vcc
    v_cvt_pk_bf16_f32 v136, v104, v105
    v_cvt_pk_bf16_f32 v137, v106, v107
    v_cvt_pk_bf16_f32 v138, v108, v109
    v_cvt_pk_bf16_f32 v139, v110, v111
    v_bfe_u32 v12, v0, 3, 1
    v_lshrrev_b32 v13, 5, v0
    v_sub_u32 v12, v12, v13
    v_cmp_eq_u32 vcc, 0, v12
    s_nop 1
    v_cndmask_b32 v112, 0, v136, vcc
    v_cndmask_b32 v113, 0, v137, vcc
    v_cndmask_b32 v114, 0, v138, vcc
    v_cndmask_b32 v115, 0, v139, vcc
    v_accvgpr_write_b32 a128, v112
    v_accvgpr_write_b32 a129, v113
    v_accvgpr_write_b32 a130, v114
    v_accvgpr_write_b32 a131, v115
    s_mov_b32 s80, 0x80008000
    s_add_u32 s4, s26, 12582912
    s_addc_u32 s5, s27, 0
    s_mov_b32 s6, 524288
    s_mov_b32 s7, 0x20000
    s_lshr_b32 s94, s2, 3
    s_and_b32 s38, s94, 7
    s_lshl_b32 s94, s94, 12
    s_lshl_b32 s38, s38, 2
    s_lshr_b32 s38, 0x76542310, s38
    s_and_b32 s38, s38, 7
    s_mov_b32 s96, s38
    s_bfe_u32 s39, s2, 0x10006
    s_bfe_u32 s96, s29, 0x10001
    s_xor_b32 s39, s39, s96
    s_lshl_b32 s39, s39, 2
    s_bfe_u32 s96, s2, 0x20003
    s_add_u32 s39, s39, s96
    s_lshl_b32 s39, s39, 2
    s_lshr_b32 s39, 0x75206431, s39
    s_and_b32 s39, s39, 7
    s_cmp_ge_u32 s2, 128
    s_cselect_b32 s38, s39, s38
    s_bfe_u32 s39, s2, 0x10005
    s_add_u32 s39, s39, 2
    s_lshr_b32 s96, s2, 6
    s_cmp_ge_u32 s2, 128
    s_cselect_b32 s96, s39, s96
    s_lshl_b32 s96, s96, 3
    s_add_u32 s96, s96, s38
    s_mul_i32 s39, s38, 41
    s_lshr_b32 s39, s39, 6
    s_lshl_b32 s38, s38, 5
    s_mul_i32 s39, s39, 50
    s_sub_u32 s89, s38, s39
    v_mov_b32 v240, s36
    v_lshlrev_b32 v251, 4, v0
    v_lshl_add_u32 v250, v240, 10, v251
    v_lshl_add_u32 v248, v240, 17, v251
    v_lshrrev_b32 v241, 4, v0
    v_lshlrev_b32 v249, 11, v241
    v_lshl_add_u32 v249, v240, 13, v249
    v_lshlrev_b32 v241, 2, v241
    v_and_b32 v242, 15, v0
    v_xor_b32 v241, v241, v242
    v_lshl_add_u32 v249, v241, 4, v249
    v_bfe_u32 v241, v0, 3, 1
    v_bfe_u32 v242, v0, 4, 1
    v_lshl_add_u32 v241, v241, 1, v242
    v_xor_b32 v242, v240, v241
    v_lshlrev_b32 v253, 8, v241
    v_lshl_add_u32 v253, v242, 6, v253
    v_and_b32 v241, 3, v0
    v_lshl_add_u32 v253, v241, 4, v253
    v_bfe_u32 v241, v0, 2, 1
    v_lshl_add_u32 v253, v241, 3, v253
    v_lshrrev_b32 v241, 5, v0
    v_lshl_add_u32 v253, v241, 11, v253
    v_add_u32 v253, 32768, v253
    v_lshlrev_b32 v252, 13, v241
    v_bfe_u32 v242, v0, 4, 1
    v_lshl_add_u32 v252, v242, 11, v252
    v_and_b32 v242, 15, v0
    v_lshl_add_u32 v252, v242, 4, v252
    v_lshl_add_u32 v252, v240, 8, v252
    v_and_b32 v242, 31, v0
    v_lshrrev_b32 v243, 4, v0
    v_and_b32 v244, 15, v0
    v_lshlrev_b32 v244, 4, v244
    v_lshl_add_u32 v251, v243, 9, v244
    v_lshl_add_u32 v252, v243, 13, v244
    v_lshl_add_u32 v252, v240, 8, v252
    v_add_u32 v242, s89, v242
    v_cmp_gt_u32 vcc, 50, v242
    v_subrev_u32 v243, 50, v242
    v_cvt_f32_u32 v244, v241
    v_cndmask_b32 v242, v243, v242, vcc
    v_cvt_f32_u32 v243, v242
    v_mul_f32 v244, 0x41000000, v244
    v_add_f32 v243, 0x41600000, v243
    v_mul_f32 v243, 0x3c000000, v243
    v_mov_b32 v245, 0x3e800000
    v_mov_b32 v247, 0
    v_add_f32 v246, 0x3f800000, v244
    v_mul_f32 v152, v246, v243
    v_fma_f32 v153, v246, v243, v245
    v_add_f32 v246, 0x40400000, v244
    v_mul_f32 v154, v246, v243
    v_fma_f32 v155, v246, v243, v245
    v_add_f32 v246, 0x40a00000, v244
    v_mul_f32 v156, v246, v243
    v_fma_f32 v157, v246, v243, v245
    v_add_f32 v246, 0x40e00000, v244
    v_mul_f32 v158, v246, v243
    v_fma_f32 v159, v246, v243, v245
    v_cos_f32 v152, v152
    v_cos_f32 v153, v153
    v_cos_f32 v154, v154
    v_cos_f32 v155, v155
    v_cos_f32 v156, v156
    v_cos_f32 v157, v157
    v_cos_f32 v158, v158
    v_cos_f32 v159, v159
    v_mul_f32 v152, 0xbd38aa3b, v152
    v_mul_f32 v153, 0xbd38aa3b, v153
    v_mul_f32 v154, 0xbd38aa3b, v154
    v_mul_f32 v155, 0xbd38aa3b, v155
    v_mul_f32 v156, 0xbd38aa3b, v156
    v_mul_f32 v157, 0xbd38aa3b, v157
    v_mul_f32 v158, 0xbd38aa3b, v158
    v_mul_f32 v159, 0xbd38aa3b, v159
    v_cvt_pk_bf16_f32 v152, v152, v153
    v_cvt_pk_bf16_f32 v153, v154, v155
    v_cvt_pk_bf16_f32 v154, v156, v157
    v_cvt_pk_bf16_f32 v155, v158, v159
    v_cndmask_b32 v156, 0, v152, vcc
    v_cndmask_b32 v152, v152, v247, vcc
    v_cndmask_b32 v157, 0, v153, vcc
    v_cndmask_b32 v153, v153, v247, vcc
    v_cndmask_b32 v158, 0, v154, vcc
    v_cndmask_b32 v154, v154, v247, vcc
    v_cndmask_b32 v159, 0, v155, vcc
    v_cndmask_b32 v155, v155, v247, vcc
    v_accvgpr_write_b32 a216, v156
    v_accvgpr_write_b32 a232, v152
    v_accvgpr_write_b32 a217, v157
    v_accvgpr_write_b32 a233, v153
    v_accvgpr_write_b32 a218, v158
    v_accvgpr_write_b32 a234, v154
    v_accvgpr_write_b32 a219, v159
    v_accvgpr_write_b32 a235, v155
    v_add_f32 v246, 0x41880000, v244
    v_mul_f32 v152, v246, v243
    v_fma_f32 v153, v246, v243, v245
    v_add_f32 v246, 0x41980000, v244
    v_mul_f32 v154, v246, v243
    v_fma_f32 v155, v246, v243, v245
    v_add_f32 v246, 0x41a80000, v244
    v_mul_f32 v156, v246, v243
    v_fma_f32 v157, v246, v243, v245
    v_add_f32 v246, 0x41b80000, v244
    v_mul_f32 v158, v246, v243
    v_fma_f32 v159, v246, v243, v245
    v_cos_f32 v152, v152
    v_cos_f32 v153, v153
    v_cos_f32 v154, v154
    v_cos_f32 v155, v155
    v_cos_f32 v156, v156
    v_cos_f32 v157, v157
    v_cos_f32 v158, v158
    v_cos_f32 v159, v159
    v_mul_f32 v152, 0xbd38aa3b, v152
    v_mul_f32 v153, 0xbd38aa3b, v153
    v_mul_f32 v154, 0xbd38aa3b, v154
    v_mul_f32 v155, 0xbd38aa3b, v155
    v_mul_f32 v156, 0xbd38aa3b, v156
    v_mul_f32 v157, 0xbd38aa3b, v157
    v_mul_f32 v158, 0xbd38aa3b, v158
    v_mul_f32 v159, 0xbd38aa3b, v159
    v_cvt_pk_bf16_f32 v152, v152, v153
    v_cvt_pk_bf16_f32 v153, v154, v155
    v_cvt_pk_bf16_f32 v154, v156, v157
    v_cvt_pk_bf16_f32 v155, v158, v159
    v_cndmask_b32 v156, 0, v152, vcc
    v_cndmask_b32 v152, v152, v247, vcc
    v_cndmask_b32 v157, 0, v153, vcc
    v_cndmask_b32 v153, v153, v247, vcc
    v_cndmask_b32 v158, 0, v154, vcc
    v_cndmask_b32 v154, v154, v247, vcc
    v_cndmask_b32 v159, 0, v155, vcc
    v_cndmask_b32 v155, v155, v247, vcc
    v_accvgpr_write_b32 a220, v156
    v_accvgpr_write_b32 a236, v152
    v_accvgpr_write_b32 a221, v157
    v_accvgpr_write_b32 a237, v153
    v_accvgpr_write_b32 a222, v158
    v_accvgpr_write_b32 a238, v154
    v_accvgpr_write_b32 a223, v159
    v_accvgpr_write_b32 a239, v155
    v_add_f32 v246, 0x42040000, v244
    v_mul_f32 v152, v246, v243
    v_fma_f32 v153, v246, v243, v245
    v_add_f32 v246, 0x420c0000, v244
    v_mul_f32 v154, v246, v243
    v_fma_f32 v155, v246, v243, v245
    v_add_f32 v246, 0x42140000, v244
    v_mul_f32 v156, v246, v243
    v_fma_f32 v157, v246, v243, v245
    v_add_f32 v246, 0x421c0000, v244
    v_mul_f32 v158, v246, v243
    v_fma_f32 v159, v246, v243, v245
    v_cos_f32 v152, v152
    v_cos_f32 v153, v153
    v_cos_f32 v154, v154
    v_cos_f32 v155, v155
    v_cos_f32 v156, v156
    v_cos_f32 v157, v157
    v_cos_f32 v158, v158
    v_cos_f32 v159, v159
    v_mul_f32 v152, 0xbd38aa3b, v152
    v_mul_f32 v153, 0xbd38aa3b, v153
    v_mul_f32 v154, 0xbd38aa3b, v154
    v_mul_f32 v155, 0xbd38aa3b, v155
    v_mul_f32 v156, 0xbd38aa3b, v156
    v_mul_f32 v157, 0xbd38aa3b, v157
    v_mul_f32 v158, 0xbd38aa3b, v158
    v_mul_f32 v159, 0xbd38aa3b, v159
    v_cvt_pk_bf16_f32 v152, v152, v153
    v_cvt_pk_bf16_f32 v153, v154, v155
    v_cvt_pk_bf16_f32 v154, v156, v157
    v_cvt_pk_bf16_f32 v155, v158, v159
    v_cndmask_b32 v156, 0, v152, vcc
    v_cndmask_b32 v152, v152, v247, vcc
    v_cndmask_b32 v157, 0, v153, vcc
    v_cndmask_b32 v153, v153, v247, vcc
    v_cndmask_b32 v158, 0, v154, vcc
    v_cndmask_b32 v154, v154, v247, vcc
    v_cndmask_b32 v159, 0, v155, vcc
    v_cndmask_b32 v155, v155, v247, vcc
    v_accvgpr_write_b32 a224, v156
    v_accvgpr_write_b32 a240, v152
    v_accvgpr_write_b32 a225, v157
    v_accvgpr_write_b32 a241, v153
    v_accvgpr_write_b32 a226, v158
    v_accvgpr_write_b32 a242, v154
    v_accvgpr_write_b32 a227, v159
    v_accvgpr_write_b32 a243, v155
    v_add_f32 v246, 0x42440000, v244
    v_mul_f32 v152, v246, v243
    v_fma_f32 v153, v246, v243, v245
    v_add_f32 v246, 0x424c0000, v244
    v_mul_f32 v154, v246, v243
    v_fma_f32 v155, v246, v243, v245
    v_add_f32 v246, 0x42540000, v244
    v_mul_f32 v156, v246, v243
    v_fma_f32 v157, v246, v243, v245
    v_add_f32 v246, 0x425c0000, v244
    v_mul_f32 v158, v246, v243
    v_fma_f32 v159, v246, v243, v245
    v_cos_f32 v152, v152
    v_cos_f32 v153, v153
    v_cos_f32 v154, v154
    v_cos_f32 v155, v155
    v_cos_f32 v156, v156
    v_cos_f32 v157, v157
    v_cos_f32 v158, v158
    v_cos_f32 v159, v159
    v_mul_f32 v152, 0xbd38aa3b, v152
    v_mul_f32 v153, 0xbd38aa3b, v153
    v_mul_f32 v154, 0xbd38aa3b, v154
    v_mul_f32 v155, 0xbd38aa3b, v155
    v_mul_f32 v156, 0xbd38aa3b, v156
    v_mul_f32 v157, 0xbd38aa3b, v157
    v_mul_f32 v158, 0xbd38aa3b, v158
    v_mul_f32 v159, 0xbd38aa3b, v159
    v_cvt_pk_bf16_f32 v152, v152, v153
    v_cvt_pk_bf16_f32 v153, v154, v155
    v_cvt_pk_bf16_f32 v154, v156, v157
    v_cvt_pk_bf16_f32 v155, v158, v159
    v_cndmask_b32 v156, 0, v152, vcc
    v_cndmask_b32 v152, v152, v247, vcc
    v_cndmask_b32 v157, 0, v153, vcc
    v_cndmask_b32 v153, v153, v247, vcc
    v_cndmask_b32 v158, 0, v154, vcc
    v_cndmask_b32 v154, v154, v247, vcc
    v_cndmask_b32 v159, 0, v155, vcc
    v_cndmask_b32 v155, v155, v247, vcc
    v_accvgpr_write_b32 a228, v156
    v_accvgpr_write_b32 a244, v152
    v_accvgpr_write_b32 a229, v157
    v_accvgpr_write_b32 a245, v153
    v_accvgpr_write_b32 a230, v158
    v_accvgpr_write_b32 a246, v154
    v_accvgpr_write_b32 a231, v159
    v_accvgpr_write_b32 a247, v155
    v_bfe_u32 v12, v0, 2, 1
    v_mul_u32_u24 v12, 0xaaaa, v12
    v_add_u32 v250, 0x4444, v12
    s_and_b32 s38, s29, 1
    s_lshl_b32 s38, s38, 3
    s_add_u32 s38, s38, s34
    s_lshl_b32 s38, s38, 20
    s_lshl_b32 s39, s35, 14
    s_add_u32 s38, s38, s39
    s_lshl_b32 s39, s36, 12
    s_add_u32 s38, s38, s39
    s_lshr_b32 s39, s29, 1
    s_lshl_b32 s39, s39, 9
    s_add_u32 s38, s38, s39
    v_lshrrev_b32 v12, 5, v0
    v_lshlrev_b32 v14, 11, v12
    v_and_b32 v12, 31, v0
    v_lshl_add_u32 v13, v12, 4, v14
    v_add_u32 v14, s38, v13
    v_subrev_u32 v12, 123840, v5
    v_subrev_u32 v15, 123840, v6
    s_mov_b32 m0, s65
    s_nop 0
    buffer_load_dwordx4 v1, s[8:11], s50 offen lds
    s_mov_b32 m0, s66
    s_nop 0
    buffer_load_dwordx4 v1, s[8:11], s51 offen lds
    s_mov_b32 m0, s67
    s_nop 0
    buffer_load_dwordx4 v1, s[8:11], s52 offen lds
    s_mov_b32 m0, s68
    s_nop 0
    buffer_load_dwordx4 v1, s[8:11], s53 offen lds
    s_mov_b32 m0, s69
    s_nop 0
    buffer_load_dwordx4 v1, s[8:11], s54 offen lds
    s_mov_b32 m0, s70
    s_nop 0
    buffer_load_dwordx4 v1, s[8:11], s55 offen lds
    s_mov_b32 m0, s71
    s_nop 0
    buffer_load_dwordx4 v1, s[8:11], s56 offen lds
    s_mov_b32 m0, s72
    s_nop 0
    buffer_load_dwordx4 v1, s[8:11], s57 offen lds
    s_mov_b32 m0, s73
    s_nop 0
    buffer_load_dwordx4 v1, s[8:11], s58 offen lds
    s_mov_b32 m0, s74
    s_nop 0
    buffer_load_dwordx4 v1, s[8:11], s59 offen lds
    s_mov_b32 m0, s75
    s_nop 0
    buffer_load_dwordx4 v1, s[8:11], s60 offen lds
    s_mov_b32 m0, s76
    s_nop 0
    buffer_load_dwordx4 v1, s[8:11], s61 offen lds
    s_mov_b32 s81, 3
    s_add_u32 s86, s36, 1
    s_mov_b32 s87, 4
    s_mov_b32 s88, 13
    s_branch L_hop
L_ret3:
    s_branch L_common2
L_body_x:
    s_mov_b32 s81, 1
    s_add_u32 s86, s36, 1
    s_mov_b32 s87, 4
    s_mov_b32 s88, 13
    s_branch L_hop
L_ret1:
    s_waitcnt vmcnt(8)
    ds_read_b64_tr_b16 v[72:73], v28 offset:0
    ds_read_b64_tr_b16 v[74:75], v28 offset:2048
    ds_read_b64_tr_b16 v[76:77], v28 offset:4096
    ds_read_b64_tr_b16 v[78:79], v28 offset:6144
    ds_read_b64_tr_b16 v[80:81], v29 offset:0
    ds_read_b64_tr_b16 v[82:83], v29 offset:2048
    ds_read_b64_tr_b16 v[84:85], v29 offset:4096
    ds_read_b64_tr_b16 v[86:87], v29 offset:6144
    ds_read_b64_tr_b16 v[88:89], v30 offset:0
    ds_read_b64_tr_b16 v[90:91], v30 offset:2048
    ds_read_b64_tr_b16 v[92:93], v30 offset:4096
    ds_read_b64_tr_b16 v[94:95], v30 offset:6144
    ds_read_b64_tr_b16 v[96:97], v31 offset:0
    ds_read_b64_tr_b16 v[98:99], v31 offset:2048
    ds_read_b64_tr_b16 v[100:101], v31 offset:4096
    ds_read_b64_tr_b16 v[102:103], v31 offset:6144
    s_waitcnt lgkmcnt(8)
    v_mfma_f32_16x16x32_bf16 v[104:107], v[72:75], v[40:43], 0
    v_mfma_f32_16x16x32_bf16 v[104:107], v[76:79], v[44:47], v[104:107]
    v_mfma_f32_16x16x32_bf16 v[108:111], v[80:83], v[40:43], 0
    v_mfma_f32_16x16x32_bf16 v[108:111], v[84:87], v[44:47], v[108:111]
    v_mfma_f32_16x16x32_bf16 v[112:115], v[72:75], v[48:51], 0
    v_mfma_f32_16x16x32_bf16 v[112:115], v[76:79], v[52:55], v[112:115]
    v_mfma_f32_16x16x32_bf16 v[116:119], v[80:83], v[48:51], 0
    v_mfma_f32_16x16x32_bf16 v[116:119], v[84:87], v[52:55], v[116:119]
    v_mfma_f32_16x16x32_bf16 v[120:123], v[72:75], v[56:59], 0
    v_mfma_f32_16x16x32_bf16 v[120:123], v[76:79], v[60:63], v[120:123]
    v_mfma_f32_16x16x32_bf16 v[124:127], v[80:83], v[56:59], 0
    v_mfma_f32_16x16x32_bf16 v[124:127], v[84:87], v[60:63], v[124:127]
    v_mfma_f32_16x16x32_bf16 v[128:131], v[72:75], v[64:67], 0
    v_mfma_f32_16x16x32_bf16 v[128:131], v[76:79], v[68:71], v[128:131]
    v_mfma_f32_16x16x32_bf16 v[132:135], v[80:83], v[64:67], 0
    v_mfma_f32_16x16x32_bf16 v[132:135], v[84:87], v[68:71], v[132:135]
    s_waitcnt lgkmcnt(0)
    v_mfma_f32_16x16x32_bf16 v[136:139], v[88:91], v[40:43], 0
    v_cvt_pk_bf16_f32 v208, v104, v105
    v_cvt_pk_bf16_f32 v209, v106, v107
    v_mfma_f32_16x16x32_bf16 v[136:139], v[92:95], v[44:47], v[136:139]
    v_cvt_pk_bf16_f32 v210, v108, v109
    v_cvt_pk_bf16_f32 v211, v110, v111
    v_mfma_f32_16x16x32_bf16 v[140:143], v[96:99], v[40:43], 0
    ds_write_b128 v32, v[208:211] offset:0
    v_mfma_f32_16x16x32_bf16 v[140:143], v[100:103], v[44:47], v[140:143]
    v_mfma_f32_16x16x32_bf16 v[144:147], v[88:91], v[48:51], 0
    v_cvt_pk_bf16_f32 v212, v112, v113
    v_cvt_pk_bf16_f32 v213, v114, v115
    v_mfma_f32_16x16x32_bf16 v[144:147], v[92:95], v[52:55], v[144:147]
L_pad1:
    s_cbranch_execz L_back
    v_cvt_pk_bf16_f32 v214, v116, v117
    v_cvt_pk_bf16_f32 v215, v118, v119
    v_mfma_f32_16x16x32_bf16 v[148:151], v[96:99], v[48:51], 0
    ds_write_b128 v32, v[212:215] offset:8192
    v_mfma_f32_16x16x32_bf16 v[148:151], v[100:103], v[52:55], v[148:151]
    v_mfma_f32_16x16x32_bf16 v[152:155], v[88:91], v[56:59], 0
    v_cvt_pk_bf16_f32 v216, v120, v121
    v_cvt_pk_bf16_f32 v217, v122, v123
    v_mfma_f32_16x16x32_bf16 v[152:155], v[92:95], v[60:63], v[152:155]
    v_cvt_pk_bf16_f32 v218, v124, v125
    v_cvt_pk_bf16_f32 v219, v126, v127
    v_mfma_f32_16x16x32_bf16 v[156:159], v[96:99], v[56:59], 0
    ds_write_b128 v32, v[216:219] offset:16384
    v_mfma_f32_16x16x32_bf16 v[156:159], v[100:103], v[60:63], v[156:159]
    v_mfma_f32_16x16x32_bf16 v[160:163], v[88:91], v[64:67], 0
    v_cvt_pk_bf16_f32 v220, v128, v129
    v_cvt_pk_bf16_f32 v221, v130, v131
    v_mfma_f32_16x16x32_bf16 v[160:163], v[92:95], v[68:71], v[160:163]
    v_cvt_pk_bf16_f32 v222, v132, v133
    v_cvt_pk_bf16_f32 v223, v134, v135
    v_mfma_f32_16x16x32_bf16 v[164:167], v[96:99], v[64:67], 0
    ds_write_b128 v32, v[220:223] offset:24576
    v_mfma_f32_16x16x32_bf16 v[164:167], v[100:103], v[68:71], v[164:167]
    s_waitcnt vmcnt(0)
    ds_read_b64_tr_b16 v[72:73], v28 offset:8192
    ds_read_b64_tr_b16 v[74:75], v28 offset:10240
    ds_read_b64_tr_b16 v[76:77], v28 offset:12288
    ds_read_b64_tr_b16 v[78:79], v28 offset:14336
    ds_read_b64_tr_b16 v[80:81], v29 offset:8192
    ds_read_b64_tr_b16 v[82:83], v29 offset:10240
    ds_read_b64_tr_b16 v[84:85], v29 offset:12288
    ds_read_b64_tr_b16 v[86:87], v29 offset:14336
    ds_read_b64_tr_b16 v[88:89], v30 offset:8192
    ds_read_b64_tr_b16 v[90:91], v30 offset:10240
    ds_read_b64_tr_b16 v[92:93], v30 offset:12288
    ds_read_b64_tr_b16 v[94:95], v30 offset:14336
    ds_read_b64_tr_b16 v[96:97], v31 offset:8192
    ds_read_b64_tr_b16 v[98:99], v31 offset:10240
    ds_read_b64_tr_b16 v[100:101], v31 offset:12288
    ds_read_b64_tr_b16 v[102:103], v31 offset:14336
    v_cvt_pk_bf16_f32 v224, v136, v137
    v_cvt_pk_bf16_f32 v225, v138, v139
    v_cvt_pk_bf16_f32 v226, v140, v141
    v_cvt_pk_bf16_f32 v227, v142, v143
    v_cvt_pk_bf16_f32 v228, v144, v145
    v_cvt_pk_bf16_f32 v229, v146, v147
    v_cvt_pk_bf16_f32 v230, v148, v149
    v_cvt_pk_bf16_f32 v231, v150, v151
    v_cvt_pk_bf16_f32 v232, v152, v153
    v_cvt_pk_bf16_f32 v233, v154, v155
    v_cvt_pk_bf16_f32 v234, v156, v157
    v_cvt_pk_bf16_f32 v235, v158, v159
    v_cvt_pk_bf16_f32 v236, v160, v161
    v_cvt_pk_bf16_f32 v237, v162, v163
    v_cvt_pk_bf16_f32 v238, v164, v165
    v_cvt_pk_bf16_f32 v239, v166, v167
    s_waitcnt lgkmcnt(8)
    v_mfma_f32_16x16x32_bf16 v[104:107], v[72:75], v[40:43], 0
    s_mov_b32 m0, s65
    v_mfma_f32_16x16x32_bf16 v[104:107], v[76:79], v[44:47], v[104:107]
    buffer_load_dwordx4 v1, s[8:11], s50 offen lds
    v_mfma_f32_16x16x32_bf16 v[108:111], v[80:83], v[40:43], 0
    s_mov_b32 m0, s66
    v_mfma_f32_16x16x32_bf16 v[108:111], v[84:87], v[44:47], v[108:111]
    buffer_load_dwordx4 v1, s[8:11], s51 offen lds
    v_mfma_f32_16x16x32_bf16 v[112:115], v[72:75], v[48:51], 0
    s_mov_b32 m0, s67
    v_mfma_f32_16x16x32_bf16 v[112:115], v[76:79], v[52:55], v[112:115]
    buffer_load_dwordx4 v1, s[8:11], s52 offen lds
    v_mfma_f32_16x16x32_bf16 v[116:119], v[80:83], v[48:51], 0
    s_mov_b32 m0, s68
    v_mfma_f32_16x16x32_bf16 v[116:119], v[84:87], v[52:55], v[116:119]
    buffer_load_dwordx4 v1, s[8:11], s53 offen lds
    v_mfma_f32_16x16x32_bf16 v[120:123], v[72:75], v[56:59], 0
    s_mov_b32 m0, s69
    v_mfma_f32_16x16x32_bf16 v[120:123], v[76:79], v[60:63], v[120:123]
    buffer_load_dwordx4 v1, s[8:11], s54 offen lds
    v_mfma_f32_16x16x32_bf16 v[124:127], v[80:83], v[56:59], 0
    s_mov_b32 m0, s70
    v_mfma_f32_16x16x32_bf16 v[124:127], v[84:87], v[60:63], v[124:127]
    buffer_load_dwordx4 v1, s[8:11], s55 offen lds
    v_mfma_f32_16x16x32_bf16 v[128:131], v[72:75], v[64:67], 0
    v_mfma_f32_16x16x32_bf16 v[128:131], v[76:79], v[68:71], v[128:131]
    v_mfma_f32_16x16x32_bf16 v[132:135], v[80:83], v[64:67], 0
    v_mfma_f32_16x16x32_bf16 v[132:135], v[84:87], v[68:71], v[132:135]
    s_waitcnt lgkmcnt(0)
    v_mfma_f32_16x16x32_bf16 v[136:139], v[88:91], v[40:43], 0
    v_cvt_pk_bf16_f32 v208, v104, v105
    v_cvt_pk_bf16_f32 v209, v106, v107
    s_mov_b32 m0, s71
    v_mfma_f32_16x16x32_bf16 v[136:139], v[92:95], v[44:47], v[136:139]
    buffer_load_dwordx4 v1, s[8:11], s56 offen lds
    v_cvt_pk_bf16_f32 v210, v108, v109
    v_cvt_pk_bf16_f32 v211, v110, v111
    v_mfma_f32_16x16x32_bf16 v[140:143], v[96:99], v[40:43], 0
    ds_write_b128 v33, v[208:211] offset:0
    s_mov_b32 m0, s72
    v_mfma_f32_16x16x32_bf16 v[140:143], v[100:103], v[44:47], v[140:143]
    buffer_load_dwordx4 v1, s[8:11], s57 offen lds
    v_mfma_f32_16x16x32_bf16 v[144:147], v[88:91], v[48:51], 0
    v_cvt_pk_bf16_f32 v212, v112, v113
    v_cvt_pk_bf16_f32 v213, v114, v115
    s_mov_b32 m0, s73
    v_mfma_f32_16x16x32_bf16 v[144:147], v[92:95], v[52:55], v[144:147]
    buffer_load_dwordx4 v1, s[8:11], s58 offen lds
    v_cvt_pk_bf16_f32 v214, v116, v117
    v_cvt_pk_bf16_f32 v215, v118, v119
    v_mfma_f32_16x16x32_bf16 v[148:151], v[96:99], v[48:51], 0
    ds_write_b128 v33, v[212:215] offset:8192
    s_mov_b32 m0, s74
    v_mfma_f32_16x16x32_bf16 v[148:151], v[100:103], v[52:55], v[148:151]
    buffer_load_dwordx4 v1, s[8:11], s59 offen lds
    v_mfma_f32_16x16x32_bf16 v[152:155], v[88:91], v[56:59], 0
    v_cvt_pk_bf16_f32 v216, v120, v121
    v_cvt_pk_bf16_f32 v217, v122, v123
    s_mov_b32 m0, s75
    v_mfma_f32_16x16x32_bf16 v[152:155], v[92:95], v[60:63], v[152:155]
    buffer_load_dwordx4 v1, s[8:11], s60 offen lds
    v_cvt_pk_bf16_f32 v218, v124, v125
    v_cvt_pk_bf16_f32 v219, v126, v127
    v_mfma_f32_16x16x32_bf16 v[156:159], v[96:99], v[56:59], 0
    ds_write_b128 v33, v[216:219] offset:16384
    s_mov_b32 m0, s76
    v_mfma_f32_16x16x32_bf16 v[156:159], v[100:103], v[60:63], v[156:159]
    buffer_load_dwordx4 v1, s[8:11], s61 offen lds
    v_mfma_f32_16x16x32_bf16 v[160:163], v[88:91], v[64:67], 0
    v_cvt_pk_bf16_f32 v220, v128, v129
    v_cvt_pk_bf16_f32 v221, v130, v131
    v_mfma_f32_16x16x32_bf16 v[160:163], v[92:95], v[68:71], v[160:163]
    v_cvt_pk_bf16_f32 v222, v132, v133
    v_cvt_pk_bf16_f32 v223, v134, v135
    v_mfma_f32_16x16x32_bf16 v[164:167], v[96:99], v[64:67], 0
    ds_write_b128 v33, v[220:223] offset:24576
    v_mfma_f32_16x16x32_bf16 v[164:167], v[100:103], v[68:71], v[164:167]
    v_add_u32 v32, 61920, v32
    v_add_u32 v33, 61920, v33
    s_waitcnt lgkmcnt(0)
    s_barrier
    ds_read_b128 v[176:179], v36 offset:0
    ds_read_b128 v[180:183], v37 offset:1024
    ds_read_b128 v[184:187], v38 offset:2048
    ds_read_b128 v[188:191], v39 offset:3072
    ds_read_b128 v[192:195], v36 offset:4096
    ds_read_b128 v[196:199], v37 offset:5120
    ds_read_b128 v[200:203], v38 offset:6144
    ds_read_b128 v[204:207], v39 offset:7168
    ds_write_b128 v32, v[224:227] offset:0
    v_cvt_pk_bf16_f32 v208, v136, v137
    v_cvt_pk_bf16_f32 v209, v138, v139
    v_cvt_pk_bf16_f32 v210, v140, v141
    v_cvt_pk_bf16_f32 v211, v142, v143
    s_waitcnt lgkmcnt(8)
    s_add_u32 s37, s28, 0
    buffer_store_dwordx4 v[176:179], v17, s[12:15], s37 offen sc1
    ds_write_b128 v32, v[228:231] offset:8192
    v_cvt_pk_bf16_f32 v212, v144, v145
    v_cvt_pk_bf16_f32 v213, v146, v147
    v_cvt_pk_bf16_f32 v214, v148, v149
    v_cvt_pk_bf16_f32 v215, v150, v151
    s_waitcnt lgkmcnt(8)
    s_add_u32 s37, s31, 327680
    buffer_store_dwordx4 v[180:183], v17, s[12:15], s37 offen sc1
    ds_write_b128 v32, v[232:235] offset:16384
    v_cvt_pk_bf16_f32 v216, v152, v153
    v_cvt_pk_bf16_f32 v217, v154, v155
    v_cvt_pk_bf16_f32 v218, v156, v157
    v_cvt_pk_bf16_f32 v219, v158, v159
    s_waitcnt lgkmcnt(8)
    s_add_u32 s37, s28, 655360
    buffer_store_dwordx4 v[184:187], v17, s[12:15], s37 offen sc1
    ds_write_b128 v32, v[236:239] offset:24576
    v_cvt_pk_bf16_f32 v220, v160, v161
    v_cvt_pk_bf16_f32 v221, v162, v163
    v_cvt_pk_bf16_f32 v222, v164, v165
    v_cvt_pk_bf16_f32 v223, v166, v167
    s_waitcnt lgkmcnt(8)
    s_add_u32 s37, s31, 983040
    buffer_store_dwordx4 v[188:191], v17, s[12:15], s37 offen sc1
    ds_write_b128 v33, v[208:211] offset:0
    s_waitcnt lgkmcnt(8)
    s_add_u32 s37, s28, 1310720
    buffer_store_dwordx4 v[192:195], v17, s[12:15], s37 offen sc1
    ds_write_b128 v33, v[212:215] offset:8192
    s_waitcnt lgkmcnt(8)
    s_add_u32 s37, s31, 1638400
    buffer_store_dwordx4 v[196:199], v17, s[12:15], s37 offen sc1
    ds_write_b128 v33, v[216:219] offset:16384
    s_waitcnt lgkmcnt(8)
    s_add_u32 s37, s28, 1966080
    buffer_store_dwordx4 v[200:203], v17, s[12:15], s37 offen sc1
    ds_write_b128 v33, v[220:223] offset:24576
    s_waitcnt lgkmcnt(8)
    s_add_u32 s37, s31, 2293760
    buffer_store_dwordx4 v[204:207], v17, s[12:15], s37 offen sc1
    v_add_u32 v36, 61920, v36
    v_add_u32 v37, 61920, v37
    v_add_u32 v38, 61920, v38
    v_add_u32 v39, 61920, v39
    s_waitcnt lgkmcnt(0)
    s_barrier
    ds_read_b128 v[176:179], v36 offset:0
    ds_read_b128 v[180:183], v37 offset:1024
    ds_read_b128 v[184:187], v38 offset:2048
    ds_read_b128 v[188:191], v39 offset:3072
    ds_read_b128 v[192:195], v36 offset:4096
    ds_read_b128 v[196:199], v37 offset:5120
    ds_read_b128 v[200:203], v38 offset:6144
    ds_read_b128 v[204:207], v39 offset:7168
    s_waitcnt lgkmcnt(7)
    s_add_u32 s37, s28, 10240
    buffer_store_dwordx4 v[176:179], v17, s[12:15], s37 offen sc1
    s_mul_i32 s48, s35, 0
    s_lshl_b32 s44, s48, 11
    s_add_u32 s48, s48, 1
    s_cmp_eq_u32 s48, 5
    s_cselect_b32 s48, 0, s48
    s_lshl_b32 s45, s48, 11
    s_add_u32 s48, s48, 1
    s_cmp_eq_u32 s48, 5
    s_cselect_b32 s48, 0, s48
    s_lshl_b32 s46, s48, 11
    s_add_u32 s48, s48, 1
    s_cmp_eq_u32 s48, 5
    s_cselect_b32 s48, 0, s48
    s_lshl_b32 s47, s48, 11
    s_add_u32 s48, s48, 1
    s_cmp_eq_u32 s48, 5
    s_cselect_b32 s48, 0, s48
    s_lshl_b32 s48, s48, 11
    s_mul_i32 s38, s32, 655360
    s_mul_i32 s39, s36, 163840
    s_add_u32 s38, s38, s39
    s_add_u32 s38, s38, 30720
    v_lshlrev_b32 v2, 4, v0
    v_add_u32 v2, s38, v2
    v_bfe_u32 v13, v0, 3, 1
    v_lshrrev_b32 v12, 5, v0
    v_xor_b32 v12, v12, v13
    v_bfe_u32 v14, v0, 4, 1
    v_lshl_add_u32 v12, v12, 1, v14
    v_bfe_u32 v14, v0, 2, 1
    v_lshl_add_u32 v12, v12, 1, v14
    v_mul_u32_u24 v3, 4128, v12
    v_lshl_add_u32 v3, v13, 9, v3
    v_and_b32 v13, 3, v0
    v_lshl_add_u32 v3, v13, 3, v3
    s_lshl_b32 s38, s36, 5
    v_add_u32 v3, s38, v3
    v_add_u32 v4, 33024, v3
    v_cmp_eq_u32 vcc, 7, v12
    s_lshl_b32 s38, s36, 12
    s_add_u32 s38, s38, 123840
    v_cndmask_b32 v4, v4, v3, vcc
    v_lshlrev_b32 v5, 4, v0
    v_add_u32 v5, s38, v5
    s_lshr_b32 s38, s36, 1
    s_lshl_b32 s38, s38, 11
    s_add_u32 s38, s38, 123840
    v_lshlrev_b32 v6, 4, v0
    s_waitcnt lgkmcnt(6)
    s_add_u32 s37, s31, 337920
    buffer_store_dwordx4 v[180:183], v17, s[12:15], s37 offen sc1
    v_add_u32 v6, s38, v6
    s_and_b32 s38, s36, 2
    v_lshrrev_b32 v13, 4, v0
    v_xor_b32 v13, s38, v13
    v_mul_u32_u24 v7, 541696, v13
    v_and_b32 v13, 15, v0
    v_lshl_add_u32 v7, v13, 4, v7
    s_lshl_b32 s38, s29, 8
    v_lshlrev_b32 v8, 11, v0
    v_add_u32 v8, s38, v8
    s_lshl_b32 s38, s29, 11
    v_lshlrev_b32 v9, 8, v0
    v_add_u32 v9, s38, v9
    v_mov_b32 v11, 1
    v_lshrrev_b32 v12, 3, v0
    v_add_u32 v12, s36, v12
    v_lshl_add_u32 v9, v12, 20, v9
    v_and_b32 v12, 2, v0
    s_lshl_b32 s38, s32, 2
    s_add_u32 s38, s38, 1
    v_add_u32 v12, s38, v12
    v_cvt_f32_u32 v12, v12
    v_mul_f32 v12, 0x3c000000, v12
    v_and_b32 v13, 1, v0
    v_cvt_f32_u32 v13, v13
    v_mul_f32 v13, 0x3e800000, v13
    v_bfe_u32 v14, v0, 4, 1
    v_bfe_u32 v15, v0, 2, 1
    v_xor_b32 v14, v14, v15
    v_lshlrev_b32 v15, 2, v14
    v_cvt_f32_u32 v15, v15
    v_fma_f32 v13, v15, v12, v13
    s_cmp_lt_u32 s33, 8
    s_cselect_b32 s38, 0x40000000, 1.0
    s_mov_b32 s39, 0x00000000
    v_fma_f32 v104, v12, s39, v13
    v_cos_f32 v104, v104
    s_mov_b32 s39, 0x3f800000
    v_fma_f32 v105, v12, s39, v13
    v_cos_f32 v105, v105
    s_mov_b32 s39, 0x41000000
    v_fma_f32 v106, v12, s39, v13
    v_cos_f32 v106, v106
    s_mov_b32 s39, 0x41100000
    v_fma_f32 v107, v12, s39, v13
    v_cos_f32 v107, v107
    s_mov_b32 s39, 0x40000000
    v_fma_f32 v108, v12, s39, v13
    s_waitcnt lgkmcnt(5)
    s_add_u32 s37, s28, 665600
    buffer_store_dwordx4 v[184:187], v17, s[12:15], s37 offen sc1
    v_cos_f32 v108, v108
    s_mov_b32 s39, 0x40400000
    v_fma_f32 v109, v12, s39, v13
    v_cos_f32 v109, v109
    s_mov_b32 s39, 0x41200000
    v_fma_f32 v110, v12, s39, v13
    v_cos_f32 v110, v110
    s_mov_b32 s39, 0x41300000
    v_fma_f32 v111, v12, s39, v13
    v_cos_f32 v111, v111
    v_mul_f32 v104, s38, v104
    v_mul_f32 v105, s38, v105
    v_mul_f32 v106, s38, v106
    v_mul_f32 v107, s38, v107
    v_mul_f32 v108, s38, v108
    v_mul_f32 v109, s38, v109
    v_mul_f32 v110, s38, v110
    v_mul_f32 v111, s38, v111
    v_cmp_eq_u32 vcc, 0, v14
    s_nop 1
    v_cndmask_b32 v111, 0, v111, vcc
    v_cvt_pk_bf16_f32 v136, v104, v105
    v_cvt_pk_bf16_f32 v137, v106, v107
    v_cvt_pk_bf16_f32 v138, v108, v109
    v_cvt_pk_bf16_f32 v139, v110, v111
    v_bfe_u32 v12, v0, 3, 1
    v_lshrrev_b32 v13, 5, v0
    v_sub_u32 v12, v12, v13
    v_cmp_eq_u32 vcc, 0, v12
    s_nop 1
    v_cndmask_b32 v112, 0, v136, vcc
    v_cndmask_b32 v113, 0, v137, vcc
    v_cndmask_b32 v114, 0, v138, vcc
    v_cndmask_b32 v115, 0, v139, vcc
    v_accvgpr_write_b32 a128, v112
    v_accvgpr_write_b32 a129, v113
    v_accvgpr_write_b32 a130, v114
    v_accvgpr_write_b32 a131, v115
    s_mov_b32 s80, 0x80008000
    s_add_u32 s4, s26, 12582912
    s_addc_u32 s5, s27, 0
    s_mov_b32 s6, 524288
    s_mov_b32 s7, 0x20000
    s_lshr_b32 s94, s2, 3
    s_and_b32 s38, s94, 7
    s_lshl_b32 s94, s94, 12
    s_lshl_b32 s38, s38, 2
    s_lshr_b32 s38, 0x76542310, s38
    s_and_b32 s38, s38, 7
    s_mov_b32 s96, s38
    s_bfe_u32 s39, s2, 0x10006
    s_bfe_u32 s96, s29, 0x10001
    s_xor_b32 s39, s39, s96
    s_lshl_b32 s39, s39, 2
    s_bfe_u32 s96, s2, 0x20003
    s_add_u32 s39, s39, s96
    s_lshl_b32 s39, s39, 2
    s_lshr_b32 s39, 0x75206431, s39
    s_and_b32 s39, s39, 7
    s_cmp_ge_u32 s2, 128
    s_cselect_b32 s38, s39, s38
    s_bfe_u32 s39, s2, 0x10005
    s_add_u32 s39, s39, 2
    s_lshr_b32 s96, s2, 6
    s_cmp_ge_u32 s2, 128
    s_cselect_b32 s96, s39, s96
    s_lshl_b32 s96, s96, 3
    s_add_u32 s96, s96, s38
    s_mul_i32 s39, s38, 41
    s_lshr_b32 s39, s39, 6
    s_lshl_b32 s38, s38, 5
    s_mul_i32 s39, s39, 50
    s_sub_u32 s89, s38, s39
    v_mov_b32 v240, s36
    s_waitcnt lgkmcnt(4)
    s_add_u32 s37, s31, 993280
    buffer_store_dwordx4 v[188:191], v17, s[12:15], s37 offen sc1
    v_lshlrev_b32 v251, 4, v0
    v_lshl_add_u32 v250, v240, 10, v251
    v_lshl_add_u32 v248, v240, 17, v251
    v_lshrrev_b32 v241, 4, v0
    v_lshlrev_b32 v249, 11, v241
    v_lshl_add_u32 v249, v240, 13, v249
    v_lshlrev_b32 v241, 2, v241
    v_and_b32 v242, 15, v0
    v_xor_b32 v241, v241, v242
    v_lshl_add_u32 v249, v241, 4, v249
    v_bfe_u32 v241, v0, 3, 1
    v_bfe_u32 v242, v0, 4, 1
    v_lshl_add_u32 v241, v241, 1, v242
    v_xor_b32 v242, v240, v241
    v_lshlrev_b32 v253, 8, v241
    v_lshl_add_u32 v253, v242, 6, v253
    v_and_b32 v241, 3, v0
    v_lshl_add_u32 v253, v241, 4, v253
    v_bfe_u32 v241, v0, 2, 1
    v_lshl_add_u32 v253, v241, 3, v253
    v_lshrrev_b32 v241, 5, v0
    v_lshl_add_u32 v253, v241, 11, v253
    v_add_u32 v253, 32768, v253
    s_waitcnt lgkmcnt(3)
    s_add_u32 s37, s28, 1320960
    buffer_store_dwordx4 v[192:195], v17, s[12:15], s37 offen sc1
    v_lshlrev_b32 v252, 13, v241
    v_bfe_u32 v242, v0, 4, 1
    v_lshl_add_u32 v252, v242, 11, v252
    v_and_b32 v242, 15, v0
    v_lshl_add_u32 v252, v242, 4, v252
    v_lshl_add_u32 v252, v240, 8, v252
    v_and_b32 v242, 31, v0
    v_lshrrev_b32 v243, 4, v0
    v_and_b32 v244, 15, v0
    v_lshlrev_b32 v244, 4, v244
    v_lshl_add_u32 v251, v243, 9, v244
    v_lshl_add_u32 v252, v243, 13, v244
    v_lshl_add_u32 v252, v240, 8, v252
    v_add_u32 v242, s89, v242
    v_cmp_gt_u32 vcc, 50, v242
    v_subrev_u32 v243, 50, v242
    v_cvt_f32_u32 v244, v241
    v_cndmask_b32 v242, v243, v242, vcc
    v_cvt_f32_u32 v243, v242
    v_mul_f32 v244, 0x41000000, v244
    v_add_f32 v243, 0x41600000, v243
    v_mul_f32 v243, 0x3c000000, v243
    v_mov_b32 v245, 0x3e800000
    v_mov_b32 v247, 0
    v_add_f32 v246, 0x3f800000, v244
    v_mul_f32 v152, v246, v243
    v_fma_f32 v153, v246, v243, v245
    v_add_f32 v246, 0x40400000, v244
    v_mul_f32 v154, v246, v243
    v_fma_f32 v155, v246, v243, v245
    v_add_f32 v246, 0x40a00000, v244
    v_mul_f32 v156, v246, v243
    v_fma_f32 v157, v246, v243, v245
    v_add_f32 v246, 0x40e00000, v244
    v_mul_f32 v158, v246, v243
    v_fma_f32 v159, v246, v243, v245
    v_cos_f32 v152, v152
    v_cos_f32 v153, v153
    v_cos_f32 v154, v154
    v_cos_f32 v155, v155
    v_cos_f32 v156, v156
    v_cos_f32 v157, v157
    v_cos_f32 v158, v158
    v_cos_f32 v159, v159
    v_mul_f32 v152, 0xbd38aa3b, v152
    v_mul_f32 v153, 0xbd38aa3b, v153
    v_mul_f32 v154, 0xbd38aa3b, v154
    v_mul_f32 v155, 0xbd38aa3b, v155
    s_waitcnt lgkmcnt(2)
    s_add_u32 s37, s31, 1648640
    buffer_store_dwordx4 v[196:199], v17, s[12:15], s37 offen sc1
    v_mul_f32 v156, 0xbd38aa3b, v156
    v_mul_f32 v157, 0xbd38aa3b, v157
    v_mul_f32 v158, 0xbd38aa3b, v158
    v_mul_f32 v159, 0xbd38aa3b, v159
    v_cvt_pk_bf16_f32 v152, v152, v153
    v_cvt_pk_bf16_f32 v153, v154, v155
    v_cvt_pk_bf16_f32 v154, v156, v157
    v_cvt_pk_bf16_f32 v155, v158, v159
    v_cndmask_b32 v156, 0, v152, vcc
    v_cndmask_b32 v152, v152, v247, vcc
    v_cndmask_b32 v157, 0, v153, vcc
    v_cndmask_b32 v153, v153, v247, vcc
    v_cndmask_b32 v158, 0, v154, vcc
    v_cndmask_b32 v154, v154, v247, vcc
    v_cndmask_b32 v159, 0, v155, vcc
    v_cndmask_b32 v155, v155, v247, vcc
    v_accvgpr_write_b32 a216, v156
    v_accvgpr_write_b32 a232, v152
    v_accvgpr_write_b32 a217, v157
    v_accvgpr_write_b32 a233, v153
    v_accvgpr_write_b32 a218, v158
    v_accvgpr_write_b32 a234, v154
    v_accvgpr_write_b32 a219, v159
    v_accvgpr_write_b32 a235, v155
    v_add_f32 v246, 0x41880000, v244
    v_mul_f32 v152, v246, v243
    v_fma_f32 v153, v246, v243, v245
    v_add_f32 v246, 0x41980000, v244
    v_mul_f32 v154, v246, v243
    v_fma_f32 v155, v246, v243, v245
    v_add_f32 v246, 0x41a80000, v244
    v_mul_f32 v156, v246, v243
    v_fma_f32 v157, v246, v243, v245
    v_add_f32 v246, 0x41b80000, v244
    v_mul_f32 v158, v246, v243
    v_fma_f32 v159, v246, v243, v245
    v_cos_f32 v152, v152
    v_cos_f32 v153, v153
    v_cos_f32 v154, v154
    v_cos_f32 v155, v155
    v_cos_f32 v156, v156
    v_cos_f32 v157, v157
    v_cos_f32 v158, v158
    v_cos_f32 v159, v159
    v_mul_f32 v152, 0xbd38aa3b, v152
    v_mul_f32 v153, 0xbd38aa3b, v153
    v_mul_f32 v154, 0xbd38aa3b, v154
    v_mul_f32 v155, 0xbd38aa3b, v155
    v_mul_f32 v156, 0xbd38aa3b, v156
    s_waitcnt lgkmcnt(1)
    s_add_u32 s37, s28, 1976320
    buffer_store_dwordx4 v[200:203], v17, s[12:15], s37 offen sc1
    v_mul_f32 v157, 0xbd38aa3b, v157
    v_mul_f32 v158, 0xbd38aa3b, v158
    v_mul_f32 v159, 0xbd38aa3b, v159
    v_cvt_pk_bf16_f32 v152, v152, v153
    v_cvt_pk_bf16_f32 v153, v154, v155
    v_cvt_pk_bf16_f32 v154, v156, v157
    v_cvt_pk_bf16_f32 v155, v158, v159
    v_cndmask_b32 v156, 0, v152, vcc
    v_cndmask_b32 v152, v152, v247, vcc
    v_cndmask_b32 v157, 0, v153, vcc
    v_cndmask_b32 v153, v153, v247, vcc
    v_cndmask_b32 v158, 0, v154, vcc
    v_cndmask_b32 v154, v154, v247, vcc
    v_cndmask_b32 v159, 0, v155, vcc
    v_cndmask_b32 v155, v155, v247, vcc
    v_accvgpr_write_b32 a220, v156
    v_accvgpr_write_b32 a236, v152
    v_accvgpr_write_b32 a221, v157
    v_accvgpr_write_b32 a237, v153
    v_accvgpr_write_b32 a222, v158
    v_accvgpr_write_b32 a238, v154
    v_accvgpr_write_b32 a223, v159
    v_accvgpr_write_b32 a239, v155
    v_add_f32 v246, 0x42040000, v244
    v_mul_f32 v152, v246, v243
    v_fma_f32 v153, v246, v243, v245
    v_add_f32 v246, 0x420c0000, v244
    v_mul_f32 v154, v246, v243
    v_fma_f32 v155, v246, v243, v245
    v_add_f32 v246, 0x42140000, v244
    v_mul_f32 v156, v246, v243
    v_fma_f32 v157, v246, v243, v245
    v_add_f32 v246, 0x421c0000, v244
    v_mul_f32 v158, v246, v243
    v_fma_f32 v159, v246, v243, v245
    v_cos_f32 v152, v152
    v_cos_f32 v153, v153
    v_cos_f32 v154, v154
    v_cos_f32 v155, v155
    v_cos_f32 v156, v156
    v_cos_f32 v157, v157
    v_cos_f32 v158, v158
    v_cos_f32 v159, v159
    v_mul_f32 v152, 0xbd38aa3b, v152
    v_mul_f32 v153, 0xbd38aa3b, v153
    v_mul_f32 v154, 0xbd38aa3b, v154
    v_mul_f32 v155, 0xbd38aa3b, v155
    v_mul_f32 v156, 0xbd38aa3b, v156
    s_waitcnt lgkmcnt(0)
    s_add_u32 s37, s31, 2304000
    buffer_store_dwordx4 v[204:207], v17, s[12:15], s37 offen sc1
    v_mul_f32 v157, 0xbd38aa3b, v157
    v_mul_f32 v158, 0xbd38aa3b, v158
    v_mul_f32 v159, 0xbd38aa3b, v159
    v_cvt_pk_bf16_f32 v152, v152, v153
    v_cvt_pk_bf16_f32 v153, v154, v155
    v_cvt_pk_bf16_f32 v154, v156, v157
    v_cvt_pk_bf16_f32 v155, v158, v159
    v_cndmask_b32 v156, 0, v152, vcc
    v_cndmask_b32 v152, v152, v247, vcc
    v_cndmask_b32 v157, 0, v153, vcc
    v_cndmask_b32 v153, v153, v247, vcc
    v_cndmask_b32 v158, 0, v154, vcc
    v_cndmask_b32 v154, v154, v247, vcc
    v_cndmask_b32 v159, 0, v155, vcc
    v_cndmask_b32 v155, v155, v247, vcc
    v_accvgpr_write_b32 a224, v156
    v_accvgpr_write_b32 a240, v152
    v_accvgpr_write_b32 a225, v157
    v_accvgpr_write_b32 a241, v153
    v_accvgpr_write_b32 a226, v158
    v_accvgpr_write_b32 a242, v154
    v_accvgpr_write_b32 a227, v159
    v_accvgpr_write_b32 a243, v155
    v_add_f32 v246, 0x42440000, v244
    v_mul_f32 v152, v246, v243
    v_fma_f32 v153, v246, v243, v245
    v_add_f32 v246, 0x424c0000, v244
    v_mul_f32 v154, v246, v243
    v_fma_f32 v155, v246, v243, v245
    v_add_f32 v246, 0x42540000, v244
    v_mul_f32 v156, v246, v243
    v_fma_f32 v157, v246, v243, v245
    v_add_f32 v246, 0x425c0000, v244
    v_mul_f32 v158, v246, v243
    v_fma_f32 v159, v246, v243, v245
    v_cos_f32 v152, v152
    v_cos_f32 v153, v153
    v_cos_f32 v154, v154
    v_cos_f32 v155, v155
    v_cos_f32 v156, v156
    v_cos_f32 v157, v157
    v_cos_f32 v158, v158
    v_cos_f32 v159, v159
    v_mul_f32 v152, 0xbd38aa3b, v152
    v_mul_f32 v153, 0xbd38aa3b, v153
    v_mul_f32 v154, 0xbd38aa3b, v154
    v_mul_f32 v155, 0xbd38aa3b, v155
    v_mul_f32 v156, 0xbd38aa3b, v156
    v_mul_f32 v157, 0xbd38aa3b, v157
    v_mul_f32 v158, 0xbd38aa3b, v158
    v_mul_f32 v159, 0xbd38aa3b, v159
    v_cvt_pk_bf16_f32 v152, v152, v153
    v_cvt_pk_bf16_f32 v153, v154, v155
    v_cvt_pk_bf16_f32 v154, v156, v157
    v_cvt_pk_bf16_f32 v155, v158, v159
    v_cndmask_b32 v156, 0, v152, vcc
    v_cndmask_b32 v152, v152, v247, vcc
    v_cndmask_b32 v157, 0, v153, vcc
    v_cndmask_b32 v153, v153, v247, vcc
    v_cndmask_b32 v158, 0, v154, vcc
    v_cndmask_b32 v154, v154, v247, vcc
    v_cndmask_b32 v159, 0, v155, vcc
    v_cndmask_b32 v155, v155, v247, vcc
    v_accvgpr_write_b32 a228, v156
    v_accvgpr_write_b32 a244, v152
    v_accvgpr_write_b32 a229, v157
    v_accvgpr_write_b32 a245, v153
    v_accvgpr_write_b32 a230, v158
    v_accvgpr_write_b32 a246, v154
    v_accvgpr_write_b32 a231, v159
    v_accvgpr_write_b32 a247, v155
    v_bfe_u32 v12, v0, 2, 1
    v_mul_u32_u24 v12, 0xaaaa, v12
L_pad2:
    s_cbranch_execz L_back
    v_add_u32 v250, 0x4444, v12
    s_and_b32 s38, s29, 1
    s_lshl_b32 s38, s38, 3
    s_add_u32 s38, s38, s34
    s_lshl_b32 s38, s38, 20
    s_lshl_b32 s39, s35, 14
    s_add_u32 s38, s38, s39
    s_lshl_b32 s39, s36, 12
    s_add_u32 s38, s38, s39
    s_lshr_b32 s39, s29, 1
    s_lshl_b32 s39, s39, 9
    s_add_u32 s38, s38, s39
    v_lshrrev_b32 v12, 5, v0
    v_lshlrev_b32 v14, 11, v12
    v_and_b32 v12, 31, v0
    v_lshl_add_u32 v13, v12, 4, v14
    v_add_u32 v14, s38, v13
    v_subrev_u32 v12, 123840, v5
    v_subrev_u32 v15, 123840, v6
L_common2:
    s_mov_b32 s16, s24
    s_mov_b32 s17, s25
    s_mov_b32 s18, 256
    s_mov_b32 s19, 0x20000
    buffer_load_dword v10, off, s[16:19], 0 sc1
    s_mov_b32 m0, s77
    s_nop 0
    buffer_load_dwordx4 v1, s[8:11], s62 offen lds
    s_mov_b32 m0, s78
    s_nop 0
    buffer_load_dwordx4 v1, s[8:11], s63 offen lds
    s_mov_b32 m0, s79
    s_nop 0
    buffer_load_dwordx4 v1, s[8:11], s64 offen lds
    v_add_u32 v1, 0x10000, v1
    s_add_u32 m0, s65, 61920
    s_nop 0
    buffer_load_dwordx4 v1, s[8:11], s50 offen lds
    s_add_u32 m0, s66, 61920
    s_nop 0
    buffer_load_dwordx4 v1, s[8:11], s51 offen lds
    s_add_u32 m0, s67, 61920
    s_nop 0
    buffer_load_dwordx4 v1, s[8:11], s52 offen lds
    s_add_u32 m0, s68, 61920
    s_nop 0
    buffer_load_dwordx4 v1, s[8:11], s53 offen lds
    s_add_u32 m0, s69, 61920
    s_nop 0
    buffer_load_dwordx4 v1, s[8:11], s54 offen lds
    s_add_u32 m0, s70, 61920
    s_nop 0
    buffer_load_dwordx4 v1, s[8:11], s55 offen lds
    s_add_u32 m0, s71, 61920
    s_nop 0
    buffer_load_dwordx4 v1, s[8:11], s56 offen lds
    v_mov_b64 v[176:177], 0
    v_mov_b64 v[178:179], 0
    v_mov_b64 v[180:181], 0
    v_mov_b64 v[182:183], 0
    v_mov_b64 v[184:185], 0
    v_mov_b64 v[186:187], 0
    v_mov_b64 v[188:189], 0
    v_mov_b64 v[190:191], 0
    s_waitcnt vmcnt(7)
    s_barrier
    s_cmp_lg_u32 s36, 0
    s_cbranch_scc1 L_rk1
    s_mov_b32 s38, 0
L_rd1:
    v_readfirstlane_b32 s39, v10
    s_add_u32 s38, s38, 1
    s_cmp_lg_u32 s39, 0
    s_cbranch_scc1 L_rk1
    s_cmp_ge_u32 s38, 200000
    s_cbranch_scc1 L_rk1
    buffer_load_dword v10, off, s[16:19], 0 sc1
    s_waitcnt vmcnt(0)
    s_branch L_rd1
L_rk1:
    s_cmp_lt_u32 s2, 160
    s_cselect_b32 s95, 0, 32768
    s_cselect_b32 s100, 19, 3
    s_lshr_b32 s38, s95, 6
    s_add_u32 s38, s38, 49152
    s_cmp_lt_u32 s2, 160
    s_cselect_b32 s38, s38, 0x100000
    s_cselect_b32 s100, s100, -1
    v_mov_b32 v10, 1
    s_mov_b64 exec, 1
    buffer_atomic_add v10, v9, s[40:43], s38 offen sc0 sc1
    s_mov_b64 exec, -1
    ds_read_b64_tr_b16 a[96:97], v3 offset:0
    ds_read_b64_tr_b16 a[98:99], v4 offset:0
    ds_read_b64_tr_b16 a[100:101], v3 offset:1024
    ds_read_b64_tr_b16 a[102:103], v4 offset:1024
    ds_read_b64_tr_b16 a[104:105], v3 offset:128
    ds_read_b64_tr_b16 a[106:107], v4 offset:128
    ds_read_b64_tr_b16 a[108:109], v3 offset:1152
    ds_read_b64_tr_b16 a[110:111], v4 offset:1152
    ds_read_b64_tr_b16 a[112:113], v3 offset:256
    ds_read_b64_tr_b16 a[114:115], v4 offset:256
    ds_read_b64_tr_b16 a[116:117], v3 offset:1280
    ds_read_b64_tr_b16 a[118:119], v4 offset:1280
    s_waitcnt lgkmcnt(8)
    s_add_u32 m0, s72, 61920
    v_smfmac_f32_16x16x64_bf16 v[176:179], a[128:131], a[96:103], v250
    buffer_load_dwordx4 v1, s[8:11], s57 offen lds
    ds_read_b64_tr_b16 a[120:121], v3 offset:384
    ds_read_b64_tr_b16 a[122:123], v4 offset:384
    ds_read_b64_tr_b16 a[124:125], v3 offset:1408
    ds_read_b64_tr_b16 a[126:127], v4 offset:1408
    s_waitcnt lgkmcnt(8)
    s_add_u32 m0, s73, 61920
    v_smfmac_f32_16x16x64_bf16 v[180:183], a[128:131], a[104:111], v250
    buffer_load_dwordx4 v1, s[8:11], s58 offen lds
    ds_read_b64_tr_b16 a[96:97], v3 offset:2048
    ds_read_b64_tr_b16 a[98:99], v4 offset:2048
    ds_read_b64_tr_b16 a[100:101], v3 offset:3072
    ds_read_b64_tr_b16 a[102:103], v4 offset:3072
    s_waitcnt lgkmcnt(8)
    s_add_u32 m0, s74, 61920
    v_smfmac_f32_16x16x64_bf16 v[184:187], a[128:131], a[112:119], v250
    buffer_load_dwordx4 v1, s[8:11], s59 offen lds
    ds_read_b64_tr_b16 a[104:105], v3 offset:2176
    ds_read_b64_tr_b16 a[106:107], v4 offset:2176
    ds_read_b64_tr_b16 a[108:109], v3 offset:3200
    ds_read_b64_tr_b16 a[110:111], v4 offset:3200
    v_cvt_pk_bf16_f32 v192, v176, v180
    v_cvt_pk_bf16_f32 v196, v177, v181
    v_cvt_pk_bf16_f32 v200, v178, v182
    v_cvt_pk_bf16_f32 v204, v179, v183
    v_mov_b64 v[176:177], 0
    v_mov_b64 v[178:179], 0
    v_mov_b64 v[180:181], 0
    v_mov_b64 v[182:183], 0
    s_waitcnt lgkmcnt(8)
    s_add_u32 m0, s75, 61920
    v_smfmac_f32_16x16x64_bf16 v[188:191], a[128:131], a[120:127], v250
    buffer_load_dwordx4 v1, s[8:11], s60 offen lds
    ds_read_b64_tr_b16 a[112:113], v3 offset:2304
    ds_read_b64_tr_b16 a[114:115], v4 offset:2304
    ds_read_b64_tr_b16 a[116:117], v3 offset:3328
    ds_read_b64_tr_b16 a[118:119], v4 offset:3328
    s_waitcnt lgkmcnt(8)
    s_add_u32 m0, s76, 61920
    v_smfmac_f32_16x16x64_bf16 v[176:179], a[128:131], a[96:103], v250
    buffer_load_dwordx4 v1, s[8:11], s61 offen lds
    ds_read_b64_tr_b16 a[120:121], v3 offset:2432
    ds_read_b64_tr_b16 a[122:123], v4 offset:2432
    ds_read_b64_tr_b16 a[124:125], v3 offset:3456
    ds_read_b64_tr_b16 a[126:127], v4 offset:3456
    v_cvt_pk_bf16_f32 v193, v184, v188
    v_cvt_pk_bf16_f32 v197, v185, v189
    v_cvt_pk_bf16_f32 v201, v186, v190
    v_cvt_pk_bf16_f32 v205, v187, v191
    v_mov_b64 v[184:185], 0
    v_mov_b64 v[186:187], 0
    v_mov_b64 v[188:189], 0
    v_mov_b64 v[190:191], 0
    s_waitcnt lgkmcnt(8)
    s_add_u32 m0, s77, 61920
    v_smfmac_f32_16x16x64_bf16 v[180:183], a[128:131], a[104:111], v250
    buffer_load_dwordx4 v1, s[8:11], s62 offen lds
    s_waitcnt lgkmcnt(4)
    s_add_u32 m0, s78, 61920
    v_smfmac_f32_16x16x64_bf16 v[184:187], a[128:131], a[112:119], v250
    buffer_load_dwordx4 v1, s[8:11], s63 offen lds
    s_nop 2
    v_cvt_pk_bf16_f32 v194, v176, v180
    v_cvt_pk_bf16_f32 v198, v177, v181
    v_cvt_pk_bf16_f32 v202, v178, v182
    v_cvt_pk_bf16_f32 v206, v179, v183
    v_mov_b64 v[176:177], 0
    v_mov_b64 v[178:179], 0
    v_mov_b64 v[180:181], 0
    v_mov_b64 v[182:183], 0
    s_waitcnt lgkmcnt(0)
    s_waitcnt vmcnt(7)
    v_readfirstlane_b32 s39, v10
    s_cmp_lg_u32 s36, 0
    s_cbranch_scc1 L_pb2
    s_cmp_lg_u32 s39, s100
    s_cbranch_scc1 L_pb2
    s_mov_b64 exec, 0xff
    buffer_store_dword v11, v8, s[40:43], s95 offen sc1
    s_mov_b64 exec, -1
L_pb2:
    s_barrier
    s_add_u32 m0, s79, 61920
    v_smfmac_f32_16x16x64_bf16 v[188:191], a[128:131], a[120:127], v250
    buffer_load_dwordx4 v1, s[8:11], s64 offen lds
    v_add_u32 v1, 0x10000, v1
    s_mov_b32 m0, s65
    s_nop 0
    buffer_load_dwordx4 v1, s[8:11], s50 offen lds
    s_mov_b32 m0, s66
    s_nop 0
    buffer_load_dwordx4 v1, s[8:11], s51 offen lds
    s_mov_b32 m0, s67
    s_nop 0
    buffer_load_dwordx4 v1, s[8:11], s52 offen lds
    v_cvt_pk_bf16_f32 v195, v184, v188
    v_cvt_pk_bf16_f32 v199, v185, v189
    v_cvt_pk_bf16_f32 v203, v186, v190
    v_cvt_pk_bf16_f32 v207, v187, v191
    s_mov_b32 m0, s68
    s_nop 0
    buffer_load_dwordx4 v1, s[8:11], s53 offen lds
    v_mov_b64 v[184:185], 0
    v_mov_b64 v[186:187], 0
    v_mov_b64 v[188:189], 0
    v_mov_b64 v[190:191], 0
    s_mov_b32 m0, s69
    s_nop 0
    buffer_load_dwordx4 v1, s[8:11], s54 offen lds
    v_accvgpr_write_b32 a136, v192
    v_accvgpr_write_b32 a137, v193
    v_accvgpr_write_b32 a138, v194
    v_accvgpr_write_b32 a139, v195
    s_mov_b32 m0, s70
    s_nop 0
    buffer_load_dwordx4 v1, s[8:11], s55 offen lds
    v_accvgpr_write_b32 a140, v196
    v_accvgpr_write_b32 a141, v197
    v_accvgpr_write_b32 a142, v198
    v_accvgpr_write_b32 a143, v199
    s_mov_b32 m0, s71
    s_nop 0
    buffer_load_dwordx4 v1, s[8:11], s56 offen lds
    v_accvgpr_write_b32 a144, v200
    v_accvgpr_write_b32 a145, v201
    v_accvgpr_write_b32 a146, v202
    v_accvgpr_write_b32 a147, v203
    v_accvgpr_write_b32 a148, v204
    v_accvgpr_write_b32 a149, v205
    v_accvgpr_write_b32 a150, v206
    v_accvgpr_write_b32 a151, v207
    s_waitcnt vmcnt(7)
    s_barrier
    ds_read_b64_tr_b16 a[96:97], v3 offset:61920
    ds_read_b64_tr_b16 a[98:99], v4 offset:61920
    ds_read_b64_tr_b16 a[100:101], v3 offset:62944
    ds_read_b64_tr_b16 a[102:103], v4 offset:62944
    ds_read_b64_tr_b16 a[104:105], v3 offset:62048
    ds_read_b64_tr_b16 a[106:107], v4 offset:62048
    ds_read_b64_tr_b16 a[108:109], v3 offset:63072
    ds_read_b64_tr_b16 a[110:111], v4 offset:63072
    ds_read_b64_tr_b16 a[112:113], v3 offset:62176
    ds_read_b64_tr_b16 a[114:115], v4 offset:62176
    ds_read_b64_tr_b16 a[116:117], v3 offset:63200
    ds_read_b64_tr_b16 a[118:119], v4 offset:63200
    s_mov_b32 m0, s72
    s_nop 0
    buffer_load_dwordx4 v1, s[8:11], s57 offen lds
    s_waitcnt lgkmcnt(8)
    s_mov_b32 m0, s73
    v_smfmac_f32_16x16x64_bf16 v[176:179], a[128:131], a[96:103], v250
    buffer_load_dwordx4 v1, s[8:11], s58 offen lds
    ds_read_b64_tr_b16 a[120:121], v3 offset:62304
    ds_read_b64_tr_b16 a[122:123], v4 offset:62304
    ds_read_b64_tr_b16 a[124:125], v3 offset:63328
    ds_read_b64_tr_b16 a[126:127], v4 offset:63328
    s_waitcnt lgkmcnt(8)
    s_mov_b32 m0, s74
    v_smfmac_f32_16x16x64_bf16 v[180:183], a[128:131], a[104:111], v250
    buffer_load_dwordx4 v1, s[8:11], s59 offen lds
    ds_read_b64_tr_b16 a[96:97], v3 offset:63968
    ds_read_b64_tr_b16 a[98:99], v4 offset:63968
    ds_read_b64_tr_b16 a[100:101], v3 offset:64992
    ds_read_b64_tr_b16 a[102:103], v4 offset:64992
    s_waitcnt lgkmcnt(8)
    s_mov_b32 m0, s75
    v_smfmac_f32_16x16x64_bf16 v[184:187], a[128:131], a[112:119], v250
    buffer_load_dwordx4 v1, s[8:11], s60 offen lds
    ds_read_b64_tr_b16 a[104:105], v3 offset:64096
    ds_read_b64_tr_b16 a[106:107], v4 offset:64096
    ds_read_b64_tr_b16 a[108:109], v3 offset:65120
    ds_read_b64_tr_b16 a[110:111], v4 offset:65120
    v_cvt_pk_bf16_f32 v192, v176, v180
    v_cvt_pk_bf16_f32 v196, v177, v181
    v_cvt_pk_bf16_f32 v200, v178, v182
    v_cvt_pk_bf16_f32 v204, v179, v183
    v_mov_b64 v[176:177], 0
    v_mov_b64 v[178:179], 0
    v_mov_b64 v[180:181], 0
    v_mov_b64 v[182:183], 0
    s_waitcnt lgkmcnt(8)
    s_mov_b32 m0, s76
    v_smfmac_f32_16x16x64_bf16 v[188:191], a[128:131], a[120:127], v250
    buffer_load_dwordx4 v1, s[8:11], s61 offen lds
    ds_read_b64_tr_b16 a[112:113], v3 offset:64224
    ds_read_b64_tr_b16 a[114:115], v4 offset:64224
    ds_read_b64_tr_b16 a[116:117], v3 offset:65248
    ds_read_b64_tr_b16 a[118:119], v4 offset:65248
    s_waitcnt lgkmcnt(8)
    s_mov_b32 m0, s77
    v_smfmac_f32_16x16x64_bf16 v[176:179], a[128:131], a[96:103], v250
    buffer_load_dwordx4 v1, s[8:11], s62 offen lds
    ds_read_b64_tr_b16 a[120:121], v3 offset:64352
    ds_read_b64_tr_b16 a[122:123], v4 offset:64352
    ds_read_b64_tr_b16 a[124:125], v3 offset:65376
    ds_read_b64_tr_b16 a[126:127], v4 offset:65376
    v_cvt_pk_bf16_f32 v193, v184, v188
    v_cvt_pk_bf16_f32 v197, v185, v189
    v_cvt_pk_bf16_f32 v201, v186, v190
    v_cvt_pk_bf16_f32 v205, v187, v191
    v_mov_b64 v[184:185], 0
    v_mov_b64 v[186:187], 0
    v_mov_b64 v[188:189], 0
    v_mov_b64 v[190:191], 0
    s_waitcnt lgkmcnt(8)
    s_mov_b32 m0, s78
    v_smfmac_f32_16x16x64_bf16 v[180:183], a[128:131], a[104:111], v250
    buffer_load_dwordx4 v1, s[8:11], s63 offen lds
    s_waitcnt lgkmcnt(4)
    s_mov_b32 m0, s79
    v_smfmac_f32_16x16x64_bf16 v[184:187], a[128:131], a[112:119], v250
    buffer_load_dwordx4 v1, s[8:11], s64 offen lds
    v_add_u32 v1, 0x10000, v1
    s_nop 1
    v_cvt_pk_bf16_f32 v194, v176, v180
    v_cvt_pk_bf16_f32 v198, v177, v181
    v_cvt_pk_bf16_f32 v202, v178, v182
    v_cvt_pk_bf16_f32 v206, v179, v183
    v_mov_b64 v[176:177], 0
    v_mov_b64 v[178:179], 0
    v_mov_b64 v[180:181], 0
    v_mov_b64 v[182:183], 0
    s_waitcnt lgkmcnt(0)
    s_barrier
    v_smfmac_f32_16x16x64_bf16 v[188:191], a[128:131], a[120:127], v250
    s_and_b32 s38, s2, 0xc2
    s_cmp_lg_u32 s38, 0xc2
    s_cbranch_scc1 L_nowl
    s_bfe_u32 s28, s2, 0x30003
    s_lshl_b32 s28, s28, 2
    s_and_b32 s38, s29, 1
    s_add_u32 s28, s28, s38
    s_lshr_b32 s38, s29, 2
    s_lshl_b32 s38, s38, 1
    s_add_u32 s28, s28, s38
    s_bfe_u32 s31, s28, 0x10001
    s_lshl_b32 s31, s31, 13
    s_lshr_b32 s38, s28, 2
    s_lshl_b32 s38, s38, 16
    s_add_u32 s31, s31, s38
    s_lshl_b32 s38, s36, 8
    s_add_u32 s31, s31, s38
    s_and_b32 s38, s28, 1
    s_lshl_b32 s38, s38, 3
    s_add_u32 s31, s31, s38
    v_lshrrev_b32 v20, 5, v0
    v_lshlrev_b32 v16, 12, v20
    v_and_b32 v20, 15, v0
    v_lshl_add_u32 v16, v20, 4, v16
    v_bfe_u32 v20, v0, 4, 1
    v_lshl_add_u32 v16, v20, 10, v16
    s_mov_b32 s16, s20
    s_mov_b32 s17, s21
    s_mov_b32 s18, 524288
    s_mov_b32 s19, 0x20000
    s_add_u32 s38, s31, 0
    buffer_load_dwordx2 v[72:73], v16, s[16:19], s38 offen offset:0
    s_add_u32 s38, s31, 16384
    buffer_load_dwordx2 v[74:75], v16, s[16:19], s38 offen offset:0
    s_add_u32 s38, s31, 32768
    buffer_load_dwordx2 v[76:77], v16, s[16:19], s38 offen offset:0
    s_add_u32 s38, s31, 49152
    buffer_load_dwordx2 v[78:79], v16, s[16:19], s38 offen offset:0
    s_add_u32 s38, s31, 0
    buffer_load_dwordx2 v[80:81], v16, s[16:19], s38 offen offset:2048
    s_add_u32 s38, s31, 16384
    buffer_load_dwordx2 v[82:83], v16, s[16:19], s38 offen offset:2048
    s_add_u32 s38, s31, 32768
    buffer_load_dwordx2 v[84:85], v16, s[16:19], s38 offen offset:2048
    s_add_u32 s38, s31, 49152
    buffer_load_dwordx2 v[86:87], v16, s[16:19], s38 offen offset:2048
L_nowl:
    s_add_u32 m0, s65, 61920
    s_nop 0
    buffer_load_dwordx4 v1, s[8:11], s50 offen lds
    s_add_u32 m0, s66, 61920
    s_nop 0
    buffer_load_dwordx4 v1, s[8:11], s51 offen lds
    s_add_u32 m0, s67, 61920
    s_nop 0
    buffer_load_dwordx4 v1, s[8:11], s52 offen lds
    v_cvt_pk_bf16_f32 v195, v184, v188
    v_cvt_pk_bf16_f32 v199, v185, v189
    v_cvt_pk_bf16_f32 v203, v186, v190
    v_cvt_pk_bf16_f32 v207, v187, v191
    s_add_u32 m0, s68, 61920
    s_nop 0
    buffer_load_dwordx4 v1, s[8:11], s53 offen lds
    v_mov_b64 v[184:185], 0
    v_mov_b64 v[186:187], 0
    v_mov_b64 v[188:189], 0
    v_mov_b64 v[190:191], 0
    s_add_u32 m0, s69, 61920
    s_nop 0
    buffer_load_dwordx4 v1, s[8:11], s54 offen lds
    v_accvgpr_write_b32 a152, v192
    v_accvgpr_write_b32 a153, v193
    v_accvgpr_write_b32 a154, v194
    v_accvgpr_write_b32 a155, v195
    s_add_u32 m0, s70, 61920
    s_nop 0
    buffer_load_dwordx4 v1, s[8:11], s55 offen lds
    v_accvgpr_write_b32 a156, v196
    v_accvgpr_write_b32 a157, v197
    v_accvgpr_write_b32 a158, v198
    v_accvgpr_write_b32 a159, v199
    s_add_u32 m0, s71, 61920
    s_nop 0
    buffer_load_dwordx4 v1, s[8:11], s56 offen lds
    v_accvgpr_write_b32 a160, v200
    v_accvgpr_write_b32 a161, v201
    v_accvgpr_write_b32 a162, v202
    v_accvgpr_write_b32 a163, v203
    v_accvgpr_write_b32 a164, v204
    v_accvgpr_write_b32 a165, v205
    v_accvgpr_write_b32 a166, v206
    v_accvgpr_write_b32 a167, v207
    s_waitcnt vmcnt(7)
    s_barrier
    ds_read_b64_tr_b16 a[96:97], v3 offset:0
    ds_read_b64_tr_b16 a[98:99], v4 offset:0
    ds_read_b64_tr_b16 a[100:101], v3 offset:1024
    ds_read_b64_tr_b16 a[102:103], v4 offset:1024
    ds_read_b64_tr_b16 a[104:105], v3 offset:128
    ds_read_b64_tr_b16 a[106:107], v4 offset:128
    ds_read_b64_tr_b16 a[108:109], v3 offset:1152
    ds_read_b64_tr_b16 a[110:111], v4 offset:1152
    ds_read_b64_tr_b16 a[112:113], v3 offset:256
    ds_read_b64_tr_b16 a[114:115], v4 offset:256
    ds_read_b64_tr_b16 a[116:117], v3 offset:1280
    ds_read_b64_tr_b16 a[118:119], v4 offset:1280
    s_add_u32 m0, s72, 61920
    s_nop 0
    buffer_load_dwordx4 v1, s[8:11], s57 offen lds
    s_waitcnt lgkmcnt(8)
    s_add_u32 m0, s73, 61920
    v_smfmac_f32_16x16x64_bf16 v[176:179], a[128:131], a[96:103], v250
    buffer_load_dwordx4 v1, s[8:11], s58 offen lds
    ds_read_b64_tr_b16 a[120:121], v3 offset:384
    ds_read_b64_tr_b16 a[122:123], v4 offset:384
    ds_read_b64_tr_b16 a[124:125], v3 offset:1408
    ds_read_b64_tr_b16 a[126:127], v4 offset:1408
    s_waitcnt lgkmcnt(8)
    s_add_u32 m0, s74, 61920
    v_smfmac_f32_16x16x64_bf16 v[180:183], a[128:131], a[104:111], v250
    buffer_load_dwordx4 v1, s[8:11], s59 offen lds
    ds_read_b64_tr_b16 a[96:97], v3 offset:2048
    ds_read_b64_tr_b16 a[98:99], v4 offset:2048
    ds_read_b64_tr_b16 a[100:101], v3 offset:3072
    ds_read_b64_tr_b16 a[102:103], v4 offset:3072
    s_waitcnt lgkmcnt(8)
    s_add_u32 m0, s75, 61920
    v_smfmac_f32_16x16x64_bf16 v[184:187], a[128:131], a[112:119], v250
    buffer_load_dwordx4 v1, s[8:11], s60 offen lds
    ds_read_b64_tr_b16 a[104:105], v3 offset:2176
    ds_read_b64_tr_b16 a[106:107], v4 offset:2176
    ds_read_b64_tr_b16 a[108:109], v3 offset:3200
    ds_read_b64_tr_b16 a[110:111], v4 offset:3200
    v_cvt_pk_bf16_f32 v192, v176, v180
    v_cvt_pk_bf16_f32 v196, v177, v181
    v_cvt_pk_bf16_f32 v200, v178, v182
    v_cvt_pk_bf16_f32 v204, v179, v183
    v_mov_b64 v[176:177], 0
    v_mov_b64 v[178:179], 0
    v_mov_b64 v[180:181], 0
    v_mov_b64 v[182:183], 0
    s_waitcnt lgkmcnt(8)
    s_add_u32 m0, s76, 61920
    v_smfmac_f32_16x16x64_bf16 v[188:191], a[128:131], a[120:127], v250
    buffer_load_dwordx4 v1, s[8:11], s61 offen lds
    ds_read_b64_tr_b16 a[112:113], v3 offset:2304
    ds_read_b64_tr_b16 a[114:115], v4 offset:2304
    ds_read_b64_tr_b16 a[116:117], v3 offset:3328
    ds_read_b64_tr_b16 a[118:119], v4 offset:3328
    s_waitcnt lgkmcnt(8)
    s_add_u32 m0, s77, 61920
    v_smfmac_f32_16x16x64_bf16 v[176:179], a[128:131], a[96:103], v250
    buffer_load_dwordx4 v1, s[8:11], s62 offen lds
    ds_read_b64_tr_b16 a[120:121], v3 offset:2432
    ds_read_b64_tr_b16 a[122:123], v4 offset:2432
    ds_read_b64_tr_b16 a[124:125], v3 offset:3456
    ds_read_b64_tr_b16 a[126:127], v4 offset:3456
    v_cvt_pk_bf16_f32 v193, v184, v188
    v_cvt_pk_bf16_f32 v197, v185, v189
    v_cvt_pk_bf16_f32 v201, v186, v190
    v_cvt_pk_bf16_f32 v205, v187, v191
    v_mov_b64 v[184:185], 0
    v_mov_b64 v[186:187], 0
    v_mov_b64 v[188:189], 0
    v_mov_b64 v[190:191], 0
    s_waitcnt lgkmcnt(8)
    s_add_u32 m0, s78, 61920
    v_smfmac_f32_16x16x64_bf16 v[180:183], a[128:131], a[104:111], v250
    buffer_load_dwordx4 v1, s[8:11], s63 offen lds
    s_waitcnt lgkmcnt(4)
    s_add_u32 m0, s79, 61920
    v_smfmac_f32_16x16x64_bf16 v[184:187], a[128:131], a[112:119], v250
    buffer_load_dwordx4 v1, s[8:11], s64 offen lds
    v_add_u32 v1, 0x10000, v1
    s_nop 1
    v_cvt_pk_bf16_f32 v194, v176, v180
    v_cvt_pk_bf16_f32 v198, v177, v181
    v_cvt_pk_bf16_f32 v202, v178, v182
    v_cvt_pk_bf16_f32 v206, v179, v183
    v_mov_b64 v[176:177], 0
    v_mov_b64 v[178:179], 0
    v_mov_b64 v[180:181], 0
    v_mov_b64 v[182:183], 0
    s_waitcnt lgkmcnt(0)
    s_barrier
    v_smfmac_f32_16x16x64_bf16 v[188:191], a[128:131], a[120:127], v250
    s_mov_b32 s95, 0
    s_mov_b32 s100, 1
    buffer_load_dword v10, v9, s[40:43], s95 offen sc1
    s_mov_b32 m0, s65
    s_nop 0
    buffer_load_dwordx4 v1, s[8:11], s50 offen lds
    s_mov_b32 m0, s66
    s_nop 0
    buffer_load_dwordx4 v1, s[8:11], s51 offen lds
    s_mov_b32 m0, s67
    s_nop 0
    buffer_load_dwordx4 v1, s[8:11], s52 offen lds
    v_cvt_pk_bf16_f32 v195, v184, v188
    v_cvt_pk_bf16_f32 v199, v185, v189
    v_cvt_pk_bf16_f32 v203, v186, v190
    v_cvt_pk_bf16_f32 v207, v187, v191
    s_mov_b32 m0, s68
    s_nop 0
    buffer_load_dwordx4 v1, s[8:11], s53 offen lds
    v_mov_b64 v[184:185], 0
    v_mov_b64 v[186:187], 0
    v_mov_b64 v[188:189], 0
    v_mov_b64 v[190:191], 0
    s_mov_b32 m0, s69
    s_nop 0
    buffer_load_dwordx4 v1, s[8:11], s54 offen lds
    v_accvgpr_write_b32 a168, v192
    v_accvgpr_write_b32 a169, v193
    v_accvgpr_write_b32 a170, v194
    v_accvgpr_write_b32 a171, v195
    s_mov_b32 m0, s70
    s_nop 0
    buffer_load_dwordx4 v1, s[8:11], s55 offen lds
    v_accvgpr_write_b32 a172, v196
    v_accvgpr_write_b32 a173, v197
    v_accvgpr_write_b32 a174, v198
    v_accvgpr_write_b32 a175, v199
    s_mov_b32 m0, s71
    s_nop 0
    buffer_load_dwordx4 v1, s[8:11], s56 offen lds
    v_accvgpr_write_b32 a176, v200
    v_accvgpr_write_b32 a177, v201
    v_accvgpr_write_b32 a178, v202
    v_accvgpr_write_b32 a179, v203
    s_mov_b32 m0, s72
    s_nop 0
    buffer_load_dwordx4 v1, s[8:11], s57 offen lds
    v_accvgpr_write_b32 a180, v204
    v_accvgpr_write_b32 a181, v205
    v_accvgpr_write_b32 a182, v206
    v_accvgpr_write_b32 a183, v207
    s_mov_b32 m0, s73
    s_nop 0
    buffer_load_dwordx4 v1, s[8:11], s58 offen lds
    s_mov_b32 m0, s74
    s_nop 0
    buffer_load_dwordx4 v1, s[8:11], s59 offen lds
    s_mov_b32 m0, s75
    s_nop 0
    buffer_load_dwordx4 v1, s[8:11], s60 offen lds
    s_mov_b32 m0, s76
    s_nop 0
    buffer_load_dwordx4 v1, s[8:11], s61 offen lds
    s_mov_b32 m0, s77
    s_nop 0
    buffer_load_dwordx4 v1, s[8:11], s62 offen lds
    s_mov_b32 m0, s78
    s_nop 0
    buffer_load_dwordx4 v1, s[8:11], s63 offen lds
    s_mov_b32 m0, s79
    s_nop 0
    buffer_load_dwordx4 v1, s[8:11], s64 offen lds
    v_add_u32 v1, 0x10000, v1
    s_waitcnt vmcnt(16)
    s_and_b32 s38, s2, 0xc2
    s_cmp_lg_u32 s38, 0xc2
    s_cbranch_scc1 L_nowo
    v_lshlrev_b32 v17, 4, v0
    s_lshl_b32 s31, s36, 17
    s_lshl_b32 s38, s28, 12
    s_add_u32 s31, s31, s38
    s_lshl_b32 s31, s36, 17
    s_lshr_b32 s38, s28, 2
    s_lshl_b32 s38, s38, 14
    s_add_u32 s31, s31, s38
    s_and_b32 s38, s28, 1
    s_lshl_b32 s38, s38, 13
    s_add_u32 s31, s31, s38
    s_and_b32 s38, s28, 2
    s_lshl_b32 s38, s38, 9
    s_add_u32 s31, s31, s38
    s_mov_b32 s38, 0x05040100
    s_mov_b32 s39, 0x07060302
    v_perm_b32 v104, v74, v72, s38
    v_perm_b32 v105, v78, v76, s38
    v_perm_b32 v106, v82, v80, s38
    v_perm_b32 v107, v86, v84, s38
    buffer_store_dwordx4 v[104:107], v17, s[4:7], s31 offen offset:0 sc1
    v_perm_b32 v108, v74, v72, s39
    v_perm_b32 v109, v78, v76, s39
    v_perm_b32 v110, v82, v80, s39
    v_perm_b32 v111, v86, v84, s39
    buffer_store_dwordx4 v[108:111], v17, s[4:7], s31 offen offset:2048 sc1
    v_perm_b32 v112, v75, v73, s38
    v_perm_b32 v113, v79, v77, s38
    v_perm_b32 v114, v83, v81, s38
    v_perm_b32 v115, v87, v85, s38
    s_add_u32 s31, s31, 4096
    buffer_store_dwordx4 v[112:115], v17, s[4:7], s31 offen offset:0 sc1
    v_perm_b32 v116, v75, v73, s39
    v_perm_b32 v117, v79, v77, s39
    v_perm_b32 v118, v83, v81, s39
    v_perm_b32 v119, v87, v85, s39
    buffer_store_dwordx4 v[116:119], v17, s[4:7], s31 offen offset:2048 sc1
L_nowo:
    s_waitcnt vmcnt(15)
    s_cmp_lg_u32 s36, 0
    s_cbranch_scc1 L_pd3
    s_mov_b32 s39, 0
L_pl3:
    v_cmp_ne_u32 vcc, s100, v10
    s_add_u32 s39, s39, 1
    s_nop 0
    s_and_b32 s38, vcc_lo, 255
    s_cbranch_scc0 L_pd3
    s_cmp_ge_u32 s39, 200000
    s_cbranch_scc1 L_pd3
    buffer_load_dword v10, v9, s[40:43], s95 offen sc1
L_pad3:
    s_cbranch_execz L_back
    s_waitcnt vmcnt(0)
    s_branch L_pl3
L_pd3:
    s_barrier
    buffer_load_dwordx4 a[64:67], v2, s[12:15], s44 offen offset:0 sc1
    buffer_load_dwordx4 v[208:211], v2, s[12:15], s44 offen offset:1024 sc1
    ds_read_b64_tr_b16 a[96:97], v3 offset:61920
    ds_read_b64_tr_b16 a[98:99], v4 offset:61920
    ds_read_b64_tr_b16 a[100:101], v3 offset:62944
    ds_read_b64_tr_b16 a[102:103], v4 offset:62944
    ds_read_b64_tr_b16 a[104:105], v3 offset:62048
    ds_read_b64_tr_b16 a[106:107], v4 offset:62048
    ds_read_b64_tr_b16 a[108:109], v3 offset:63072
    ds_read_b64_tr_b16 a[110:111], v4 offset:63072
    ds_read_b64_tr_b16 a[112:113], v3 offset:62176
    ds_read_b64_tr_b16 a[114:115], v4 offset:62176
    ds_read_b64_tr_b16 a[116:117], v3 offset:63200
    ds_read_b64_tr_b16 a[118:119], v4 offset:63200
    s_waitcnt lgkmcnt(8)
    v_smfmac_f32_16x16x64_bf16 v[176:179], a[128:131], a[96:103], v250
    buffer_load_dwordx4 a[68:71], v2, s[12:15], s45 offen offset:0 sc1
    ds_read_b64_tr_b16 a[120:121], v3 offset:62304
    ds_read_b64_tr_b16 a[122:123], v4 offset:62304
    ds_read_b64_tr_b16 a[124:125], v3 offset:63328
    ds_read_b64_tr_b16 a[126:127], v4 offset:63328
    s_waitcnt lgkmcnt(8)
    v_smfmac_f32_16x16x64_bf16 v[180:183], a[128:131], a[104:111], v250
    buffer_load_dwordx4 v[212:215], v2, s[12:15], s45 offen offset:1024 sc1
    ds_read_b64_tr_b16 a[96:97], v3 offset:63968
    ds_read_b64_tr_b16 a[98:99], v4 offset:63968
    ds_read_b64_tr_b16 a[100:101], v3 offset:64992
    ds_read_b64_tr_b16 a[102:103], v4 offset:64992
    s_waitcnt lgkmcnt(8)
    v_smfmac_f32_16x16x64_bf16 v[184:187], a[128:131], a[112:119], v250
    buffer_load_dwordx4 a[72:75], v2, s[12:15], s46 offen offset:0 sc1
    ds_read_b64_tr_b16 a[104:105], v3 offset:64096
    ds_read_b64_tr_b16 a[106:107], v4 offset:64096
    ds_read_b64_tr_b16 a[108:109], v3 offset:65120
    ds_read_b64_tr_b16 a[110:111], v4 offset:65120
    v_cvt_pk_bf16_f32 v192, v176, v180
    v_cvt_pk_bf16_f32 v196, v177, v181
    v_cvt_pk_bf16_f32 v200, v178, v182
    v_cvt_pk_bf16_f32 v204, v179, v183
    v_mov_b64 v[176:177], 0
    v_mov_b64 v[178:179], 0
    v_mov_b64 v[180:181], 0
    v_mov_b64 v[182:183], 0
    s_waitcnt lgkmcnt(8)
    v_smfmac_f32_16x16x64_bf16 v[188:191], a[128:131], a[120:127], v250
    buffer_load_dwordx4 v[216:219], v2, s[12:15], s46 offen offset:1024 sc1
    ds_read_b64_tr_b16 a[112:113], v3 offset:64224
    ds_read_b64_tr_b16 a[114:115], v4 offset:64224
    ds_read_b64_tr_b16 a[116:117], v3 offset:65248
    ds_read_b64_tr_b16 a[118:119], v4 offset:65248
    s_waitcnt lgkmcnt(8)
    v_smfmac_f32_16x16x64_bf16 v[176:179], a[128:131], a[96:103], v250
    buffer_load_dwordx4 a[76:79], v2, s[12:15], s47 offen offset:0 sc1
    ds_read_b64_tr_b16 a[120:121], v3 offset:64352
    ds_read_b64_tr_b16 a[122:123], v4 offset:64352
    ds_read_b64_tr_b16 a[124:125], v3 offset:65376
    ds_read_b64_tr_b16 a[126:127], v4 offset:65376
    v_cvt_pk_bf16_f32 v193, v184, v188
    v_cvt_pk_bf16_f32 v197, v185, v189
    v_cvt_pk_bf16_f32 v201, v186, v190
    v_cvt_pk_bf16_f32 v205, v187, v191
    v_mov_b64 v[184:185], 0
    v_mov_b64 v[186:187], 0
    v_mov_b64 v[188:189], 0
    v_mov_b64 v[190:191], 0
    s_waitcnt lgkmcnt(8)
    v_smfmac_f32_16x16x64_bf16 v[180:183], a[128:131], a[104:111], v250
    buffer_load_dwordx4 v[220:223], v2, s[12:15], s47 offen offset:1024 sc1
    s_waitcnt lgkmcnt(4)
    v_smfmac_f32_16x16x64_bf16 v[184:187], a[128:131], a[112:119], v250
    s_nop 3
    buffer_load_dwordx4 a[80:83], v2, s[12:15], s48 offen offset:0 sc1
    v_cvt_pk_bf16_f32 v194, v176, v180
    v_cvt_pk_bf16_f32 v198, v177, v181
    v_cvt_pk_bf16_f32 v202, v178, v182
    v_cvt_pk_bf16_f32 v206, v179, v183
    v_mov_b64 v[176:177], 0
    v_mov_b64 v[178:179], 0
    v_mov_b64 v[180:181], 0
    v_mov_b64 v[182:183], 0
    s_waitcnt lgkmcnt(0)
    v_smfmac_f32_16x16x64_bf16 v[188:191], a[128:131], a[120:127], v250
    buffer_load_dwordx4 v[224:227], v2, s[12:15], s48 offen offset:1024 sc1
    s_nop 5
    s_nop 0
    v_cvt_pk_bf16_f32 v195, v184, v188
    v_cvt_pk_bf16_f32 v199, v185, v189
    v_cvt_pk_bf16_f32 v203, v186, v190
    v_cvt_pk_bf16_f32 v207, v187, v191
    v_mov_b64 v[184:185], 0
    v_mov_b64 v[186:187], 0
    v_mov_b64 v[188:189], 0
    v_mov_b64 v[190:191], 0
    ds_write_b128 v5, v[192:195] offset:0
    ds_write_b128 v5, v[196:199] offset:1024
    ds_write_b128 v5, v[200:203] offset:2048
    ds_write_b128 v5, v[204:207] offset:3072
    v_add_u32 v2, 10240, v2
    s_waitcnt vmcnt(10)
    s_waitcnt lgkmcnt(0)
    s_barrier
    ds_read_b128 a[0:3], v6 offset:0
    ds_read_b128 a[4:7], v6 offset:1024
    ds_read_b128 a[8:11], v6 offset:4096
    ds_read_b128 a[12:15], v6 offset:5120
    ds_read_b128 a[16:19], v6 offset:8192
    ds_read_b128 a[20:23], v6 offset:9216
    ds_read_b128 a[24:27], v6 offset:12288
    ds_read_b128 a[28:31], v6 offset:13312
    ds_read_b64_tr_b16 a[96:97], v3 offset:0
    ds_read_b64_tr_b16 a[98:99], v4 offset:0
    ds_read_b64_tr_b16 a[100:101], v3 offset:1024
    ds_read_b64_tr_b16 a[102:103], v4 offset:1024
    ds_read_b64_tr_b16 a[104:105], v3 offset:128
    ds_read_b64_tr_b16 a[106:107], v4 offset:128
    ds_read_b64_tr_b16 a[108:109], v3 offset:1152
    ds_read_b64_tr_b16 a[110:111], v4 offset:1152
    s_waitcnt vmcnt(8)
    v_xor_b32 v240, s80, v208
    v_xor_b32 v241, s80, v209
    v_xor_b32 v242, s80, v210
    v_xor_b32 v243, s80, v211
    s_waitcnt lgkmcnt(8)
    v_mfma_f32_16x16x32_bf16 v[16:19], a[64:67], a[0:3], 0
    s_add_u32 m0, s65, 61920
    v_mfma_f32_16x16x32_bf16 v[16:19], v[240:243], a[4:7], v[16:19]
    buffer_load_dwordx4 v1, s[8:11], s50 offen lds
    v_mfma_f32_16x16x32_bf16 v[96:99], a[64:67], a[4:7], 0
    v_mfma_f32_16x16x32_bf16 v[96:99], v[208:211], a[0:3], v[96:99]
    s_add_u32 m0, s66, 61920
    v_mfma_f32_16x16x32_bf16 v[100:103], v[208:211], a[8:11], 0
    s_waitcnt lgkmcnt(4)
    v_smfmac_f32_16x16x64_bf16 v[176:179], a[128:131], a[96:103], v250
    buffer_load_dwordx4 v1, s[8:11], s51 offen lds
    v_mfma_f32_16x16x32_bf16 v[100:103], a[64:67], a[12:15], v[100:103]
    ds_read_b64_tr_b16 a[112:113], v3 offset:256
    v_mfma_f32_16x16x32_bf16 v[20:23], v[240:243], a[12:15], 0
    s_add_u32 m0, s67, 61920
    ds_read_b64_tr_b16 a[114:115], v4 offset:256
    v_mfma_f32_16x16x32_bf16 v[20:23], a[64:67], a[8:11], v[20:23]
    s_waitcnt vmcnt(8)
    buffer_load_dwordx4 v1, s[8:11], s52 offen lds
    v_mfma_f32_16x16x32_bf16 v[24:27], a[64:67], a[16:19], 0
    s_add_u32 m0, s68, 61920
    ds_read_b64_tr_b16 a[116:117], v3 offset:1280
    v_mfma_f32_16x16x32_bf16 v[24:27], v[240:243], a[20:23], v[24:27]
    s_waitcnt lgkmcnt(3)
    ds_read_b64_tr_b16 a[118:119], v4 offset:1280
    v_xor_b32 v244, s80, v212
    v_smfmac_f32_16x16x64_bf16 v[180:183], a[128:131], a[104:111], v250
    buffer_load_dwordx4 v1, s[8:11], s53 offen lds
    v_mfma_f32_16x16x32_bf16 v[104:107], a[64:67], a[20:23], 0
    ds_read_b64_tr_b16 a[120:121], v3 offset:384
    v_xor_b32 v245, s80, v213
    v_mfma_f32_16x16x32_bf16 v[104:107], v[208:211], a[16:19], v[104:107]
    ds_read_b64_tr_b16 a[122:123], v4 offset:384
    v_xor_b32 v246, s80, v214
    v_mfma_f32_16x16x32_bf16 v[108:111], v[208:211], a[24:27], 0
    s_add_u32 m0, s69, 61920
    ds_read_b64_tr_b16 a[124:125], v3 offset:1408
    v_xor_b32 v247, s80, v215
    v_mfma_f32_16x16x32_bf16 v[108:111], a[64:67], a[28:31], v[108:111]
    buffer_load_dwordx4 v1, s[8:11], s54 offen lds
    v_mfma_f32_16x16x32_bf16 v[28:31], v[240:243], a[28:31], 0
    s_waitcnt lgkmcnt(3)
    ds_read_b64_tr_b16 a[126:127], v4 offset:1408
    v_cvt_pk_bf16_f32 v192, v176, v180
    v_smfmac_f32_16x16x64_bf16 v[184:187], a[128:131], a[112:119], v250
    s_add_u32 m0, s70, 61920
    ds_read_b64_tr_b16 a[96:97], v3 offset:2048
    v_cvt_pk_bf16_f32 v196, v177, v181
    v_mfma_f32_16x16x32_bf16 v[28:31], a[64:67], a[24:27], v[28:31]
    buffer_load_dwordx4 v1, s[8:11], s55 offen lds
    v_mfma_f32_16x16x32_bf16 v[32:35], a[68:71], a[0:3], 0
    ds_read_b64_tr_b16 a[98:99], v4 offset:2048
    v_cvt_pk_bf16_f32 v200, v178, v182
    v_mfma_f32_16x16x32_bf16 v[32:35], v[244:247], a[4:7], v[32:35]
    s_add_u32 m0, s71, 61920
    ds_read_b64_tr_b16 a[100:101], v3 offset:3072
    v_cvt_pk_bf16_f32 v204, v179, v183
    v_mfma_f32_16x16x32_bf16 v[112:115], a[68:71], a[4:7], 0
    buffer_load_dwordx4 v1, s[8:11], s56 offen lds
    v_mfma_f32_16x16x32_bf16 v[112:115], v[212:215], a[0:3], v[112:115]
    s_waitcnt lgkmcnt(3)
    ds_read_b64_tr_b16 a[102:103], v4 offset:3072
    v_mov_b64 v[176:177], 0
    v_smfmac_f32_16x16x64_bf16 v[188:191], a[128:131], a[120:127], v250
    ds_read_b64_tr_b16 a[104:105], v3 offset:2176
    v_mov_b64 v[178:179], 0
    v_mfma_f32_16x16x32_bf16 v[116:119], v[212:215], a[8:11], 0
    s_add_u32 m0, s72, 61920
    ds_read_b64_tr_b16 a[106:107], v4 offset:2176
    v_mov_b64 v[180:181], 0
    v_mfma_f32_16x16x32_bf16 v[116:119], a[68:71], a[12:15], v[116:119]
    buffer_load_dwordx4 v1, s[8:11], s57 offen lds
    v_mfma_f32_16x16x32_bf16 v[36:39], v[244:247], a[12:15], 0
    ds_read_b64_tr_b16 a[108:109], v3 offset:3200
    v_mov_b64 v[182:183], 0
    v_mfma_f32_16x16x32_bf16 v[36:39], a[68:71], a[8:11], v[36:39]
    s_add_u32 m0, s73, 61920
    ds_read_b64_tr_b16 a[110:111], v4 offset:3200
    v_mfma_f32_16x16x32_bf16 v[40:43], a[68:71], a[16:19], 0
    s_waitcnt lgkmcnt(4)
    buffer_load_dwordx4 v1, s[8:11], s58 offen lds
    v_smfmac_f32_16x16x64_bf16 v[176:179], a[128:131], a[96:103], v250
    s_waitcnt vmcnt(13)
    ds_read_b64_tr_b16 a[112:113], v3 offset:2304
    v_cvt_pk_bf16_f32 v193, v184, v188
    v_mfma_f32_16x16x32_bf16 v[40:43], v[244:247], a[20:23], v[40:43]
    s_add_u32 m0, s74, 61920
    ds_read_b64_tr_b16 a[114:115], v4 offset:2304
    v_cvt_pk_bf16_f32 v197, v185, v189
    v_mfma_f32_16x16x32_bf16 v[120:123], a[68:71], a[20:23], 0
    buffer_load_dwordx4 v1, s[8:11], s59 offen lds
    v_xor_b32 v243, s80, v219
    v_mfma_f32_16x16x32_bf16 v[120:123], v[212:215], a[16:19], v[120:123]
    ds_read_b64_tr_b16 a[116:117], v3 offset:3328
    v_cvt_pk_bf16_f32 v201, v186, v190
    v_mfma_f32_16x16x32_bf16 v[124:127], v[212:215], a[24:27], 0
    s_add_u32 m0, s75, 61920
    ds_read_b64_tr_b16 a[118:119], v4 offset:3328
    v_cvt_pk_bf16_f32 v205, v187, v191
    v_mfma_f32_16x16x32_bf16 v[124:127], a[68:71], a[28:31], v[124:127]
    s_waitcnt lgkmcnt(4)
    v_xor_b32 v240, s80, v216
    v_xor_b32 v241, s80, v217
    v_smfmac_f32_16x16x64_bf16 v[180:183], a[128:131], a[104:111], v250
    buffer_load_dwordx4 v1, s[8:11], s60 offen lds
    v_mfma_f32_16x16x32_bf16 v[44:47], v[244:247], a[28:31], 0
    ds_read_b64_tr_b16 a[120:121], v3 offset:2432
    v_xor_b32 v242, s80, v218
    v_mfma_f32_16x16x32_bf16 v[44:47], a[68:71], a[24:27], v[44:47]
    ds_read_b64_tr_b16 a[122:123], v4 offset:2432
    v_mov_b64 v[184:185], 0
    v_mfma_f32_16x16x32_bf16 v[48:51], a[72:75], a[0:3], 0
    buffer_load_dwordx4 a[84:87], v2, s[12:15], s44 offen offset:0 sc1
    v_mfma_f32_16x16x32_bf16 v[48:51], v[240:243], a[4:7], v[48:51]
    ds_read_b64_tr_b16 a[124:125], v3 offset:3456
    v_mov_b64 v[186:187], 0
    v_mfma_f32_16x16x32_bf16 v[128:131], a[72:75], a[4:7], 0
    s_waitcnt lgkmcnt(3)
    ds_read_b64_tr_b16 a[126:127], v4 offset:3456
    v_cvt_pk_bf16_f32 v194, v176, v180
    v_smfmac_f32_16x16x64_bf16 v[184:187], a[128:131], a[112:119], v250
    buffer_load_dwordx4 v[228:231], v2, s[12:15], s44 offen offset:1024 sc1
    v_mfma_f32_16x16x32_bf16 v[128:131], v[216:219], a[0:3], v[128:131]
    v_cvt_pk_bf16_f32 v198, v177, v181
    v_cvt_pk_bf16_f32 v202, v178, v182
    v_mfma_f32_16x16x32_bf16 v[132:135], v[216:219], a[8:11], 0
    v_cvt_pk_bf16_f32 v206, v179, v183
    v_mov_b64 v[188:189], 0
    v_mfma_f32_16x16x32_bf16 v[132:135], a[72:75], a[12:15], v[132:135]
    v_mov_b64 v[190:191], 0
    v_mfma_f32_16x16x32_bf16 v[52:55], v[240:243], a[12:15], 0
    buffer_load_dwordx4 a[88:91], v2, s[12:15], s45 offen offset:0 sc1
    v_mfma_f32_16x16x32_bf16 v[52:55], a[72:75], a[8:11], v[52:55]
    s_waitcnt lgkmcnt(0)
    v_smfmac_f32_16x16x64_bf16 v[188:191], a[128:131], a[120:127], v250
    s_waitcnt vmcnt(16)
    v_xor_b32 v244, s80, v220
    v_xor_b32 v245, s80, v221
    v_mfma_f32_16x16x32_bf16 v[56:59], a[72:75], a[16:19], 0
    buffer_load_dwordx4 v[232:235], v2, s[12:15], s45 offen offset:1024 sc1
    v_mfma_f32_16x16x32_bf16 v[56:59], v[240:243], a[20:23], v[56:59]
    v_xor_b32 v246, s80, v222
    v_xor_b32 v247, s80, v223
    v_mfma_f32_16x16x32_bf16 v[136:139], a[72:75], a[20:23], 0
    v_mfma_f32_16x16x32_bf16 v[136:139], v[216:219], a[16:19], v[136:139]
    buffer_load_dwordx4 a[92:95], v2, s[12:15], s46 offen offset:0 sc1
    v_mfma_f32_16x16x32_bf16 v[140:143], v[216:219], a[24:27], 0
    v_cvt_pk_bf16_f32 v195, v184, v188
    v_cvt_pk_bf16_f32 v199, v185, v189
    v_mfma_f32_16x16x32_bf16 v[140:143], a[72:75], a[28:31], v[140:143]
    v_cvt_pk_bf16_f32 v203, v186, v190
    v_cvt_pk_bf16_f32 v207, v187, v191
    v_mfma_f32_16x16x32_bf16 v[60:63], v[240:243], a[28:31], 0
    ds_write_b128 v5, v[192:195] offset:16384
    v_mfma_f32_16x16x32_bf16 v[60:63], a[72:75], a[24:27], v[60:63]
    buffer_load_dwordx4 v[236:239], v2, s[12:15], s46 offen offset:1024 sc1
    v_mfma_f32_16x16x32_bf16 v[64:67], a[76:79], a[0:3], 0
    v_mfma_f32_16x16x32_bf16 v[64:67], v[244:247], a[4:7], v[64:67]
    ds_write_b128 v5, v[196:199] offset:17408
    v_mfma_f32_16x16x32_bf16 v[144:147], a[76:79], a[4:7], 0
    buffer_load_dwordx4 a[64:67], v2, s[12:15], s47 offen offset:0 sc1
    v_mfma_f32_16x16x32_bf16 v[144:147], v[220:223], a[0:3], v[144:147]
    v_mfma_f32_16x16x32_bf16 v[148:151], v[220:223], a[8:11], 0
    ds_write_b128 v5, v[200:203] offset:18432
    v_mfma_f32_16x16x32_bf16 v[148:151], a[76:79], a[12:15], v[148:151]
    buffer_load_dwordx4 v[208:211], v2, s[12:15], s47 offen offset:1024 sc1
    v_mfma_f32_16x16x32_bf16 v[68:71], v[244:247], a[12:15], 0
    v_mfma_f32_16x16x32_bf16 v[68:71], a[76:79], a[8:11], v[68:71]
    s_waitcnt vmcnt(19)
    ds_write_b128 v5, v[204:207] offset:19456
    v_mfma_f32_16x16x32_bf16 v[72:75], a[76:79], a[16:19], 0
    v_xor_b32 v240, s80, v224
    v_xor_b32 v241, s80, v225
    v_mfma_f32_16x16x32_bf16 v[72:75], v[244:247], a[20:23], v[72:75]
    buffer_load_dwordx4 a[68:71], v2, s[12:15], s48 offen offset:0 sc1
    v_mfma_f32_16x16x32_bf16 v[152:155], a[76:79], a[20:23], 0
    v_xor_b32 v242, s80, v226
    v_xor_b32 v243, s80, v227
    v_mfma_f32_16x16x32_bf16 v[152:155], v[220:223], a[16:19], v[152:155]
    v_mfma_f32_16x16x32_bf16 v[156:159], v[220:223], a[24:27], 0
    buffer_load_dwordx4 v[212:215], v2, s[12:15], s48 offen offset:1024 sc1
    v_mfma_f32_16x16x32_bf16 v[156:159], a[76:79], a[28:31], v[156:159]
    v_add_u32 v2, 4294926336, v2
    v_mfma_f32_16x16x32_bf16 v[76:79], v[244:247], a[28:31], 0
    v_mfma_f32_16x16x32_bf16 v[76:79], a[76:79], a[24:27], v[76:79]
    s_waitcnt lgkmcnt(0)
    s_barrier
    s_mov_b32 s95, 32768
    s_and_b32 s38, s2, 0xc2
    s_cmp_eq_u32 s38, 0xc2
    s_cselect_b32 s100, 7, -1
    s_mov_b32 s38, 49664
    s_cselect_b32 s38, s38, 0x100000
    v_mov_b32 v10, 1
    s_mov_b64 exec, 1
    buffer_atomic_add v10, v9, s[40:43], s38 offen sc0 sc1
    s_mov_b64 exec, -1
    v_mfma_f32_16x16x32_bf16 v[80:83], a[80:83], a[0:3], 0
    s_add_u32 m0, s76, 61920
    ds_read_b128 a[32:35], v6 offset:16384
    v_mfma_f32_16x16x32_bf16 v[80:83], v[240:243], a[4:7], v[80:83]
    buffer_load_dwordx4 v1, s[8:11], s61 offen lds
    v_mfma_f32_16x16x32_bf16 v[160:163], a[80:83], a[4:7], 0
    ds_read_b128 a[36:39], v6 offset:17408
    v_mfma_f32_16x16x32_bf16 v[160:163], v[224:227], a[0:3], v[160:163]
    ds_read_b128 a[40:43], v6 offset:20480
    v_mfma_f32_16x16x32_bf16 v[164:167], v[224:227], a[8:11], 0
    s_add_u32 m0, s77, 61920
    ds_read_b128 a[44:47], v6 offset:21504
    v_mfma_f32_16x16x32_bf16 v[164:167], a[80:83], a[12:15], v[164:167]
    buffer_load_dwordx4 v1, s[8:11], s62 offen lds
    v_mfma_f32_16x16x32_bf16 v[84:87], v[240:243], a[12:15], 0
    ds_read_b128 a[48:51], v6 offset:24576
    v_mfma_f32_16x16x32_bf16 v[84:87], a[80:83], a[8:11], v[84:87]
    s_waitcnt vmcnt(11)
    ds_read_b128 a[52:55], v6 offset:25600
    v_xor_b32 v244, s80, v228
    v_mfma_f32_16x16x32_bf16 v[88:91], a[80:83], a[16:19], 0
    s_add_u32 m0, s78, 61920
    ds_read_b128 a[56:59], v6 offset:28672
    v_xor_b32 v245, s80, v229
    v_mfma_f32_16x16x32_bf16 v[88:91], v[240:243], a[20:23], v[88:91]
    buffer_load_dwordx4 v1, s[8:11], s63 offen lds
    v_mfma_f32_16x16x32_bf16 v[168:171], a[80:83], a[20:23], 0
    ds_read_b128 a[60:63], v6 offset:29696
    v_xor_b32 v246, s80, v230
    v_mfma_f32_16x16x32_bf16 v[168:171], v[224:227], a[16:19], v[168:171]
    v_xor_b32 v247, s80, v231
    v_mfma_f32_16x16x32_bf16 v[172:175], v[224:227], a[24:27], 0
    s_add_u32 m0, s79, 61920
    v_mfma_f32_16x16x32_bf16 v[172:175], a[80:83], a[28:31], v[172:175]
    buffer_load_dwordx4 v1, s[8:11], s64 offen lds
    v_mfma_f32_16x16x32_bf16 v[92:95], v[240:243], a[28:31], 0
    v_add_u32 v1, 0x10000, v1
    v_mfma_f32_16x16x32_bf16 v[92:95], a[80:83], a[24:27], v[92:95]
    s_waitcnt lgkmcnt(0)
    v_mfma_f32_16x16x32_bf16 v[16:19], a[84:87], a[32:35], v[16:19]
    s_mov_b32 s97, 458752
    buffer_load_dwordx4 a[248:251], v14, s[8:11], s97 offen
    v_mfma_f32_16x16x32_bf16 v[16:19], v[244:247], a[36:39], v[16:19]
    v_mfma_f32_16x16x32_bf16 v[96:99], a[84:87], a[36:39], v[96:99]
    ds_write_b128 v5, a[136:139] offset:0
    v_mfma_f32_16x16x32_bf16 v[96:99], v[228:231], a[32:35], v[96:99]
    v_mfma_f32_16x16x32_bf16 v[100:103], v[228:231], a[40:43], v[100:103]
    s_mov_b32 s97, 524288
    buffer_load_dwordx4 a[248:251], v14, s[8:11], s97 offen
    v_mfma_f32_16x16x32_bf16 v[100:103], a[84:87], a[44:47], v[100:103]
    v_mfma_f32_16x16x32_bf16 v[20:23], v[244:247], a[44:47], v[20:23]
    v_mfma_f32_16x16x32_bf16 v[20:23], a[84:87], a[40:43], v[20:23]
    s_waitcnt vmcnt(13)
    v_xor_b32 v240, s80, v232
    v_xor_b32 v241, s80, v233
    v_mfma_f32_16x16x32_bf16 v[24:27], a[84:87], a[48:51], v[24:27]
    s_mov_b32 s97, 589824
    buffer_load_dwordx4 a[248:251], v14, s[8:11], s97 offen
    v_mfma_f32_16x16x32_bf16 v[24:27], v[244:247], a[52:55], v[24:27]
    v_xor_b32 v242, s80, v234
    v_xor_b32 v243, s80, v235
    v_mfma_f32_16x16x32_bf16 v[104:107], a[84:87], a[52:55], v[104:107]
    s_mov_b32 m0, s65
    v_mfma_f32_16x16x32_bf16 v[104:107], v[228:231], a[48:51], v[104:107]
    buffer_load_dwordx4 v1, s[8:11], s50 offen lds
    v_mfma_f32_16x16x32_bf16 v[108:111], v[228:231], a[56:59], v[108:111]
    v_mfma_f32_16x16x32_bf16 v[108:111], a[84:87], a[60:63], v[108:111]
    v_mfma_f32_16x16x32_bf16 v[28:31], v[244:247], a[60:63], v[28:31]
    s_mov_b32 m0, s66
    v_mfma_f32_16x16x32_bf16 v[28:31], a[84:87], a[56:59], v[28:31]
    buffer_load_dwordx4 v1, s[8:11], s51 offen lds
    v_mfma_f32_16x16x32_bf16 v[32:35], a[88:91], a[32:35], v[32:35]
    v_mfma_f32_16x16x32_bf16 v[32:35], v[240:243], a[36:39], v[32:35]
    v_mfma_f32_16x16x32_bf16 v[112:115], a[88:91], a[36:39], v[112:115]
    s_mov_b32 m0, s67
    ds_write_b128 v5, a[140:143] offset:1024
    v_mfma_f32_16x16x32_bf16 v[112:115], v[232:235], a[32:35], v[112:115]
    buffer_load_dwordx4 v1, s[8:11], s52 offen lds
    v_mfma_f32_16x16x32_bf16 v[116:119], v[232:235], a[40:43], v[116:119]
    v_mfma_f32_16x16x32_bf16 v[116:119], a[88:91], a[44:47], v[116:119]
    v_mfma_f32_16x16x32_bf16 v[36:39], v[240:243], a[44:47], v[36:39]
    s_mov_b32 m0, s68
    v_mfma_f32_16x16x32_bf16 v[36:39], a[88:91], a[40:43], v[36:39]
    s_waitcnt vmcnt(15)
    buffer_load_dwordx4 v1, s[8:11], s53 offen lds
    v_mfma_f32_16x16x32_bf16 v[40:43], a[88:91], a[48:51], v[40:43]
    v_xor_b32 v244, s80, v236
    v_xor_b32 v245, s80, v237
    v_mfma_f32_16x16x32_bf16 v[40:43], v[240:243], a[52:55], v[40:43]
    v_xor_b32 v246, s80, v238
    v_xor_b32 v247, s80, v239
    v_mfma_f32_16x16x32_bf16 v[120:123], a[88:91], a[52:55], v[120:123]
    buffer_load_dwordx4 a[72:75], v2, s[12:15], s44 offen offset:0 sc1
    v_mfma_f32_16x16x32_bf16 v[120:123], v[232:235], a[48:51], v[120:123]
    v_mfma_f32_16x16x32_bf16 v[124:127], v[232:235], a[56:59], v[124:127]
    v_mfma_f32_16x16x32_bf16 v[124:127], a[88:91], a[60:63], v[124:127]
    v_mfma_f32_16x16x32_bf16 v[44:47], v[240:243], a[60:63], v[44:47]
    buffer_load_dwordx4 v[216:219], v2, s[12:15], s44 offen offset:1024 sc1
    v_mfma_f32_16x16x32_bf16 v[44:47], a[88:91], a[56:59], v[44:47]
    v_mfma_f32_16x16x32_bf16 v[48:51], a[92:95], a[32:35], v[48:51]
    v_mfma_f32_16x16x32_bf16 v[48:51], v[244:247], a[36:39], v[48:51]
    v_mfma_f32_16x16x32_bf16 v[128:131], a[92:95], a[36:39], v[128:131]
    buffer_load_dwordx4 a[76:79], v2, s[12:15], s45 offen offset:0 sc1
    v_mfma_f32_16x16x32_bf16 v[128:131], v[236:239], a[32:35], v[128:131]
    ds_write_b128 v5, a[144:147] offset:2048
    v_mfma_f32_16x16x32_bf16 v[132:135], v[236:239], a[40:43], v[132:135]
    v_mfma_f32_16x16x32_bf16 v[132:135], a[92:95], a[44:47], v[132:135]
    buffer_load_dwordx4 v[220:223], v2, s[12:15], s45 offen offset:1024 sc1
    v_mfma_f32_16x16x32_bf16 v[52:55], v[244:247], a[44:47], v[52:55]
    v_mfma_f32_16x16x32_bf16 v[52:55], a[92:95], a[40:43], v[52:55]
    s_waitcnt vmcnt(18)
    v_xor_b32 v240, s80, v208
    v_xor_b32 v241, s80, v209
    v_mfma_f32_16x16x32_bf16 v[56:59], a[92:95], a[48:51], v[56:59]
    v_xor_b32 v242, s80, v210
    v_xor_b32 v243, s80, v211
    v_mfma_f32_16x16x32_bf16 v[56:59], v[244:247], a[52:55], v[56:59]
    buffer_load_dwordx4 a[80:83], v2, s[12:15], s46 offen offset:0 sc1
    v_mfma_f32_16x16x32_bf16 v[136:139], a[92:95], a[52:55], v[136:139]
    v_mfma_f32_16x16x32_bf16 v[136:139], v[236:239], a[48:51], v[136:139]
    v_mfma_f32_16x16x32_bf16 v[140:143], v[236:239], a[56:59], v[140:143]
    v_mfma_f32_16x16x32_bf16 v[140:143], a[92:95], a[60:63], v[140:143]
    buffer_load_dwordx4 v[224:227], v2, s[12:15], s46 offen offset:1024 sc1
    v_mfma_f32_16x16x32_bf16 v[60:63], v[244:247], a[60:63], v[60:63]
    v_mfma_f32_16x16x32_bf16 v[60:63], a[92:95], a[56:59], v[60:63]
    v_mfma_f32_16x16x32_bf16 v[64:67], a[64:67], a[32:35], v[64:67]
    v_mfma_f32_16x16x32_bf16 v[64:67], v[240:243], a[36:39], v[64:67]
    buffer_load_dwordx4 a[84:87], v2, s[12:15], s47 offen offset:0 sc1
    v_mfma_f32_16x16x32_bf16 v[144:147], a[64:67], a[36:39], v[144:147]
    ds_write_b128 v5, a[148:151] offset:3072
    v_mfma_f32_16x16x32_bf16 v[144:147], v[208:211], a[32:35], v[144:147]
    v_mfma_f32_16x16x32_bf16 v[148:151], v[208:211], a[40:43], v[148:151]
    buffer_load_dwordx4 v[228:231], v2, s[12:15], s47 offen offset:1024 sc1
    v_mfma_f32_16x16x32_bf16 v[148:151], a[64:67], a[44:47], v[148:151]
    v_mfma_f32_16x16x32_bf16 v[68:71], v[240:243], a[44:47], v[68:71]
    v_mfma_f32_16x16x32_bf16 v[68:71], a[64:67], a[40:43], v[68:71]
    s_waitcnt vmcnt(20)
    v_xor_b32 v244, s80, v212
    v_xor_b32 v245, s80, v213
    v_mfma_f32_16x16x32_bf16 v[72:75], a[64:67], a[48:51], v[72:75]
    buffer_load_dwordx4 a[88:91], v2, s[12:15], s48 offen offset:0 sc1
    v_mfma_f32_16x16x32_bf16 v[72:75], v[240:243], a[52:55], v[72:75]
    v_xor_b32 v246, s80, v214
    v_xor_b32 v247, s80, v215
    v_mfma_f32_16x16x32_bf16 v[152:155], a[64:67], a[52:55], v[152:155]
    v_mfma_f32_16x16x32_bf16 v[152:155], v[208:211], a[48:51], v[152:155]
    v_mfma_f32_16x16x32_bf16 v[156:159], v[208:211], a[56:59], v[156:159]
    buffer_load_dwordx4 v[232:235], v2, s[12:15], s48 offen offset:1024 sc1
    v_mfma_f32_16x16x32_bf16 v[156:159], a[64:67], a[60:63], v[156:159]
    v_add_u32 v2, 51200, v2
    v_mfma_f32_16x16x32_bf16 v[76:79], v[240:243], a[60:63], v[76:79]
    v_mfma_f32_16x16x32_bf16 v[76:79], a[64:67], a[56:59], v[76:79]
    s_waitcnt vmcnt(17) lgkmcnt(0)
    v_readfirstlane_b32 s39, v10
    s_cmp_lg_u32 s36, 0
    s_cbranch_scc1 L_pb5
    s_cmp_lg_u32 s39, s100
    s_cbranch_scc1 L_pb5
    s_mov_b64 exec, 0xff
    buffer_store_dword v11, v8, s[40:43], s95 offen sc1
    s_mov_b64 exec, -1
L_pb5:
    s_barrier
    v_mfma_f32_16x16x32_bf16 v[80:83], a[68:71], a[32:35], v[80:83]
    ds_read_b128 a[0:3], v6 offset:0
    v_mov_b64 v[176:177], 0
    v_mfma_f32_16x16x32_bf16 v[80:83], v[244:247], a[36:39], v[80:83]
    s_mov_b32 m0, s69
    ds_read_b128 a[4:7], v6 offset:1024
    v_mov_b64 v[178:179], 0
    v_mfma_f32_16x16x32_bf16 v[160:163], a[68:71], a[36:39], v[160:163]
    buffer_load_dwordx4 v1, s[8:11], s54 offen lds
    v_mfma_f32_16x16x32_bf16 v[160:163], v[212:215], a[32:35], v[160:163]
    ds_read_b128 a[8:11], v6 offset:4096
    v_mov_b64 v[180:181], 0
    v_mfma_f32_16x16x32_bf16 v[164:167], v[212:215], a[40:43], v[164:167]
    ds_read_b128 a[12:15], v6 offset:5120
    v_mov_b64 v[182:183], 0
    v_mfma_f32_16x16x32_bf16 v[164:167], a[68:71], a[44:47], v[164:167]
    s_mov_b32 m0, s70
    ds_read_b128 a[16:19], v6 offset:8192
    v_mov_b64 v[184:185], 0
    v_mfma_f32_16x16x32_bf16 v[84:87], v[244:247], a[44:47], v[84:87]
    buffer_load_dwordx4 v1, s[8:11], s55 offen lds
    v_mfma_f32_16x16x32_bf16 v[84:87], a[68:71], a[40:43], v[84:87]
    s_waitcnt vmcnt(10)
    ds_read_b128 a[20:23], v6 offset:9216
    v_xor_b32 v240, s80, v216
    v_mfma_f32_16x16x32_bf16 v[88:91], a[68:71], a[48:51], v[88:91]
    ds_read_b128 a[24:27], v6 offset:12288
    v_xor_b32 v241, s80, v217
    v_mfma_f32_16x16x32_bf16 v[88:91], v[244:247], a[52:55], v[88:91]
    s_mov_b32 m0, s71
    ds_read_b128 a[28:31], v6 offset:13312
    v_xor_b32 v242, s80, v218
    v_mfma_f32_16x16x32_bf16 v[168:171], a[68:71], a[52:55], v[168:171]
    buffer_load_dwordx4 v1, s[8:11], s56 offen lds
    v_mfma_f32_16x16x32_bf16 v[168:171], v[212:215], a[48:51], v[168:171]
    ds_read_b64_tr_b16 a[96:97], v3 offset:61920
    v_xor_b32 v243, s80, v219
    v_mfma_f32_16x16x32_bf16 v[172:175], v[212:215], a[56:59], v[172:175]
    ds_read_b64_tr_b16 a[98:99], v4 offset:61920
    v_mov_b64 v[186:187], 0
    v_mfma_f32_16x16x32_bf16 v[172:175], a[68:71], a[60:63], v[172:175]
    s_mov_b32 m0, s72
    ds_read_b64_tr_b16 a[100:101], v3 offset:62944
    v_mov_b64 v[188:189], 0
    v_mfma_f32_16x16x32_bf16 v[92:95], v[244:247], a[60:63], v[92:95]
    buffer_load_dwordx4 v1, s[8:11], s57 offen lds
    v_mfma_f32_16x16x32_bf16 v[92:95], a[68:71], a[56:59], v[92:95]
    s_waitcnt lgkmcnt(3)
    ds_read_b64_tr_b16 a[102:103], v4 offset:62944
    v_mov_b64 v[190:191], 0
    v_mfma_f32_16x16x32_bf16 v[16:19], a[72:75], a[0:3], v[16:19]
    ds_read_b64_tr_b16 a[104:105], v3 offset:62048
    v_mfma_f32_16x16x32_bf16 v[16:19], v[240:243], a[4:7], v[16:19]
    s_mov_b32 m0, s73
    ds_read_b64_tr_b16 a[106:107], v4 offset:62048
    v_mfma_f32_16x16x32_bf16 v[96:99], a[72:75], a[4:7], v[96:99]
    buffer_load_dwordx4 v1, s[8:11], s58 offen lds
    v_mfma_f32_16x16x32_bf16 v[96:99], v[216:219], a[0:3], v[96:99]
    ds_read_b64_tr_b16 a[108:109], v3 offset:63072
    v_mfma_f32_16x16x32_bf16 v[100:103], v[216:219], a[8:11], v[100:103]
    s_waitcnt lgkmcnt(3)
    ds_read_b64_tr_b16 a[110:111], v4 offset:63072
    v_smfmac_f32_16x16x64_bf16 v[176:179], a[128:131], a[96:103], v250
    s_mov_b32 m0, s74
    ds_read_b64_tr_b16 a[112:113], v3 offset:62176
    v_mfma_f32_16x16x32_bf16 v[100:103], a[72:75], a[12:15], v[100:103]
    buffer_load_dwordx4 v1, s[8:11], s59 offen lds
    v_mfma_f32_16x16x32_bf16 v[20:23], v[240:243], a[12:15], v[20:23]
    ds_read_b64_tr_b16 a[114:115], v4 offset:62176
    v_mfma_f32_16x16x32_bf16 v[20:23], a[72:75], a[8:11], v[20:23]
    s_waitcnt vmcnt(12)
    ds_read_b64_tr_b16 a[116:117], v3 offset:63200
    v_mfma_f32_16x16x32_bf16 v[24:27], a[72:75], a[16:19], v[24:27]
    s_mov_b32 m0, s75
    ds_read_b64_tr_b16 a[118:119], v4 offset:63200
    v_mfma_f32_16x16x32_bf16 v[24:27], v[240:243], a[20:23], v[24:27]
    s_waitcnt lgkmcnt(4)
    buffer_load_dwordx4 v1, s[8:11], s60 offen lds
    v_smfmac_f32_16x16x64_bf16 v[180:183], a[128:131], a[104:111], v250
    ds_read_b64_tr_b16 a[120:121], v3 offset:62304
    v_xor_b32 v244, s80, v220
    v_mfma_f32_16x16x32_bf16 v[104:107], a[72:75], a[20:23], v[104:107]
    ds_read_b64_tr_b16 a[122:123], v4 offset:62304
    v_xor_b32 v245, s80, v221
    v_mfma_f32_16x16x32_bf16 v[104:107], v[216:219], a[16:19], v[104:107]
    s_mov_b32 m0, s76
    ds_read_b64_tr_b16 a[124:125], v3 offset:63328
    v_xor_b32 v246, s80, v222
    v_mfma_f32_16x16x32_bf16 v[108:111], v[216:219], a[24:27], v[108:111]
    buffer_load_dwordx4 v1, s[8:11], s61 offen lds
    v_mfma_f32_16x16x32_bf16 v[108:111], a[72:75], a[28:31], v[108:111]
    ds_read_b64_tr_b16 a[126:127], v4 offset:63328
    v_xor_b32 v247, s80, v223
    v_mfma_f32_16x16x32_bf16 v[28:31], v[240:243], a[28:31], v[28:31]
    s_waitcnt lgkmcnt(4)
    v_cvt_pk_bf16_f32 v192, v176, v180
    v_cvt_pk_bf16_f32 v196, v177, v181
    v_smfmac_f32_16x16x64_bf16 v[184:187], a[128:131], a[112:119], v250
    s_mov_b32 m0, s77
    ds_read_b64_tr_b16 a[96:97], v3 offset:63968
    v_cvt_pk_bf16_f32 v200, v178, v182
    v_mfma_f32_16x16x32_bf16 v[28:31], a[72:75], a[24:27], v[28:31]
L_pad4:
    s_cbranch_execz L_back
    buffer_load_dwordx4 v1, s[8:11], s62 offen lds
    v_mfma_f32_16x16x32_bf16 v[32:35], a[76:79], a[0:3], v[32:35]
    ds_read_b64_tr_b16 a[98:99], v4 offset:63968
    v_cvt_pk_bf16_f32 v204, v179, v183
    v_mfma_f32_16x16x32_bf16 v[32:35], v[244:247], a[4:7], v[32:35]
    ds_read_b64_tr_b16 a[100:101], v3 offset:64992
    v_mov_b64 v[176:177], 0
    v_mfma_f32_16x16x32_bf16 v[112:115], a[76:79], a[4:7], v[112:115]
    s_mov_b32 m0, s78
    ds_read_b64_tr_b16 a[102:103], v4 offset:64992
    v_mov_b64 v[178:179], 0
    v_mfma_f32_16x16x32_bf16 v[112:115], v[220:223], a[0:3], v[112:115]
    s_waitcnt lgkmcnt(4)
    buffer_load_dwordx4 v1, s[8:11], s63 offen lds
    v_smfmac_f32_16x16x64_bf16 v[188:191], a[128:131], a[120:127], v250
    ds_read_b64_tr_b16 a[104:105], v3 offset:64096
    v_mov_b64 v[180:181], 0
    v_mfma_f32_16x16x32_bf16 v[116:119], v[220:223], a[8:11], v[116:119]
    ds_read_b64_tr_b16 a[106:107], v4 offset:64096
    v_mov_b64 v[182:183], 0
    v_mfma_f32_16x16x32_bf16 v[116:119], a[76:79], a[12:15], v[116:119]
    ds_read_b64_tr_b16 a[108:109], v3 offset:65120
    v_mfma_f32_16x16x32_bf16 v[36:39], v[244:247], a[12:15], v[36:39]
    s_mov_b32 m0, s79
    ds_read_b64_tr_b16 a[110:111], v4 offset:65120
    v_mfma_f32_16x16x32_bf16 v[36:39], a[76:79], a[8:11], v[36:39]
    buffer_load_dwordx4 v1, s[8:11], s64 offen lds
    v_mfma_f32_16x16x32_bf16 v[40:43], a[76:79], a[16:19], v[40:43]
    s_waitcnt lgkmcnt(4)
    v_add_u32 v1, 0x10000, v1
    v_cvt_pk_bf16_f32 v193, v184, v188
    v_smfmac_f32_16x16x64_bf16 v[176:179], a[128:131], a[96:103], v250
    s_waitcnt vmcnt(15)
    ds_read_b64_tr_b16 a[112:113], v3 offset:64224
    v_cvt_pk_bf16_f32 v197, v185, v189
    v_mfma_f32_16x16x32_bf16 v[40:43], v[244:247], a[20:23], v[40:43]
    ds_read_b64_tr_b16 a[114:115], v4 offset:64224
    v_cvt_pk_bf16_f32 v201, v186, v190
    v_mfma_f32_16x16x32_bf16 v[120:123], a[76:79], a[20:23], v[120:123]
    buffer_load_dwordx4 a[92:95], v2, s[12:15], s44 offen offset:0 sc1
    v_mfma_f32_16x16x32_bf16 v[120:123], v[220:223], a[16:19], v[120:123]
    ds_read_b64_tr_b16 a[116:117], v3 offset:65248
    v_cvt_pk_bf16_f32 v205, v187, v191
    v_mfma_f32_16x16x32_bf16 v[124:127], v[220:223], a[24:27], v[124:127]
    ds_read_b64_tr_b16 a[118:119], v4 offset:65248
    v_xor_b32 v240, s80, v224
    v_mfma_f32_16x16x32_bf16 v[124:127], a[76:79], a[28:31], v[124:127]
    s_waitcnt lgkmcnt(4)
    v_xor_b32 v241, s80, v225
    v_xor_b32 v242, s80, v226
    v_smfmac_f32_16x16x64_bf16 v[180:183], a[128:131], a[104:111], v250
    buffer_load_dwordx4 v[236:239], v2, s[12:15], s44 offen offset:1024 sc1
    v_mfma_f32_16x16x32_bf16 v[44:47], v[244:247], a[28:31], v[44:47]
    ds_read_b64_tr_b16 a[120:121], v3 offset:64352
    v_xor_b32 v243, s80, v227
    v_mfma_f32_16x16x32_bf16 v[44:47], a[76:79], a[24:27], v[44:47]
    ds_read_b64_tr_b16 a[122:123], v4 offset:64352
    v_mov_b64 v[184:185], 0
    v_mfma_f32_16x16x32_bf16 v[48:51], a[80:83], a[0:3], v[48:51]
    ds_read_b64_tr_b16 a[124:125], v3 offset:65376
    v_mov_b64 v[186:187], 0
    v_mfma_f32_16x16x32_bf16 v[48:51], v[240:243], a[4:7], v[48:51]
    buffer_load_dwordx4 a[64:67], v2, s[12:15], s45 offen offset:0 sc1
    v_mfma_f32_16x16x32_bf16 v[128:131], a[80:83], a[4:7], v[128:131]
    s_waitcnt lgkmcnt(3)
    ds_read_b64_tr_b16 a[126:127], v4 offset:65376
    v_cvt_pk_bf16_f32 v194, v176, v180
    v_smfmac_f32_16x16x64_bf16 v[184:187], a[128:131], a[112:119], v250
    v_cvt_pk_bf16_f32 v198, v177, v181
    v_cvt_pk_bf16_f32 v202, v178, v182
    v_mfma_f32_16x16x32_bf16 v[128:131], v[224:227], a[0:3], v[128:131]
    v_cvt_pk_bf16_f32 v206, v179, v183
    v_mov_b64 v[188:189], 0
    v_mfma_f32_16x16x32_bf16 v[132:135], v[224:227], a[8:11], v[132:135]
    buffer_load_dwordx4 v[208:211], v2, s[12:15], s45 offen offset:1024 sc1
    v_mfma_f32_16x16x32_bf16 v[132:135], a[80:83], a[12:15], v[132:135]
    v_mov_b64 v[190:191], 0
    v_mfma_f32_16x16x32_bf16 v[52:55], v[240:243], a[12:15], v[52:55]
    v_mfma_f32_16x16x32_bf16 v[52:55], a[80:83], a[8:11], v[52:55]
    s_waitcnt lgkmcnt(0)
    v_smfmac_f32_16x16x64_bf16 v[188:191], a[128:131], a[120:127], v250
    s_waitcnt vmcnt(17)
    buffer_load_dwordx4 a[68:71], v2, s[12:15], s46 offen offset:0 sc1
    v_mfma_f32_16x16x32_bf16 v[56:59], a[80:83], a[16:19], v[56:59]
    v_xor_b32 v244, s80, v228
    v_xor_b32 v245, s80, v229
    v_mfma_f32_16x16x32_bf16 v[56:59], v[240:243], a[20:23], v[56:59]
    v_xor_b32 v246, s80, v230
    v_xor_b32 v247, s80, v231
    v_mfma_f32_16x16x32_bf16 v[136:139], a[80:83], a[20:23], v[136:139]
    v_mfma_f32_16x16x32_bf16 v[136:139], v[224:227], a[16:19], v[136:139]
    buffer_load_dwordx4 v[212:215], v2, s[12:15], s46 offen offset:1024 sc1
    v_mfma_f32_16x16x32_bf16 v[140:143], v[224:227], a[24:27], v[140:143]
    v_cvt_pk_bf16_f32 v195, v184, v188
    v_cvt_pk_bf16_f32 v199, v185, v189
    v_mfma_f32_16x16x32_bf16 v[140:143], a[80:83], a[28:31], v[140:143]
    v_cvt_pk_bf16_f32 v203, v186, v190
    v_cvt_pk_bf16_f32 v207, v187, v191
    v_mfma_f32_16x16x32_bf16 v[60:63], v[240:243], a[28:31], v[60:63]
    ds_write_b128 v5, v[192:195] offset:16384
    v_mfma_f32_16x16x32_bf16 v[60:63], a[80:83], a[24:27], v[60:63]
    buffer_load_dwordx4 a[72:75], v2, s[12:15], s47 offen offset:0 sc1
    v_mfma_f32_16x16x32_bf16 v[64:67], a[84:87], a[0:3], v[64:67]
    v_mfma_f32_16x16x32_bf16 v[64:67], v[244:247], a[4:7], v[64:67]
    ds_write_b128 v5, v[196:199] offset:17408
    v_mfma_f32_16x16x32_bf16 v[144:147], a[84:87], a[4:7], v[144:147]
    v_mfma_f32_16x16x32_bf16 v[144:147], v[228:231], a[0:3], v[144:147]
    buffer_load_dwordx4 v[216:219], v2, s[12:15], s47 offen offset:1024 sc1
    v_mfma_f32_16x16x32_bf16 v[148:151], v[228:231], a[8:11], v[148:151]
    ds_write_b128 v5, v[200:203] offset:18432
    v_mfma_f32_16x16x32_bf16 v[148:151], a[84:87], a[12:15], v[148:151]
    v_mfma_f32_16x16x32_bf16 v[68:71], v[244:247], a[12:15], v[68:71]
    v_mfma_f32_16x16x32_bf16 v[68:71], a[84:87], a[8:11], v[68:71]
    s_waitcnt vmcnt(19)
    buffer_load_dwordx4 a[76:79], v2, s[12:15], s48 offen offset:0 sc1
    v_mfma_f32_16x16x32_bf16 v[72:75], a[84:87], a[16:19], v[72:75]
    ds_write_b128 v5, v[204:207] offset:19456
    v_mfma_f32_16x16x32_bf16 v[72:75], v[244:247], a[20:23], v[72:75]
    v_xor_b32 v240, s80, v232
    v_xor_b32 v241, s80, v233
    v_mfma_f32_16x16x32_bf16 v[152:155], a[84:87], a[20:23], v[152:155]
    v_xor_b32 v242, s80, v234
    v_xor_b32 v243, s80, v235
    v_mfma_f32_16x16x32_bf16 v[152:155], v[228:231], a[16:19], v[152:155]
    buffer_load_dwordx4 v[220:223], v2, s[12:15], s48 offen offset:1024 sc1
    v_mfma_f32_16x16x32_bf16 v[156:159], v[228:231], a[24:27], v[156:159]
    v_add_u32 v2, 10240, v2
    v_mfma_f32_16x16x32_bf16 v[156:159], a[84:87], a[28:31], v[156:159]
    v_mfma_f32_16x16x32_bf16 v[76:79], v[244:247], a[28:31], v[76:79]
    v_mfma_f32_16x16x32_bf16 v[76:79], a[84:87], a[24:27], v[76:79]
    s_waitcnt vmcnt(10) lgkmcnt(0)
    s_barrier
    v_mfma_f32_16x16x32_bf16 v[80:83], a[88:91], a[0:3], v[80:83]
    s_add_u32 m0, s65, 61920
    ds_read_b128 a[32:35], v6 offset:16384
    v_mov_b64 v[176:177], 0
    v_mfma_f32_16x16x32_bf16 v[80:83], v[240:243], a[4:7], v[80:83]
    buffer_load_dwordx4 v1, s[8:11], s50 offen lds
    v_mfma_f32_16x16x32_bf16 v[160:163], a[88:91], a[4:7], v[160:163]
    ds_read_b128 a[36:39], v6 offset:17408
    v_mov_b64 v[178:179], 0
    v_mfma_f32_16x16x32_bf16 v[160:163], v[232:235], a[0:3], v[160:163]
    ds_read_b128 a[40:43], v6 offset:20480
    v_mov_b64 v[180:181], 0
    v_mfma_f32_16x16x32_bf16 v[164:167], v[232:235], a[8:11], v[164:167]
    s_add_u32 m0, s66, 61920
    ds_read_b128 a[44:47], v6 offset:21504
    v_mov_b64 v[182:183], 0
    v_mfma_f32_16x16x32_bf16 v[164:167], a[88:91], a[12:15], v[164:167]
    buffer_load_dwordx4 v1, s[8:11], s51 offen lds
    v_mfma_f32_16x16x32_bf16 v[84:87], v[240:243], a[12:15], v[84:87]
    s_waitcnt vmcnt(10)
    ds_read_b128 a[48:51], v6 offset:24576
    v_mov_b64 v[184:185], 0
    v_mfma_f32_16x16x32_bf16 v[84:87], a[88:91], a[8:11], v[84:87]
    s_add_u32 m0, s67, 61920
    ds_read_b128 a[52:55], v6 offset:25600
    v_xor_b32 v244, s80, v236
    v_mfma_f32_16x16x32_bf16 v[88:91], a[88:91], a[16:19], v[88:91]
    buffer_load_dwordx4 v1, s[8:11], s52 offen lds
    v_mfma_f32_16x16x32_bf16 v[88:91], v[240:243], a[20:23], v[88:91]
    ds_read_b128 a[56:59], v6 offset:28672
    v_xor_b32 v245, s80, v237
    v_mfma_f32_16x16x32_bf16 v[168:171], a[88:91], a[20:23], v[168:171]
    ds_read_b128 a[60:63], v6 offset:29696
    v_xor_b32 v246, s80, v238
    v_mfma_f32_16x16x32_bf16 v[168:171], v[232:235], a[16:19], v[168:171]
    s_add_u32 m0, s68, 61920
    ds_read_b64_tr_b16 a[96:97], v3 offset:0
    v_xor_b32 v247, s80, v239
    v_mfma_f32_16x16x32_bf16 v[172:175], v[232:235], a[24:27], v[172:175]
    buffer_load_dwordx4 v1, s[8:11], s53 offen lds
    v_mfma_f32_16x16x32_bf16 v[172:175], a[88:91], a[28:31], v[172:175]
    ds_read_b64_tr_b16 a[98:99], v4 offset:0
    v_mov_b64 v[186:187], 0
    v_mfma_f32_16x16x32_bf16 v[92:95], v[240:243], a[28:31], v[92:95]
    s_add_u32 m0, s69, 61920
    ds_read_b64_tr_b16 a[100:101], v3 offset:1024
    v_mov_b64 v[188:189], 0
    v_mfma_f32_16x16x32_bf16 v[92:95], a[88:91], a[24:27], v[92:95]
    s_waitcnt lgkmcnt(3)
    buffer_load_dwordx4 v1, s[8:11], s54 offen lds
    v_mfma_f32_16x16x32_bf16 v[16:19], a[92:95], a[32:35], v[16:19]
    ds_read_b64_tr_b16 a[102:103], v4 offset:1024
    v_mov_b64 v[190:191], 0
    v_mfma_f32_16x16x32_bf16 v[16:19], v[244:247], a[36:39], v[16:19]
    s_add_u32 m0, s70, 61920
    ds_read_b64_tr_b16 a[104:105], v3 offset:128
    v_mfma_f32_16x16x32_bf16 v[96:99], a[92:95], a[36:39], v[96:99]
    buffer_load_dwordx4 v1, s[8:11], s55 offen lds
    v_mfma_f32_16x16x32_bf16 v[96:99], v[236:239], a[32:35], v[96:99]
    ds_read_b64_tr_b16 a[106:107], v4 offset:128
    v_mfma_f32_16x16x32_bf16 v[100:103], v[236:239], a[40:43], v[100:103]
    s_waitcnt lgkmcnt(2)
    ds_read_b64_tr_b16 a[108:109], v3 offset:1152
    v_smfmac_f32_16x16x64_bf16 v[176:179], a[128:131], a[96:103], v250
    s_add_u32 m0, s71, 61920
    ds_read_b64_tr_b16 a[110:111], v4 offset:1152
    v_mfma_f32_16x16x32_bf16 v[100:103], a[92:95], a[44:47], v[100:103]
    buffer_load_dwordx4 v1, s[8:11], s56 offen lds
    v_mfma_f32_16x16x32_bf16 v[20:23], v[244:247], a[44:47], v[20:23]
    ds_read_b64_tr_b16 a[112:113], v3 offset:256
    v_mfma_f32_16x16x32_bf16 v[20:23], a[92:95], a[40:43], v[20:23]
    s_add_u32 m0, s72, 61920
    ds_read_b64_tr_b16 a[114:115], v4 offset:256
    v_mfma_f32_16x16x32_bf16 v[24:27], a[92:95], a[48:51], v[24:27]
    s_waitcnt vmcnt(13)
    buffer_load_dwordx4 v1, s[8:11], s57 offen lds
    v_mfma_f32_16x16x32_bf16 v[24:27], v[244:247], a[52:55], v[24:27]
    s_waitcnt lgkmcnt(2)
    ds_read_b64_tr_b16 a[116:117], v3 offset:1280
    v_xor_b32 v240, s80, v208
    v_smfmac_f32_16x16x64_bf16 v[180:183], a[128:131], a[104:111], v250
    ds_read_b64_tr_b16 a[118:119], v4 offset:1280
    v_xor_b32 v241, s80, v209
    v_mfma_f32_16x16x32_bf16 v[104:107], a[92:95], a[52:55], v[104:107]
    s_add_u32 m0, s73, 61920
    ds_read_b64_tr_b16 a[120:121], v3 offset:384
    v_xor_b32 v242, s80, v210
    v_mfma_f32_16x16x32_bf16 v[104:107], v[236:239], a[48:51], v[104:107]
    buffer_load_dwordx4 v1, s[8:11], s58 offen lds
    v_mfma_f32_16x16x32_bf16 v[108:111], v[236:239], a[56:59], v[108:111]
    ds_read_b64_tr_b16 a[122:123], v4 offset:384
    v_xor_b32 v243, s80, v211
    v_mfma_f32_16x16x32_bf16 v[108:111], a[92:95], a[60:63], v[108:111]
    s_add_u32 m0, s74, 61920
    ds_read_b64_tr_b16 a[124:125], v3 offset:1408
    v_mfma_f32_16x16x32_bf16 v[28:31], v[244:247], a[60:63], v[28:31]
    s_waitcnt lgkmcnt(3)
    buffer_load_dwordx4 v1, s[8:11], s59 offen lds
    v_smfmac_f32_16x16x64_bf16 v[184:187], a[128:131], a[112:119], v250
    ds_read_b64_tr_b16 a[126:127], v4 offset:1408
    v_cvt_pk_bf16_f32 v192, v176, v180
    v_mfma_f32_16x16x32_bf16 v[28:31], a[92:95], a[56:59], v[28:31]
    ds_read_b64_tr_b16 a[96:97], v3 offset:2048
    v_cvt_pk_bf16_f32 v196, v177, v181
    v_mfma_f32_16x16x32_bf16 v[32:35], a[64:67], a[32:35], v[32:35]
    s_add_u32 m0, s75, 61920
    ds_read_b64_tr_b16 a[98:99], v4 offset:2048
    v_cvt_pk_bf16_f32 v200, v178, v182
    v_mfma_f32_16x16x32_bf16 v[32:35], v[240:243], a[36:39], v[32:35]
    buffer_load_dwordx4 v1, s[8:11], s60 offen lds
    v_mfma_f32_16x16x32_bf16 v[112:115], a[64:67], a[36:39], v[112:115]
    s_add_u32 m0, s76, 61920
    ds_read_b64_tr_b16 a[100:101], v3 offset:3072
    v_cvt_pk_bf16_f32 v204, v179, v183
    v_mfma_f32_16x16x32_bf16 v[112:115], v[208:211], a[32:35], v[112:115]
    s_waitcnt lgkmcnt(3)
    ds_read_b64_tr_b16 a[102:103], v4 offset:3072
    v_mov_b64 v[176:177], 0
    v_smfmac_f32_16x16x64_bf16 v[188:191], a[128:131], a[120:127], v250
    buffer_load_dwordx4 v1, s[8:11], s61 offen lds
    v_mfma_f32_16x16x32_bf16 v[116:119], v[208:211], a[40:43], v[116:119]
    ds_read_b64_tr_b16 a[104:105], v3 offset:2176
    v_mov_b64 v[178:179], 0
    v_mfma_f32_16x16x32_bf16 v[116:119], a[64:67], a[44:47], v[116:119]
    ds_read_b64_tr_b16 a[106:107], v4 offset:2176
    v_mov_b64 v[180:181], 0
    v_mfma_f32_16x16x32_bf16 v[36:39], v[240:243], a[44:47], v[36:39]
    s_add_u32 m0, s77, 61920
    ds_read_b64_tr_b16 a[108:109], v3 offset:3200
    v_mov_b64 v[182:183], 0
    v_mfma_f32_16x16x32_bf16 v[36:39], a[64:67], a[40:43], v[36:39]
    s_waitcnt vmcnt(16)
    buffer_load_dwordx4 v1, s[8:11], s62 offen lds
    v_mfma_f32_16x16x32_bf16 v[40:43], a[64:67], a[48:51], v[40:43]
    s_waitcnt lgkmcnt(3)
    ds_read_b64_tr_b16 a[110:111], v4 offset:3200
    v_cvt_pk_bf16_f32 v193, v184, v188
    v_smfmac_f32_16x16x64_bf16 v[176:179], a[128:131], a[96:103], v250
    s_add_u32 m0, s78, 61920
    ds_read_b64_tr_b16 a[112:113], v3 offset:2304
    v_cvt_pk_bf16_f32 v197, v185, v189
    v_mfma_f32_16x16x32_bf16 v[40:43], v[240:243], a[52:55], v[40:43]
    buffer_load_dwordx4 v1, s[8:11], s63 offen lds
    v_xor_b32 v246, s80, v214
    v_mfma_f32_16x16x32_bf16 v[120:123], a[64:67], a[52:55], v[120:123]
    ds_read_b64_tr_b16 a[114:115], v4 offset:2304
    v_cvt_pk_bf16_f32 v201, v186, v190
    v_xor_b32 v247, s80, v215
    v_mfma_f32_16x16x32_bf16 v[120:123], v[208:211], a[48:51], v[120:123]
    s_add_u32 m0, s79, 61920
    ds_read_b64_tr_b16 a[116:117], v3 offset:3328
    v_cvt_pk_bf16_f32 v205, v187, v191
    v_mfma_f32_16x16x32_bf16 v[124:127], v[208:211], a[56:59], v[124:127]
    buffer_load_dwordx4 v1, s[8:11], s64 offen lds
    v_mfma_f32_16x16x32_bf16 v[124:127], a[64:67], a[60:63], v[124:127]
    s_waitcnt lgkmcnt(3)
    ds_read_b64_tr_b16 a[118:119], v4 offset:3328
    v_add_u32 v1, 0x10000, v1
    v_smfmac_f32_16x16x64_bf16 v[180:183], a[128:131], a[104:111], v250
    ds_read_b64_tr_b16 a[120:121], v3 offset:2432
    v_xor_b32 v244, s80, v212
    v_mfma_f32_16x16x32_bf16 v[44:47], v[240:243], a[60:63], v[44:47]
    ds_read_b64_tr_b16 a[122:123], v4 offset:2432
    v_xor_b32 v245, s80, v213
    v_mfma_f32_16x16x32_bf16 v[44:47], a[64:67], a[56:59], v[44:47]
    buffer_load_dwordx4 a[80:83], v2, s[12:15], s44 offen offset:0 sc1
    v_mfma_f32_16x16x32_bf16 v[48:51], a[68:71], a[32:35], v[48:51]
    ds_read_b64_tr_b16 a[124:125], v3 offset:3456
    v_mov_b64 v[184:185], 0
    v_mfma_f32_16x16x32_bf16 v[48:51], v[244:247], a[36:39], v[48:51]
    ds_read_b64_tr_b16 a[126:127], v4 offset:3456
    v_mov_b64 v[186:187], 0
    v_mfma_f32_16x16x32_bf16 v[128:131], a[68:71], a[36:39], v[128:131]
    s_waitcnt lgkmcnt(4)
    buffer_load_dwordx4 v[224:227], v2, s[12:15], s44 offen offset:1024 sc1
    v_smfmac_f32_16x16x64_bf16 v[184:187], a[128:131], a[112:119], v250
    v_cvt_pk_bf16_f32 v194, v176, v180
    v_cvt_pk_bf16_f32 v198, v177, v181
    v_mfma_f32_16x16x32_bf16 v[128:131], v[212:215], a[32:35], v[128:131]
    v_cvt_pk_bf16_f32 v202, v178, v182
    v_cvt_pk_bf16_f32 v206, v179, v183
    v_mfma_f32_16x16x32_bf16 v[132:135], v[212:215], a[40:43], v[132:135]
    v_mov_b64 v[188:189], 0
    v_mov_b64 v[190:191], 0
    v_mfma_f32_16x16x32_bf16 v[132:135], a[68:71], a[44:47], v[132:135]
    buffer_load_dwordx4 a[84:87], v2, s[12:15], s45 offen offset:0 sc1
    v_mfma_f32_16x16x32_bf16 v[52:55], v[244:247], a[44:47], v[52:55]
    v_mfma_f32_16x16x32_bf16 v[52:55], a[68:71], a[40:43], v[52:55]
    s_waitcnt lgkmcnt(0)
    v_smfmac_f32_16x16x64_bf16 v[188:191], a[128:131], a[120:127], v250
    s_waitcnt vmcnt(20)
    buffer_load_dwordx4 v[228:231], v2, s[12:15], s45 offen offset:1024 sc1
    v_mfma_f32_16x16x32_bf16 v[56:59], a[68:71], a[48:51], v[56:59]
    v_xor_b32 v240, s80, v216
    v_xor_b32 v241, s80, v217
    v_mfma_f32_16x16x32_bf16 v[56:59], v[244:247], a[52:55], v[56:59]
    v_xor_b32 v242, s80, v218
    v_xor_b32 v243, s80, v219
    v_mfma_f32_16x16x32_bf16 v[136:139], a[68:71], a[52:55], v[136:139]
    v_mfma_f32_16x16x32_bf16 v[136:139], v[212:215], a[48:51], v[136:139]
    buffer_load_dwordx4 a[88:91], v2, s[12:15], s46 offen offset:0 sc1
    v_mfma_f32_16x16x32_bf16 v[140:143], v[212:215], a[56:59], v[140:143]
    v_cvt_pk_bf16_f32 v195, v184, v188
    v_cvt_pk_bf16_f32 v199, v185, v189
    v_mfma_f32_16x16x32_bf16 v[140:143], a[68:71], a[60:63], v[140:143]
    v_cvt_pk_bf16_f32 v203, v186, v190
    v_cvt_pk_bf16_f32 v207, v187, v191
    v_mfma_f32_16x16x32_bf16 v[60:63], v[244:247], a[60:63], v[60:63]
    buffer_load_dwordx4 v[232:235], v2, s[12:15], s46 offen offset:1024 sc1
    v_mfma_f32_16x16x32_bf16 v[60:63], a[68:71], a[56:59], v[60:63]
    ds_write_b128 v5, v[192:195] offset:0
    v_mfma_f32_16x16x32_bf16 v[64:67], a[72:75], a[32:35], v[64:67]
    v_mfma_f32_16x16x32_bf16 v[64:67], v[240:243], a[36:39], v[64:67]
    buffer_load_dwordx4 a[92:95], v2, s[12:15], s47 offen offset:0 sc1
    v_mfma_f32_16x16x32_bf16 v[144:147], a[72:75], a[36:39], v[144:147]
    ds_write_b128 v5, v[196:199] offset:1024
    v_mfma_f32_16x16x32_bf16 v[144:147], v[216:219], a[32:35], v[144:147]
    v_mfma_f32_16x16x32_bf16 v[148:151], v[216:219], a[40:43], v[148:151]
    v_mfma_f32_16x16x32_bf16 v[148:151], a[72:75], a[44:47], v[148:151]
    buffer_load_dwordx4 v[236:239], v2, s[12:15], s47 offen offset:1024 sc1
    v_mfma_f32_16x16x32_bf16 v[68:71], v[240:243], a[44:47], v[68:71]
    ds_write_b128 v5, v[200:203] offset:2048
    v_mfma_f32_16x16x32_bf16 v[68:71], a[72:75], a[40:43], v[68:71]
    s_waitcnt vmcnt(23)
    v_xor_b32 v244, s80, v220
    v_xor_b32 v245, s80, v221
    v_mfma_f32_16x16x32_bf16 v[72:75], a[72:75], a[48:51], v[72:75]
    buffer_load_dwordx4 a[64:67], v2, s[12:15], s48 offen offset:0 sc1
    v_mfma_f32_16x16x32_bf16 v[72:75], v[240:243], a[52:55], v[72:75]
    ds_write_b128 v5, v[204:207] offset:3072
    v_mfma_f32_16x16x32_bf16 v[152:155], a[72:75], a[52:55], v[152:155]
    v_xor_b32 v246, s80, v222
    v_xor_b32 v247, s80, v223
    v_mfma_f32_16x16x32_bf16 v[152:155], v[216:219], a[48:51], v[152:155]
    v_mfma_f32_16x16x32_bf16 v[156:159], v[216:219], a[56:59], v[156:159]
    buffer_load_dwordx4 v[208:211], v2, s[12:15], s48 offen offset:1024 sc1
    v_mfma_f32_16x16x32_bf16 v[156:159], a[72:75], a[60:63], v[156:159]
    v_add_u32 v2, 10240, v2
    v_mfma_f32_16x16x32_bf16 v[76:79], v[240:243], a[60:63], v[76:79]
    v_mfma_f32_16x16x32_bf16 v[76:79], a[72:75], a[56:59], v[76:79]
    s_waitcnt vmcnt(10) lgkmcnt(0)
    s_barrier
    v_mfma_f32_16x16x32_bf16 v[80:83], a[76:79], a[32:35], v[80:83]
    ds_read_b128 a[0:3], v6 offset:0
    v_mov_b64 v[176:177], 0
    v_mfma_f32_16x16x32_bf16 v[80:83], v[244:247], a[36:39], v[80:83]
    s_mov_b32 s97, 655360
    buffer_load_dwordx4 a[248:251], v14, s[8:11], s97 offen
    v_mfma_f32_16x16x32_bf16 v[160:163], a[76:79], a[36:39], v[160:163]
    ds_read_b128 a[4:7], v6 offset:1024
    v_mov_b64 v[178:179], 0
    v_mfma_f32_16x16x32_bf16 v[160:163], v[220:223], a[32:35], v[160:163]
    ds_read_b128 a[8:11], v6 offset:4096
    v_mov_b64 v[180:181], 0
    v_mfma_f32_16x16x32_bf16 v[164:167], v[220:223], a[40:43], v[164:167]
    s_mov_b32 s97, 720896
    buffer_load_dwordx4 a[248:251], v14, s[8:11], s97 offen
    v_mfma_f32_16x16x32_bf16 v[164:167], a[76:79], a[44:47], v[164:167]
    ds_read_b128 a[12:15], v6 offset:5120
    v_mov_b64 v[182:183], 0
    v_mfma_f32_16x16x32_bf16 v[84:87], v[244:247], a[44:47], v[84:87]
    ds_read_b128 a[16:19], v6 offset:8192
    v_mov_b64 v[184:185], 0
    v_mfma_f32_16x16x32_bf16 v[84:87], a[76:79], a[40:43], v[84:87]
    s_waitcnt vmcnt(10)
    s_mov_b32 s97, 786432
    buffer_load_dwordx4 a[248:251], v14, s[8:11], s97 offen
    v_mfma_f32_16x16x32_bf16 v[88:91], a[76:79], a[48:51], v[88:91]
    ds_read_b128 a[20:23], v6 offset:9216
    v_xor_b32 v240, s80, v224
    v_mfma_f32_16x16x32_bf16 v[88:91], v[244:247], a[52:55], v[88:91]
    s_mov_b32 m0, s65
    ds_read_b128 a[24:27], v6 offset:12288
    v_xor_b32 v241, s80, v225
    v_mfma_f32_16x16x32_bf16 v[168:171], a[76:79], a[52:55], v[168:171]
    buffer_load_dwordx4 v1, s[8:11], s50 offen lds
    v_mfma_f32_16x16x32_bf16 v[168:171], v[220:223], a[48:51], v[168:171]
    ds_read_b128 a[28:31], v6 offset:13312
    v_xor_b32 v242, s80, v226
    v_mfma_f32_16x16x32_bf16 v[172:175], v[220:223], a[56:59], v[172:175]
    s_mov_b32 m0, s66
    ds_read_b64_tr_b16 a[96:97], v3 offset:61920
    v_xor_b32 v243, s80, v227
    v_mfma_f32_16x16x32_bf16 v[172:175], a[76:79], a[60:63], v[172:175]
    buffer_load_dwordx4 v1, s[8:11], s51 offen lds
    v_mfma_f32_16x16x32_bf16 v[92:95], v[244:247], a[60:63], v[92:95]
    s_mov_b32 m0, s67
    ds_read_b64_tr_b16 a[98:99], v4 offset:61920
    v_mov_b64 v[186:187], 0
    v_mfma_f32_16x16x32_bf16 v[92:95], a[76:79], a[56:59], v[92:95]
    s_waitcnt lgkmcnt(2)
    ds_read_b64_tr_b16 a[100:101], v3 offset:62944
    v_mov_b64 v[188:189], 0
    v_mfma_f32_16x16x32_bf16 v[16:19], a[80:83], a[0:3], v[16:19]
    buffer_load_dwordx4 v1, s[8:11], s52 offen lds
    v_mfma_f32_16x16x32_bf16 v[16:19], v[240:243], a[4:7], v[16:19]
    ds_read_b64_tr_b16 a[102:103], v4 offset:62944
    v_mov_b64 v[190:191], 0
    v_mfma_f32_16x16x32_bf16 v[96:99], a[80:83], a[4:7], v[96:99]
    s_mov_b32 m0, s68
    ds_read_b64_tr_b16 a[104:105], v3 offset:62048
    v_mfma_f32_16x16x32_bf16 v[96:99], v[224:227], a[0:3], v[96:99]
    buffer_load_dwordx4 v1, s[8:11], s53 offen lds
    v_mfma_f32_16x16x32_bf16 v[100:103], v[224:227], a[8:11], v[100:103]
    s_waitcnt lgkmcnt(1)
    ds_read_b64_tr_b16 a[106:107], v4 offset:62048
    v_smfmac_f32_16x16x64_bf16 v[176:179], a[128:131], a[96:103], v250
    ds_read_b64_tr_b16 a[108:109], v3 offset:63072
    v_mfma_f32_16x16x32_bf16 v[100:103], a[80:83], a[12:15], v[100:103]
    s_mov_b32 m0, s69
    ds_read_b64_tr_b16 a[110:111], v4 offset:63072
    v_mfma_f32_16x16x32_bf16 v[20:23], v[240:243], a[12:15], v[20:23]
    buffer_load_dwordx4 v1, s[8:11], s54 offen lds
    v_mfma_f32_16x16x32_bf16 v[20:23], a[80:83], a[8:11], v[20:23]
    s_waitcnt vmcnt(14)
    ds_read_b64_tr_b16 a[112:113], v3 offset:62176
    v_mfma_f32_16x16x32_bf16 v[24:27], a[80:83], a[16:19], v[24:27]
    s_mov_b32 m0, s70
    ds_read_b64_tr_b16 a[114:115], v4 offset:62176
    v_mfma_f32_16x16x32_bf16 v[24:27], v[240:243], a[20:23], v[24:27]
    s_waitcnt lgkmcnt(2)
    buffer_load_dwordx4 v1, s[8:11], s55 offen lds
    v_smfmac_f32_16x16x64_bf16 v[180:183], a[128:131], a[104:111], v250
    ds_read_b64_tr_b16 a[116:117], v3 offset:63200
    v_xor_b32 v244, s80, v228
    v_mfma_f32_16x16x32_bf16 v[104:107], a[80:83], a[20:23], v[104:107]
    s_mov_b32 m0, s71
    ds_read_b64_tr_b16 a[118:119], v4 offset:63200
    v_xor_b32 v245, s80, v229
    v_mfma_f32_16x16x32_bf16 v[104:107], v[224:227], a[16:19], v[104:107]
    buffer_load_dwordx4 v1, s[8:11], s56 offen lds
    v_mfma_f32_16x16x32_bf16 v[108:111], v[224:227], a[24:27], v[108:111]
    ds_read_b64_tr_b16 a[120:121], v3 offset:62304
    v_xor_b32 v246, s80, v230
    v_mfma_f32_16x16x32_bf16 v[108:111], a[80:83], a[28:31], v[108:111]
    s_mov_b32 m0, s72
    ds_read_b64_tr_b16 a[122:123], v4 offset:62304
    v_xor_b32 v247, s80, v231
    v_mfma_f32_16x16x32_bf16 v[28:31], v[240:243], a[28:31], v[28:31]
    s_waitcnt lgkmcnt(2)
    buffer_load_dwordx4 v1, s[8:11], s57 offen lds
    v_smfmac_f32_16x16x64_bf16 v[184:187], a[128:131], a[112:119], v250
    ds_read_b64_tr_b16 a[124:125], v3 offset:63328
    v_cvt_pk_bf16_f32 v192, v176, v180
    v_mfma_f32_16x16x32_bf16 v[28:31], a[80:83], a[24:27], v[28:31]
    s_mov_b32 m0, s73
    ds_read_b64_tr_b16 a[126:127], v4 offset:63328
    v_cvt_pk_bf16_f32 v196, v177, v181
    v_mfma_f32_16x16x32_bf16 v[32:35], a[84:87], a[0:3], v[32:35]
    buffer_load_dwordx4 v1, s[8:11], s58 offen lds
    v_mfma_f32_16x16x32_bf16 v[32:35], v[244:247], a[4:7], v[32:35]
    ds_read_b64_tr_b16 a[96:97], v3 offset:63968
    v_cvt_pk_bf16_f32 v200, v178, v182
    v_mfma_f32_16x16x32_bf16 v[112:115], a[84:87], a[4:7], v[112:115]
    s_mov_b32 m0, s74
    ds_read_b64_tr_b16 a[98:99], v4 offset:63968
    v_cvt_pk_bf16_f32 v204, v179, v183
    v_mfma_f32_16x16x32_bf16 v[112:115], v[228:231], a[0:3], v[112:115]
    s_waitcnt lgkmcnt(2)
    buffer_load_dwordx4 v1, s[8:11], s59 offen lds
    v_smfmac_f32_16x16x64_bf16 v[188:191], a[128:131], a[120:127], v250
    ds_read_b64_tr_b16 a[100:101], v3 offset:64992
    v_mov_b64 v[176:177], 0
    v_mfma_f32_16x16x32_bf16 v[116:119], v[228:231], a[8:11], v[116:119]
    s_mov_b32 m0, s75
    ds_read_b64_tr_b16 a[102:103], v4 offset:64992
    v_mov_b64 v[178:179], 0
    v_mfma_f32_16x16x32_bf16 v[116:119], a[84:87], a[12:15], v[116:119]
    buffer_load_dwordx4 v1, s[8:11], s60 offen lds
    v_mfma_f32_16x16x32_bf16 v[36:39], v[244:247], a[12:15], v[36:39]
    ds_read_b64_tr_b16 a[104:105], v3 offset:64096
    v_mov_b64 v[180:181], 0
    v_mfma_f32_16x16x32_bf16 v[36:39], a[84:87], a[8:11], v[36:39]
    s_mov_b32 m0, s76
    ds_read_b64_tr_b16 a[106:107], v4 offset:64096
    v_mov_b64 v[182:183], 0
    v_mfma_f32_16x16x32_bf16 v[40:43], a[84:87], a[16:19], v[40:43]
    s_waitcnt lgkmcnt(2)
    buffer_load_dwordx4 v1, s[8:11], s61 offen lds
    v_smfmac_f32_16x16x64_bf16 v[176:179], a[128:131], a[96:103], v250
    s_waitcnt vmcnt(19)
    ds_read_b64_tr_b16 a[108:109], v3 offset:65120
    v_cvt_pk_bf16_f32 v193, v184, v188
    v_mfma_f32_16x16x32_bf16 v[40:43], v[244:247], a[20:23], v[40:43]
    s_mov_b32 m0, s77
    ds_read_b64_tr_b16 a[110:111], v4 offset:65120
    v_cvt_pk_bf16_f32 v197, v185, v189
    v_mfma_f32_16x16x32_bf16 v[120:123], a[84:87], a[20:23], v[120:123]
    buffer_load_dwordx4 v1, s[8:11], s62 offen lds
    v_xor_b32 v242, s80, v234
    v_mfma_f32_16x16x32_bf16 v[120:123], v[228:231], a[16:19], v[120:123]
    ds_read_b64_tr_b16 a[112:113], v3 offset:64224
    v_cvt_pk_bf16_f32 v201, v186, v190
    v_xor_b32 v243, s80, v235
    v_mfma_f32_16x16x32_bf16 v[124:127], v[228:231], a[24:27], v[124:127]
    s_mov_b32 m0, s78
    ds_read_b64_tr_b16 a[114:115], v4 offset:64224
    v_cvt_pk_bf16_f32 v205, v187, v191
    v_mfma_f32_16x16x32_bf16 v[124:127], a[84:87], a[28:31], v[124:127]
    s_waitcnt lgkmcnt(2)
    buffer_load_dwordx4 v1, s[8:11], s63 offen lds
    v_smfmac_f32_16x16x64_bf16 v[180:183], a[128:131], a[104:111], v250
    ds_read_b64_tr_b16 a[116:117], v3 offset:65248
    v_xor_b32 v240, s80, v232
    v_mov_b64 v[186:187], 0
    v_mfma_f32_16x16x32_bf16 v[44:47], v[244:247], a[28:31], v[44:47]
    s_mov_b32 m0, s79
    ds_read_b64_tr_b16 a[118:119], v4 offset:65248
    v_xor_b32 v241, s80, v233
    v_mfma_f32_16x16x32_bf16 v[44:47], a[84:87], a[24:27], v[44:47]
    buffer_load_dwordx4 v1, s[8:11], s64 offen lds
    v_mfma_f32_16x16x32_bf16 v[48:51], a[88:91], a[0:3], v[48:51]
    ds_read_b64_tr_b16 a[120:121], v3 offset:64352
    v_add_u32 v1, 0x10000, v1
    v_mfma_f32_16x16x32_bf16 v[48:51], v[240:243], a[4:7], v[48:51]
    ds_read_b64_tr_b16 a[122:123], v4 offset:64352
    v_mov_b64 v[184:185], 0
    v_mfma_f32_16x16x32_bf16 v[128:131], a[88:91], a[4:7], v[128:131]
    s_waitcnt lgkmcnt(2)
    buffer_load_dwordx4 a[68:71], v2, s[12:15], s44 offen offset:0 sc1
    v_smfmac_f32_16x16x64_bf16 v[184:187], a[128:131], a[112:119], v250
    ds_read_b64_tr_b16 a[124:125], v3 offset:65376
    v_cvt_pk_bf16_f32 v194, v176, v180
    v_mfma_f32_16x16x32_bf16 v[128:131], v[232:235], a[0:3], v[128:131]
    ds_read_b64_tr_b16 a[126:127], v4 offset:65376
    v_cvt_pk_bf16_f32 v198, v177, v181
    v_mfma_f32_16x16x32_bf16 v[132:135], v[232:235], a[8:11], v[132:135]
    buffer_load_dwordx4 v[212:215], v2, s[12:15], s44 offen offset:1024 sc1
    v_mfma_f32_16x16x32_bf16 v[132:135], a[88:91], a[12:15], v[132:135]
    v_cvt_pk_bf16_f32 v202, v178, v182
    v_cvt_pk_bf16_f32 v206, v179, v183
    v_mfma_f32_16x16x32_bf16 v[52:55], v[240:243], a[12:15], v[52:55]
    v_mov_b64 v[188:189], 0
    v_mov_b64 v[190:191], 0
    v_mfma_f32_16x16x32_bf16 v[52:55], a[88:91], a[8:11], v[52:55]
    s_waitcnt lgkmcnt(0)
    buffer_load_dwordx4 a[72:75], v2, s[12:15], s45 offen offset:0 sc1
    v_smfmac_f32_16x16x64_bf16 v[188:191], a[128:131], a[120:127], v250
    s_waitcnt vmcnt(23)
    v_xor_b32 v244, s80, v236
    v_xor_b32 v245, s80, v237
    v_mfma_f32_16x16x32_bf16 v[56:59], a[88:91], a[16:19], v[56:59]
    v_xor_b32 v246, s80, v238
    v_xor_b32 v247, s80, v239
    v_mfma_f32_16x16x32_bf16 v[56:59], v[240:243], a[20:23], v[56:59]
    v_mfma_f32_16x16x32_bf16 v[136:139], a[88:91], a[20:23], v[136:139]
L_pad5:
    s_cbranch_execz L_back
    buffer_load_dwordx4 v[216:219], v2, s[12:15], s45 offen offset:1024 sc1
    v_mfma_f32_16x16x32_bf16 v[136:139], v[232:235], a[16:19], v[136:139]
    v_mfma_f32_16x16x32_bf16 v[140:143], v[232:235], a[24:27], v[140:143]
    v_cvt_pk_bf16_f32 v195, v184, v188
    v_cvt_pk_bf16_f32 v199, v185, v189
    v_mfma_f32_16x16x32_bf16 v[140:143], a[88:91], a[28:31], v[140:143]
    buffer_load_dwordx4 a[76:79], v2, s[12:15], s46 offen offset:0 sc1
    v_mfma_f32_16x16x32_bf16 v[60:63], v[240:243], a[28:31], v[60:63]
    v_cvt_pk_bf16_f32 v203, v186, v190
    v_cvt_pk_bf16_f32 v207, v187, v191
    v_mfma_f32_16x16x32_bf16 v[60:63], a[88:91], a[24:27], v[60:63]
    ds_write_b128 v5, v[192:195] offset:16384
    v_mfma_f32_16x16x32_bf16 v[64:67], a[92:95], a[0:3], v[64:67]
    buffer_load_dwordx4 v[220:223], v2, s[12:15], s46 offen offset:1024 sc1
    v_mfma_f32_16x16x32_bf16 v[64:67], v[244:247], a[4:7], v[64:67]
    v_mfma_f32_16x16x32_bf16 v[144:147], a[92:95], a[4:7], v[144:147]
    ds_write_b128 v5, v[196:199] offset:17408
    v_mfma_f32_16x16x32_bf16 v[144:147], v[236:239], a[0:3], v[144:147]
    buffer_load_dwordx4 a[80:83], v2, s[12:15], s47 offen offset:0 sc1
    v_mfma_f32_16x16x32_bf16 v[148:151], v[236:239], a[8:11], v[148:151]
    v_mfma_f32_16x16x32_bf16 v[148:151], a[92:95], a[12:15], v[148:151]
    ds_write_b128 v5, v[200:203] offset:18432
    v_mfma_f32_16x16x32_bf16 v[68:71], v[244:247], a[12:15], v[68:71]
    buffer_load_dwordx4 v[224:227], v2, s[12:15], s47 offen offset:1024 sc1
    v_mfma_f32_16x16x32_bf16 v[68:71], a[92:95], a[8:11], v[68:71]
    s_waitcnt vmcnt(26)
    v_xor_b32 v240, s80, v208
    v_xor_b32 v241, s80, v209
    v_mfma_f32_16x16x32_bf16 v[72:75], a[92:95], a[16:19], v[72:75]
    ds_write_b128 v5, v[204:207] offset:19456
    v_mfma_f32_16x16x32_bf16 v[72:75], v[244:247], a[20:23], v[72:75]
    buffer_load_dwordx4 a[84:87], v2, s[12:15], s48 offen offset:0 sc1
    v_mfma_f32_16x16x32_bf16 v[152:155], a[92:95], a[20:23], v[152:155]
    v_xor_b32 v242, s80, v210
    v_xor_b32 v243, s80, v211
    v_mfma_f32_16x16x32_bf16 v[152:155], v[236:239], a[16:19], v[152:155]
    v_mfma_f32_16x16x32_bf16 v[156:159], v[236:239], a[24:27], v[156:159]
    buffer_load_dwordx4 v[228:231], v2, s[12:15], s48 offen offset:1024 sc1
    v_mfma_f32_16x16x32_bf16 v[156:159], a[92:95], a[28:31], v[156:159]
    v_add_u32 v2, 10240, v2
    v_mfma_f32_16x16x32_bf16 v[76:79], v[244:247], a[28:31], v[76:79]
    v_mfma_f32_16x16x32_bf16 v[76:79], a[92:95], a[24:27], v[76:79]
    s_waitcnt vmcnt(10) lgkmcnt(0)
    s_barrier
    v_mfma_f32_16x16x32_bf16 v[80:83], a[64:67], a[0:3], v[80:83]
    s_add_u32 m0, s65, 61920
    ds_read_b128 a[32:35], v6 offset:16384
    v_mov_b64 v[176:177], 0
    v_mfma_f32_16x16x32_bf16 v[80:83], v[240:243], a[4:7], v[80:83]
    buffer_load_dwordx4 v1, s[8:11], s50 offen lds
    v_mfma_f32_16x16x32_bf16 v[160:163], a[64:67], a[4:7], v[160:163]
    ds_read_b128 a[36:39], v6 offset:17408
    v_mov_b64 v[178:179], 0
    v_mfma_f32_16x16x32_bf16 v[160:163], v[208:211], a[0:3], v[160:163]
    ds_read_b128 a[40:43], v6 offset:20480
    v_mov_b64 v[180:181], 0
    v_mfma_f32_16x16x32_bf16 v[164:167], v[208:211], a[8:11], v[164:167]
    s_add_u32 m0, s66, 61920
    ds_read_b128 a[44:47], v6 offset:21504
    v_mov_b64 v[182:183], 0
    v_mfma_f32_16x16x32_bf16 v[164:167], a[64:67], a[12:15], v[164:167]
    buffer_load_dwordx4 v1, s[8:11], s51 offen lds
    v_mfma_f32_16x16x32_bf16 v[84:87], v[240:243], a[12:15], v[84:87]
    s_waitcnt vmcnt(10)
    ds_read_b128 a[48:51], v6 offset:24576
    v_mov_b64 v[184:185], 0
    v_mfma_f32_16x16x32_bf16 v[84:87], a[64:67], a[8:11], v[84:87]
    s_add_u32 m0, s67, 61920
    ds_read_b128 a[52:55], v6 offset:25600
    v_xor_b32 v244, s80, v212
    v_mfma_f32_16x16x32_bf16 v[88:91], a[64:67], a[16:19], v[88:91]
    buffer_load_dwordx4 v1, s[8:11], s52 offen lds
    v_mfma_f32_16x16x32_bf16 v[88:91], v[240:243], a[20:23], v[88:91]
    ds_read_b128 a[56:59], v6 offset:28672
    v_xor_b32 v245, s80, v213
    v_mfma_f32_16x16x32_bf16 v[168:171], a[64:67], a[20:23], v[168:171]
    ds_read_b128 a[60:63], v6 offset:29696
    v_xor_b32 v246, s80, v214
    v_mfma_f32_16x16x32_bf16 v[168:171], v[208:211], a[16:19], v[168:171]
    s_add_u32 m0, s68, 61920
    ds_read_b64_tr_b16 a[96:97], v3 offset:0
    v_xor_b32 v247, s80, v215
    v_mfma_f32_16x16x32_bf16 v[172:175], v[208:211], a[24:27], v[172:175]
    buffer_load_dwordx4 v1, s[8:11], s53 offen lds
    v_mfma_f32_16x16x32_bf16 v[172:175], a[64:67], a[28:31], v[172:175]
    ds_read_b64_tr_b16 a[98:99], v4 offset:0
    v_mov_b64 v[186:187], 0
    v_mfma_f32_16x16x32_bf16 v[92:95], v[240:243], a[28:31], v[92:95]
    s_add_u32 m0, s69, 61920
    ds_read_b64_tr_b16 a[100:101], v3 offset:1024
    v_mov_b64 v[188:189], 0
    v_mfma_f32_16x16x32_bf16 v[92:95], a[64:67], a[24:27], v[92:95]
    s_waitcnt lgkmcnt(3)
    buffer_load_dwordx4 v1, s[8:11], s54 offen lds
    v_mfma_f32_16x16x32_bf16 v[16:19], a[68:71], a[32:35], v[16:19]
    ds_read_b64_tr_b16 a[102:103], v4 offset:1024
    v_mov_b64 v[190:191], 0
    v_mfma_f32_16x16x32_bf16 v[16:19], v[244:247], a[36:39], v[16:19]
    s_add_u32 m0, s70, 61920
    ds_read_b64_tr_b16 a[104:105], v3 offset:128
    v_mfma_f32_16x16x32_bf16 v[96:99], a[68:71], a[36:39], v[96:99]
    buffer_load_dwordx4 v1, s[8:11], s55 offen lds
    v_mfma_f32_16x16x32_bf16 v[96:99], v[212:215], a[32:35], v[96:99]
    ds_read_b64_tr_b16 a[106:107], v4 offset:128
    v_mfma_f32_16x16x32_bf16 v[100:103], v[212:215], a[40:43], v[100:103]
    s_waitcnt lgkmcnt(2)
    ds_read_b64_tr_b16 a[108:109], v3 offset:1152
    v_smfmac_f32_16x16x64_bf16 v[176:179], a[128:131], a[96:103], v250
    s_add_u32 m0, s71, 61920
    ds_read_b64_tr_b16 a[110:111], v4 offset:1152
    v_mfma_f32_16x16x32_bf16 v[100:103], a[68:71], a[44:47], v[100:103]
    buffer_load_dwordx4 v1, s[8:11], s56 offen lds
    v_mfma_f32_16x16x32_bf16 v[20:23], v[244:247], a[44:47], v[20:23]
    ds_read_b64_tr_b16 a[112:113], v3 offset:256
    v_mfma_f32_16x16x32_bf16 v[20:23], a[68:71], a[40:43], v[20:23]
    s_add_u32 m0, s72, 61920
    ds_read_b64_tr_b16 a[114:115], v4 offset:256
    v_mfma_f32_16x16x32_bf16 v[24:27], a[68:71], a[48:51], v[24:27]
    s_waitcnt vmcnt(13)
    buffer_load_dwordx4 v1, s[8:11], s57 offen lds
    v_mfma_f32_16x16x32_bf16 v[24:27], v[244:247], a[52:55], v[24:27]
    s_waitcnt lgkmcnt(2)
    ds_read_b64_tr_b16 a[116:117], v3 offset:1280
    v_xor_b32 v240, s80, v216
    v_smfmac_f32_16x16x64_bf16 v[180:183], a[128:131], a[104:111], v250
    ds_read_b64_tr_b16 a[118:119], v4 offset:1280
    v_xor_b32 v241, s80, v217
    v_mfma_f32_16x16x32_bf16 v[104:107], a[68:71], a[52:55], v[104:107]
    s_add_u32 m0, s73, 61920
    ds_read_b64_tr_b16 a[120:121], v3 offset:384
    v_xor_b32 v242, s80, v218
    v_mfma_f32_16x16x32_bf16 v[104:107], v[212:215], a[48:51], v[104:107]
    buffer_load_dwordx4 v1, s[8:11], s58 offen lds
    v_mfma_f32_16x16x32_bf16 v[108:111], v[212:215], a[56:59], v[108:111]
    ds_read_b64_tr_b16 a[122:123], v4 offset:384
    v_xor_b32 v243, s80, v219
    v_mfma_f32_16x16x32_bf16 v[108:111], a[68:71], a[60:63], v[108:111]
    s_add_u32 m0, s74, 61920
    ds_read_b64_tr_b16 a[124:125], v3 offset:1408
    v_mfma_f32_16x16x32_bf16 v[28:31], v[244:247], a[60:63], v[28:31]
    s_waitcnt lgkmcnt(3)
    buffer_load_dwordx4 v1, s[8:11], s59 offen lds
    v_smfmac_f32_16x16x64_bf16 v[184:187], a[128:131], a[112:119], v250
    ds_read_b64_tr_b16 a[126:127], v4 offset:1408
    v_cvt_pk_bf16_f32 v192, v176, v180
    v_mfma_f32_16x16x32_bf16 v[28:31], a[68:71], a[56:59], v[28:31]
    ds_read_b64_tr_b16 a[96:97], v3 offset:2048
    v_cvt_pk_bf16_f32 v196, v177, v181
    v_mfma_f32_16x16x32_bf16 v[32:35], a[72:75], a[32:35], v[32:35]
    s_add_u32 m0, s75, 61920
    ds_read_b64_tr_b16 a[98:99], v4 offset:2048
    v_cvt_pk_bf16_f32 v200, v178, v182
    v_mfma_f32_16x16x32_bf16 v[32:35], v[240:243], a[36:39], v[32:35]
    buffer_load_dwordx4 v1, s[8:11], s60 offen lds
    v_mfma_f32_16x16x32_bf16 v[112:115], a[72:75], a[36:39], v[112:115]
    s_add_u32 m0, s76, 61920
    ds_read_b64_tr_b16 a[100:101], v3 offset:3072
    v_cvt_pk_bf16_f32 v204, v179, v183
    v_mfma_f32_16x16x32_bf16 v[112:115], v[216:219], a[32:35], v[112:115]
    s_waitcnt lgkmcnt(3)
    ds_read_b64_tr_b16 a[102:103], v4 offset:3072
    v_mov_b64 v[176:177], 0
    v_smfmac_f32_16x16x64_bf16 v[188:191], a[128:131], a[120:127], v250
    buffer_load_dwordx4 v1, s[8:11], s61 offen lds
    v_mfma_f32_16x16x32_bf16 v[116:119], v[216:219], a[40:43], v[116:119]
    ds_read_b64_tr_b16 a[104:105], v3 offset:2176
    v_mov_b64 v[178:179], 0
    v_mfma_f32_16x16x32_bf16 v[116:119], a[72:75], a[44:47], v[116:119]
    ds_read_b64_tr_b16 a[106:107], v4 offset:2176
    v_mov_b64 v[180:181], 0
    v_mfma_f32_16x16x32_bf16 v[36:39], v[240:243], a[44:47], v[36:39]
    s_add_u32 m0, s77, 61920
    ds_read_b64_tr_b16 a[108:109], v3 offset:3200
    v_mov_b64 v[182:183], 0
    v_mfma_f32_16x16x32_bf16 v[36:39], a[72:75], a[40:43], v[36:39]
    s_waitcnt vmcnt(16)
    buffer_load_dwordx4 v1, s[8:11], s62 offen lds
    v_mfma_f32_16x16x32_bf16 v[40:43], a[72:75], a[48:51], v[40:43]
    s_waitcnt lgkmcnt(3)
    ds_read_b64_tr_b16 a[110:111], v4 offset:3200
    v_cvt_pk_bf16_f32 v193, v184, v188
    v_smfmac_f32_16x16x64_bf16 v[176:179], a[128:131], a[96:103], v250
    s_add_u32 m0, s78, 61920
    ds_read_b64_tr_b16 a[112:113], v3 offset:2304
    v_cvt_pk_bf16_f32 v197, v185, v189
    v_mfma_f32_16x16x32_bf16 v[40:43], v[240:243], a[52:55], v[40:43]
    buffer_load_dwordx4 v1, s[8:11], s63 offen lds
    v_xor_b32 v246, s80, v222
    v_mfma_f32_16x16x32_bf16 v[120:123], a[72:75], a[52:55], v[120:123]
    ds_read_b64_tr_b16 a[114:115], v4 offset:2304
    v_cvt_pk_bf16_f32 v201, v186, v190
    v_xor_b32 v247, s80, v223
    v_mfma_f32_16x16x32_bf16 v[120:123], v[216:219], a[48:51], v[120:123]
    s_add_u32 m0, s79, 61920
    ds_read_b64_tr_b16 a[116:117], v3 offset:3328
    v_cvt_pk_bf16_f32 v205, v187, v191
    v_mfma_f32_16x16x32_bf16 v[124:127], v[216:219], a[56:59], v[124:127]
    buffer_load_dwordx4 v1, s[8:11], s64 offen lds
    v_mfma_f32_16x16x32_bf16 v[124:127], a[72:75], a[60:63], v[124:127]
    s_waitcnt lgkmcnt(3)
    ds_read_b64_tr_b16 a[118:119], v4 offset:3328
    v_add_u32 v1, 0x10000, v1
    v_smfmac_f32_16x16x64_bf16 v[180:183], a[128:131], a[104:111], v250
    ds_read_b64_tr_b16 a[120:121], v3 offset:2432
    v_xor_b32 v244, s80, v220
    v_mfma_f32_16x16x32_bf16 v[44:47], v[240:243], a[60:63], v[44:47]
    ds_read_b64_tr_b16 a[122:123], v4 offset:2432
    v_xor_b32 v245, s80, v221
    v_mfma_f32_16x16x32_bf16 v[44:47], a[72:75], a[56:59], v[44:47]
    buffer_load_dwordx4 a[88:91], v2, s[12:15], s44 offen offset:0 sc1
    v_mfma_f32_16x16x32_bf16 v[48:51], a[76:79], a[32:35], v[48:51]
    ds_read_b64_tr_b16 a[124:125], v3 offset:3456
    v_mov_b64 v[184:185], 0
    v_mfma_f32_16x16x32_bf16 v[48:51], v[244:247], a[36:39], v[48:51]
    ds_read_b64_tr_b16 a[126:127], v4 offset:3456
    v_mov_b64 v[186:187], 0
    v_mfma_f32_16x16x32_bf16 v[128:131], a[76:79], a[36:39], v[128:131]
    s_waitcnt lgkmcnt(4)
    buffer_load_dwordx4 v[232:235], v2, s[12:15], s44 offen offset:1024 sc1
    v_smfmac_f32_16x16x64_bf16 v[184:187], a[128:131], a[112:119], v250
    v_cvt_pk_bf16_f32 v194, v176, v180
    v_cvt_pk_bf16_f32 v198, v177, v181
    v_mfma_f32_16x16x32_bf16 v[128:131], v[220:223], a[32:35], v[128:131]
    v_cvt_pk_bf16_f32 v202, v178, v182
    v_cvt_pk_bf16_f32 v206, v179, v183
    v_mfma_f32_16x16x32_bf16 v[132:135], v[220:223], a[40:43], v[132:135]
    v_mov_b64 v[188:189], 0
    v_mov_b64 v[190:191], 0
    v_mfma_f32_16x16x32_bf16 v[132:135], a[76:79], a[44:47], v[132:135]
    buffer_load_dwordx4 a[92:95], v2, s[12:15], s45 offen offset:0 sc1
    v_mfma_f32_16x16x32_bf16 v[52:55], v[244:247], a[44:47], v[52:55]
    v_mfma_f32_16x16x32_bf16 v[52:55], a[76:79], a[40:43], v[52:55]
    s_waitcnt lgkmcnt(0)
    v_smfmac_f32_16x16x64_bf16 v[188:191], a[128:131], a[120:127], v250
    s_waitcnt vmcnt(20)
    buffer_load_dwordx4 v[236:239], v2, s[12:15], s45 offen offset:1024 sc1
    v_mfma_f32_16x16x32_bf16 v[56:59], a[76:79], a[48:51], v[56:59]
    v_xor_b32 v240, s80, v224
    v_xor_b32 v241, s80, v225
    v_mfma_f32_16x16x32_bf16 v[56:59], v[244:247], a[52:55], v[56:59]
    v_xor_b32 v242, s80, v226
    v_xor_b32 v243, s80, v227
    v_mfma_f32_16x16x32_bf16 v[136:139], a[76:79], a[52:55], v[136:139]
    v_mfma_f32_16x16x32_bf16 v[136:139], v[220:223], a[48:51], v[136:139]
    buffer_load_dwordx4 a[64:67], v2, s[12:15], s46 offen offset:0 sc1
    v_mfma_f32_16x16x32_bf16 v[140:143], v[220:223], a[56:59], v[140:143]
    v_cvt_pk_bf16_f32 v195, v184, v188
    v_cvt_pk_bf16_f32 v199, v185, v189
    v_mfma_f32_16x16x32_bf16 v[140:143], a[76:79], a[60:63], v[140:143]
    v_cvt_pk_bf16_f32 v203, v186, v190
    v_cvt_pk_bf16_f32 v207, v187, v191
    v_mfma_f32_16x16x32_bf16 v[60:63], v[244:247], a[60:63], v[60:63]
    buffer_load_dwordx4 v[208:211], v2, s[12:15], s46 offen offset:1024 sc1
    v_mfma_f32_16x16x32_bf16 v[60:63], a[76:79], a[56:59], v[60:63]
    ds_write_b128 v5, v[192:195] offset:0
    v_mfma_f32_16x16x32_bf16 v[64:67], a[80:83], a[32:35], v[64:67]
    v_mfma_f32_16x16x32_bf16 v[64:67], v[240:243], a[36:39], v[64:67]
    buffer_load_dwordx4 a[68:71], v2, s[12:15], s47 offen offset:0 sc1
    v_mfma_f32_16x16x32_bf16 v[144:147], a[80:83], a[36:39], v[144:147]
    ds_write_b128 v5, v[196:199] offset:1024
    v_mfma_f32_16x16x32_bf16 v[144:147], v[224:227], a[32:35], v[144:147]
    v_mfma_f32_16x16x32_bf16 v[148:151], v[224:227], a[40:43], v[148:151]
    v_mfma_f32_16x16x32_bf16 v[148:151], a[80:83], a[44:47], v[148:151]
    buffer_load_dwordx4 v[212:215], v2, s[12:15], s47 offen offset:1024 sc1
    v_mfma_f32_16x16x32_bf16 v[68:71], v[240:243], a[44:47], v[68:71]
    ds_write_b128 v5, v[200:203] offset:2048
    v_mfma_f32_16x16x32_bf16 v[68:71], a[80:83], a[40:43], v[68:71]
    s_waitcnt vmcnt(23)
    v_xor_b32 v244, s80, v228
    v_xor_b32 v245, s80, v229
    v_mfma_f32_16x16x32_bf16 v[72:75], a[80:83], a[48:51], v[72:75]
    buffer_load_dwordx4 a[72:75], v2, s[12:15], s48 offen offset:0 sc1
    v_mfma_f32_16x16x32_bf16 v[72:75], v[240:243], a[52:55], v[72:75]
    ds_write_b128 v5, v[204:207] offset:3072
    v_mfma_f32_16x16x32_bf16 v[152:155], a[80:83], a[52:55], v[152:155]
    v_xor_b32 v246, s80, v230
    v_xor_b32 v247, s80, v231
    v_mfma_f32_16x16x32_bf16 v[152:155], v[224:227], a[48:51], v[152:155]
    v_mfma_f32_16x16x32_bf16 v[156:159], v[224:227], a[56:59], v[156:159]
    buffer_load_dwordx4 v[216:219], v2, s[12:15], s48 offen offset:1024 sc1
    v_mfma_f32_16x16x32_bf16 v[156:159], a[80:83], a[60:63], v[156:159]
    v_add_u32 v2, 10240, v2
    v_mfma_f32_16x16x32_bf16 v[76:79], v[240:243], a[60:63], v[76:79]
    v_mfma_f32_16x16x32_bf16 v[76:79], a[80:83], a[56:59], v[76:79]
    s_waitcnt vmcnt(10) lgkmcnt(0)
    s_barrier
    v_mfma_f32_16x16x32_bf16 v[80:83], a[84:87], a[32:35], v[80:83]
    s_mov_b32 m0, s65
    ds_read_b128 a[0:3], v6 offset:0
    v_mov_b64 v[176:177], 0
    v_mfma_f32_16x16x32_bf16 v[80:83], v[244:247], a[36:39], v[80:83]
    buffer_load_dwordx4 v1, s[8:11], s50 offen lds
    v_mfma_f32_16x16x32_bf16 v[160:163], a[84:87], a[36:39], v[160:163]
    ds_read_b128 a[4:7], v6 offset:1024
    v_mov_b64 v[178:179], 0
    v_mfma_f32_16x16x32_bf16 v[160:163], v[228:231], a[32:35], v[160:163]
    ds_read_b128 a[8:11], v6 offset:4096
    v_mov_b64 v[180:181], 0
    v_mfma_f32_16x16x32_bf16 v[164:167], v[228:231], a[40:43], v[164:167]
    s_mov_b32 m0, s66
    ds_read_b128 a[12:15], v6 offset:5120
    v_mov_b64 v[182:183], 0
    v_mfma_f32_16x16x32_bf16 v[164:167], a[84:87], a[44:47], v[164:167]
    buffer_load_dwordx4 v1, s[8:11], s51 offen lds
    v_mfma_f32_16x16x32_bf16 v[84:87], v[244:247], a[44:47], v[84:87]
    s_waitcnt vmcnt(10)
    ds_read_b128 a[16:19], v6 offset:8192
    v_mov_b64 v[184:185], 0
    v_mfma_f32_16x16x32_bf16 v[84:87], a[84:87], a[40:43], v[84:87]
    s_mov_b32 m0, s67
    ds_read_b128 a[20:23], v6 offset:9216
    v_xor_b32 v240, s80, v232
    v_mfma_f32_16x16x32_bf16 v[88:91], a[84:87], a[48:51], v[88:91]
    buffer_load_dwordx4 v1, s[8:11], s52 offen lds
    v_mfma_f32_16x16x32_bf16 v[88:91], v[244:247], a[52:55], v[88:91]
    ds_read_b128 a[24:27], v6 offset:12288
    v_xor_b32 v241, s80, v233
    v_mfma_f32_16x16x32_bf16 v[168:171], a[84:87], a[52:55], v[168:171]
    ds_read_b128 a[28:31], v6 offset:13312
    v_xor_b32 v242, s80, v234
    v_mfma_f32_16x16x32_bf16 v[168:171], v[228:231], a[48:51], v[168:171]
    s_mov_b32 m0, s68
    ds_read_b64_tr_b16 a[96:97], v3 offset:61920
    v_xor_b32 v243, s80, v235
    v_mfma_f32_16x16x32_bf16 v[172:175], v[228:231], a[56:59], v[172:175]
    buffer_load_dwordx4 v1, s[8:11], s53 offen lds
    v_mfma_f32_16x16x32_bf16 v[172:175], a[84:87], a[60:63], v[172:175]
    ds_read_b64_tr_b16 a[98:99], v4 offset:61920
    v_mov_b64 v[186:187], 0
    v_mfma_f32_16x16x32_bf16 v[92:95], v[244:247], a[60:63], v[92:95]
    s_mov_b32 m0, s69
    ds_read_b64_tr_b16 a[100:101], v3 offset:62944
    v_mov_b64 v[188:189], 0
    v_mfma_f32_16x16x32_bf16 v[92:95], a[84:87], a[56:59], v[92:95]
    s_waitcnt lgkmcnt(3)
    buffer_load_dwordx4 v1, s[8:11], s54 offen lds
    v_mfma_f32_16x16x32_bf16 v[16:19], a[88:91], a[0:3], v[16:19]
    ds_read_b64_tr_b16 a[102:103], v4 offset:62944
    v_mov_b64 v[190:191], 0
    v_mfma_f32_16x16x32_bf16 v[16:19], v[240:243], a[4:7], v[16:19]
    s_mov_b32 m0, s70
    ds_read_b64_tr_b16 a[104:105], v3 offset:62048
    v_mfma_f32_16x16x32_bf16 v[96:99], a[88:91], a[4:7], v[96:99]
    buffer_load_dwordx4 v1, s[8:11], s55 offen lds
    v_mfma_f32_16x16x32_bf16 v[96:99], v[232:235], a[0:3], v[96:99]
    ds_read_b64_tr_b16 a[106:107], v4 offset:62048
    v_mfma_f32_16x16x32_bf16 v[100:103], v[232:235], a[8:11], v[100:103]
    s_waitcnt lgkmcnt(2)
    ds_read_b64_tr_b16 a[108:109], v3 offset:63072
    v_smfmac_f32_16x16x64_bf16 v[176:179], a[128:131], a[96:103], v250
    s_mov_b32 m0, s71
    ds_read_b64_tr_b16 a[110:111], v4 offset:63072
    v_mfma_f32_16x16x32_bf16 v[100:103], a[88:91], a[12:15], v[100:103]
    buffer_load_dwordx4 v1, s[8:11], s56 offen lds
    v_mfma_f32_16x16x32_bf16 v[20:23], v[240:243], a[12:15], v[20:23]
    ds_read_b64_tr_b16 a[112:113], v3 offset:62176
    v_mfma_f32_16x16x32_bf16 v[20:23], a[88:91], a[8:11], v[20:23]
    s_mov_b32 m0, s72
    ds_read_b64_tr_b16 a[114:115], v4 offset:62176
    v_mfma_f32_16x16x32_bf16 v[24:27], a[88:91], a[16:19], v[24:27]
    s_waitcnt vmcnt(13)
    buffer_load_dwordx4 v1, s[8:11], s57 offen lds
    v_mfma_f32_16x16x32_bf16 v[24:27], v[240:243], a[20:23], v[24:27]
    s_waitcnt lgkmcnt(2)
    ds_read_b64_tr_b16 a[116:117], v3 offset:63200
    v_xor_b32 v244, s80, v236
    v_smfmac_f32_16x16x64_bf16 v[180:183], a[128:131], a[104:111], v250
    ds_read_b64_tr_b16 a[118:119], v4 offset:63200
    v_xor_b32 v245, s80, v237
    v_mfma_f32_16x16x32_bf16 v[104:107], a[88:91], a[20:23], v[104:107]
    s_mov_b32 m0, s73
    ds_read_b64_tr_b16 a[120:121], v3 offset:62304
    v_xor_b32 v246, s80, v238
    v_mfma_f32_16x16x32_bf16 v[104:107], v[232:235], a[16:19], v[104:107]
    buffer_load_dwordx4 v1, s[8:11], s58 offen lds
    v_mfma_f32_16x16x32_bf16 v[108:111], v[232:235], a[24:27], v[108:111]
    ds_read_b64_tr_b16 a[122:123], v4 offset:62304
    v_xor_b32 v247, s80, v239
    v_mfma_f32_16x16x32_bf16 v[108:111], a[88:91], a[28:31], v[108:111]
    s_mov_b32 m0, s74
    ds_read_b64_tr_b16 a[124:125], v3 offset:63328
    v_mfma_f32_16x16x32_bf16 v[28:31], v[240:243], a[28:31], v[28:31]
    s_waitcnt lgkmcnt(3)
    buffer_load_dwordx4 v1, s[8:11], s59 offen lds
    v_smfmac_f32_16x16x64_bf16 v[184:187], a[128:131], a[112:119], v250
    ds_read_b64_tr_b16 a[126:127], v4 offset:63328
    v_cvt_pk_bf16_f32 v192, v176, v180
    v_mfma_f32_16x16x32_bf16 v[28:31], a[88:91], a[24:27], v[28:31]
    ds_read_b64_tr_b16 a[96:97], v3 offset:63968
    v_cvt_pk_bf16_f32 v196, v177, v181
    v_mfma_f32_16x16x32_bf16 v[32:35], a[92:95], a[0:3], v[32:35]
    s_mov_b32 m0, s75
    ds_read_b64_tr_b16 a[98:99], v4 offset:63968
    v_cvt_pk_bf16_f32 v200, v178, v182
    v_mfma_f32_16x16x32_bf16 v[32:35], v[244:247], a[4:7], v[32:35]
    buffer_load_dwordx4 v1, s[8:11], s60 offen lds
    v_mfma_f32_16x16x32_bf16 v[112:115], a[92:95], a[4:7], v[112:115]
    s_mov_b32 m0, s76
    ds_read_b64_tr_b16 a[100:101], v3 offset:64992
    v_cvt_pk_bf16_f32 v204, v179, v183
    v_mfma_f32_16x16x32_bf16 v[112:115], v[236:239], a[0:3], v[112:115]
    s_waitcnt lgkmcnt(3)
    ds_read_b64_tr_b16 a[102:103], v4 offset:64992
    v_mov_b64 v[176:177], 0
    v_smfmac_f32_16x16x64_bf16 v[188:191], a[128:131], a[120:127], v250
    buffer_load_dwordx4 v1, s[8:11], s61 offen lds
    v_mfma_f32_16x16x32_bf16 v[116:119], v[236:239], a[8:11], v[116:119]
    ds_read_b64_tr_b16 a[104:105], v3 offset:64096
    v_mov_b64 v[178:179], 0
    v_mfma_f32_16x16x32_bf16 v[116:119], a[92:95], a[12:15], v[116:119]
    ds_read_b64_tr_b16 a[106:107], v4 offset:64096
    v_mov_b64 v[180:181], 0
    v_mfma_f32_16x16x32_bf16 v[36:39], v[244:247], a[12:15], v[36:39]
    s_mov_b32 m0, s77
    ds_read_b64_tr_b16 a[108:109], v3 offset:65120
    v_mov_b64 v[182:183], 0
    v_mfma_f32_16x16x32_bf16 v[36:39], a[92:95], a[8:11], v[36:39]
    s_waitcnt vmcnt(16)
    buffer_load_dwordx4 v1, s[8:11], s62 offen lds
    v_mfma_f32_16x16x32_bf16 v[40:43], a[92:95], a[16:19], v[40:43]
    s_waitcnt lgkmcnt(3)
    ds_read_b64_tr_b16 a[110:111], v4 offset:65120
    v_cvt_pk_bf16_f32 v193, v184, v188
    v_smfmac_f32_16x16x64_bf16 v[176:179], a[128:131], a[96:103], v250
    s_mov_b32 m0, s78
    ds_read_b64_tr_b16 a[112:113], v3 offset:64224
    v_cvt_pk_bf16_f32 v197, v185, v189
    v_mfma_f32_16x16x32_bf16 v[40:43], v[244:247], a[20:23], v[40:43]
    buffer_load_dwordx4 v1, s[8:11], s63 offen lds
    v_xor_b32 v242, s80, v210
    v_mfma_f32_16x16x32_bf16 v[120:123], a[92:95], a[20:23], v[120:123]
    ds_read_b64_tr_b16 a[114:115], v4 offset:64224
    v_cvt_pk_bf16_f32 v201, v186, v190
    v_xor_b32 v243, s80, v211
    v_mfma_f32_16x16x32_bf16 v[120:123], v[236:239], a[16:19], v[120:123]
    s_mov_b32 m0, s79
    ds_read_b64_tr_b16 a[116:117], v3 offset:65248
    v_cvt_pk_bf16_f32 v205, v187, v191
    v_mfma_f32_16x16x32_bf16 v[124:127], v[236:239], a[24:27], v[124:127]
    buffer_load_dwordx4 v1, s[8:11], s64 offen lds
    v_mfma_f32_16x16x32_bf16 v[124:127], a[92:95], a[28:31], v[124:127]
    s_waitcnt lgkmcnt(3)
    ds_read_b64_tr_b16 a[118:119], v4 offset:65248
    v_add_u32 v1, 0x10000, v1
    v_smfmac_f32_16x16x64_bf16 v[180:183], a[128:131], a[104:111], v250
    ds_read_b64_tr_b16 a[120:121], v3 offset:64352
    v_xor_b32 v240, s80, v208
    v_mfma_f32_16x16x32_bf16 v[44:47], v[244:247], a[28:31], v[44:47]
    ds_read_b64_tr_b16 a[122:123], v4 offset:64352
    v_xor_b32 v241, s80, v209
    v_mfma_f32_16x16x32_bf16 v[44:47], a[92:95], a[24:27], v[44:47]
    buffer_load_dwordx4 a[76:79], v2, s[12:15], s44 offen offset:0 sc1
    v_mfma_f32_16x16x32_bf16 v[48:51], a[64:67], a[0:3], v[48:51]
    ds_read_b64_tr_b16 a[124:125], v3 offset:65376
    v_mov_b64 v[184:185], 0
    v_mfma_f32_16x16x32_bf16 v[48:51], v[240:243], a[4:7], v[48:51]
    ds_read_b64_tr_b16 a[126:127], v4 offset:65376
    v_mov_b64 v[186:187], 0
    v_mfma_f32_16x16x32_bf16 v[128:131], a[64:67], a[4:7], v[128:131]
    s_waitcnt lgkmcnt(4)
    buffer_load_dwordx4 v[220:223], v2, s[12:15], s44 offen offset:1024 sc1
    v_smfmac_f32_16x16x64_bf16 v[184:187], a[128:131], a[112:119], v250
    v_cvt_pk_bf16_f32 v194, v176, v180
    v_cvt_pk_bf16_f32 v198, v177, v181
    v_mfma_f32_16x16x32_bf16 v[128:131], v[208:211], a[0:3], v[128:131]
    v_cvt_pk_bf16_f32 v202, v178, v182
    v_cvt_pk_bf16_f32 v206, v179, v183
    v_mfma_f32_16x16x32_bf16 v[132:135], v[208:211], a[8:11], v[132:135]
    v_mov_b64 v[188:189], 0
    v_mov_b64 v[190:191], 0
    v_mfma_f32_16x16x32_bf16 v[132:135], a[64:67], a[12:15], v[132:135]
    buffer_load_dwordx4 a[80:83], v2, s[12:15], s45 offen offset:0 sc1
    v_mfma_f32_16x16x32_bf16 v[52:55], v[240:243], a[12:15], v[52:55]
    v_mfma_f32_16x16x32_bf16 v[52:55], a[64:67], a[8:11], v[52:55]
    s_waitcnt lgkmcnt(0)
    v_smfmac_f32_16x16x64_bf16 v[188:191], a[128:131], a[120:127], v250
    s_waitcnt vmcnt(20)
    buffer_load_dwordx4 v[224:227], v2, s[12:15], s45 offen offset:1024 sc1
    v_mfma_f32_16x16x32_bf16 v[56:59], a[64:67], a[16:19], v[56:59]
    v_xor_b32 v244, s80, v212
    v_xor_b32 v245, s80, v213
    v_mfma_f32_16x16x32_bf16 v[56:59], v[240:243], a[20:23], v[56:59]
    v_xor_b32 v246, s80, v214
    v_xor_b32 v247, s80, v215
    v_mfma_f32_16x16x32_bf16 v[136:139], a[64:67], a[20:23], v[136:139]
    v_mfma_f32_16x16x32_bf16 v[136:139], v[208:211], a[16:19], v[136:139]
    buffer_load_dwordx4 a[84:87], v2, s[12:15], s46 offen offset:0 sc1
    v_mfma_f32_16x16x32_bf16 v[140:143], v[208:211], a[24:27], v[140:143]
    v_cvt_pk_bf16_f32 v195, v184, v188
    v_cvt_pk_bf16_f32 v199, v185, v189
    v_mfma_f32_16x16x32_bf16 v[140:143], a[64:67], a[28:31], v[140:143]
    v_cvt_pk_bf16_f32 v203, v186, v190
    v_cvt_pk_bf16_f32 v207, v187, v191
    v_mfma_f32_16x16x32_bf16 v[60:63], v[240:243], a[28:31], v[60:63]
    buffer_load_dwordx4 v[228:231], v2, s[12:15], s46 offen offset:1024 sc1
    v_mfma_f32_16x16x32_bf16 v[60:63], a[64:67], a[24:27], v[60:63]
    ds_write_b128 v5, v[192:195] offset:16384
    v_mfma_f32_16x16x32_bf16 v[64:67], a[68:71], a[0:3], v[64:67]
    v_mfma_f32_16x16x32_bf16 v[64:67], v[244:247], a[4:7], v[64:67]
    buffer_load_dwordx4 a[88:91], v2, s[12:15], s47 offen offset:0 sc1
    v_mfma_f32_16x16x32_bf16 v[144:147], a[68:71], a[4:7], v[144:147]
    ds_write_b128 v5, v[196:199] offset:17408
    v_mfma_f32_16x16x32_bf16 v[144:147], v[212:215], a[0:3], v[144:147]
    v_mfma_f32_16x16x32_bf16 v[148:151], v[212:215], a[8:11], v[148:151]
    v_mfma_f32_16x16x32_bf16 v[148:151], a[68:71], a[12:15], v[148:151]
    buffer_load_dwordx4 v[232:235], v2, s[12:15], s47 offen offset:1024 sc1
    v_mfma_f32_16x16x32_bf16 v[68:71], v[244:247], a[12:15], v[68:71]
    ds_write_b128 v5, v[200:203] offset:18432
    v_mfma_f32_16x16x32_bf16 v[68:71], a[68:71], a[8:11], v[68:71]
    s_waitcnt vmcnt(23)
    v_xor_b32 v240, s80, v216
    v_xor_b32 v241, s80, v217
    v_mfma_f32_16x16x32_bf16 v[72:75], a[68:71], a[16:19], v[72:75]
    buffer_load_dwordx4 a[92:95], v2, s[12:15], s48 offen offset:0 sc1
    v_mfma_f32_16x16x32_bf16 v[72:75], v[244:247], a[20:23], v[72:75]
    ds_write_b128 v5, v[204:207] offset:19456
    v_mfma_f32_16x16x32_bf16 v[152:155], a[68:71], a[20:23], v[152:155]
    v_xor_b32 v242, s80, v218
    v_xor_b32 v243, s80, v219
    v_mfma_f32_16x16x32_bf16 v[152:155], v[212:215], a[16:19], v[152:155]
    v_mfma_f32_16x16x32_bf16 v[156:159], v[212:215], a[24:27], v[156:159]
    buffer_load_dwordx4 v[236:239], v2, s[12:15], s48 offen offset:1024 sc1
    v_mfma_f32_16x16x32_bf16 v[156:159], a[68:71], a[28:31], v[156:159]
    v_add_u32 v2, 10240, v2
    v_mfma_f32_16x16x32_bf16 v[76:79], v[244:247], a[28:31], v[76:79]
    v_mfma_f32_16x16x32_bf16 v[76:79], a[68:71], a[24:27], v[76:79]
    s_waitcnt vmcnt(10) lgkmcnt(0)
    s_barrier
    v_mfma_f32_16x16x32_bf16 v[80:83], a[72:75], a[0:3], v[80:83]
    ds_read_b128 a[32:35], v6 offset:16384
    v_mov_b64 v[176:177], 0
    v_mfma_f32_16x16x32_bf16 v[80:83], v[240:243], a[4:7], v[80:83]
    s_mov_b32 s97, 851968
    buffer_load_dwordx4 a[248:251], v14, s[8:11], s97 offen
    v_mfma_f32_16x16x32_bf16 v[160:163], a[72:75], a[4:7], v[160:163]
    ds_read_b128 a[36:39], v6 offset:17408
    v_mov_b64 v[178:179], 0
    v_mfma_f32_16x16x32_bf16 v[160:163], v[216:219], a[0:3], v[160:163]
    ds_read_b128 a[40:43], v6 offset:20480
    v_mov_b64 v[180:181], 0
    v_mfma_f32_16x16x32_bf16 v[164:167], v[216:219], a[8:11], v[164:167]
    s_mov_b32 s97, 917504
    buffer_load_dwordx4 a[248:251], v14, s[8:11], s97 offen
    v_mfma_f32_16x16x32_bf16 v[164:167], a[72:75], a[12:15], v[164:167]
    ds_read_b128 a[44:47], v6 offset:21504
    v_mov_b64 v[182:183], 0
    v_mfma_f32_16x16x32_bf16 v[84:87], v[240:243], a[12:15], v[84:87]
    ds_read_b128 a[48:51], v6 offset:24576
    v_mov_b64 v[184:185], 0
    v_mfma_f32_16x16x32_bf16 v[84:87], a[72:75], a[8:11], v[84:87]
    s_waitcnt vmcnt(10)
    s_mov_b32 s97, 983040
    buffer_load_dwordx4 a[248:251], v14, s[8:11], s97 offen
    v_mfma_f32_16x16x32_bf16 v[88:91], a[72:75], a[16:19], v[88:91]
    ds_read_b128 a[52:55], v6 offset:25600
    v_xor_b32 v244, s80, v220
    v_mfma_f32_16x16x32_bf16 v[88:91], v[240:243], a[20:23], v[88:91]
    s_add_u32 m0, s65, 61920
    ds_read_b128 a[56:59], v6 offset:28672
    v_xor_b32 v245, s80, v221
    v_mfma_f32_16x16x32_bf16 v[168:171], a[72:75], a[20:23], v[168:171]
    buffer_load_dwordx4 v1, s[8:11], s50 offen lds
    v_mfma_f32_16x16x32_bf16 v[168:171], v[216:219], a[16:19], v[168:171]
    ds_read_b128 a[60:63], v6 offset:29696
    v_xor_b32 v246, s80, v222
    v_mfma_f32_16x16x32_bf16 v[172:175], v[216:219], a[24:27], v[172:175]
    s_add_u32 m0, s66, 61920
    ds_read_b64_tr_b16 a[96:97], v3 offset:0
    v_xor_b32 v247, s80, v223
    v_mfma_f32_16x16x32_bf16 v[172:175], a[72:75], a[28:31], v[172:175]
    buffer_load_dwordx4 v1, s[8:11], s51 offen lds
    v_mfma_f32_16x16x32_bf16 v[92:95], v[240:243], a[28:31], v[92:95]
    s_add_u32 m0, s67, 61920
    ds_read_b64_tr_b16 a[98:99], v4 offset:0
    v_mov_b64 v[186:187], 0
    v_mfma_f32_16x16x32_bf16 v[92:95], a[72:75], a[24:27], v[92:95]
    s_waitcnt lgkmcnt(2)
    ds_read_b64_tr_b16 a[100:101], v3 offset:1024
    v_mov_b64 v[188:189], 0
    v_mfma_f32_16x16x32_bf16 v[16:19], a[76:79], a[32:35], v[16:19]
    buffer_load_dwordx4 v1, s[8:11], s52 offen lds
    v_mfma_f32_16x16x32_bf16 v[16:19], v[244:247], a[36:39], v[16:19]
L_pad6:
    s_cbranch_execz L_back
    ds_read_b64_tr_b16 a[102:103], v4 offset:1024
    v_mov_b64 v[190:191], 0
    v_mfma_f32_16x16x32_bf16 v[96:99], a[76:79], a[36:39], v[96:99]
    s_add_u32 m0, s68, 61920
    ds_read_b64_tr_b16 a[104:105], v3 offset:128
    v_mfma_f32_16x16x32_bf16 v[96:99], v[220:223], a[32:35], v[96:99]
    buffer_load_dwordx4 v1, s[8:11], s53 offen lds
    v_mfma_f32_16x16x32_bf16 v[100:103], v[220:223], a[40:43], v[100:103]
    s_waitcnt lgkmcnt(1)
    ds_read_b64_tr_b16 a[106:107], v4 offset:128
    v_smfmac_f32_16x16x64_bf16 v[176:179], a[128:131], a[96:103], v250
    ds_read_b64_tr_b16 a[108:109], v3 offset:1152
    v_mfma_f32_16x16x32_bf16 v[100:103], a[76:79], a[44:47], v[100:103]
    s_add_u32 m0, s69, 61920
    ds_read_b64_tr_b16 a[110:111], v4 offset:1152
    v_mfma_f32_16x16x32_bf16 v[20:23], v[244:247], a[44:47], v[20:23]
    buffer_load_dwordx4 v1, s[8:11], s54 offen lds
    v_mfma_f32_16x16x32_bf16 v[20:23], a[76:79], a[40:43], v[20:23]
    s_waitcnt vmcnt(14)
    ds_read_b64_tr_b16 a[112:113], v3 offset:256
    v_mfma_f32_16x16x32_bf16 v[24:27], a[76:79], a[48:51], v[24:27]
    s_add_u32 m0, s70, 61920
    ds_read_b64_tr_b16 a[114:115], v4 offset:256
    v_mfma_f32_16x16x32_bf16 v[24:27], v[244:247], a[52:55], v[24:27]
    s_waitcnt lgkmcnt(2)
    buffer_load_dwordx4 v1, s[8:11], s55 offen lds
    v_smfmac_f32_16x16x64_bf16 v[180:183], a[128:131], a[104:111], v250
    ds_read_b64_tr_b16 a[116:117], v3 offset:1280
    v_xor_b32 v240, s80, v224
    v_mfma_f32_16x16x32_bf16 v[104:107], a[76:79], a[52:55], v[104:107]
    s_add_u32 m0, s71, 61920
    ds_read_b64_tr_b16 a[118:119], v4 offset:1280
    v_xor_b32 v241, s80, v225
    v_mfma_f32_16x16x32_bf16 v[104:107], v[220:223], a[48:51], v[104:107]
    buffer_load_dwordx4 v1, s[8:11], s56 offen lds
    v_mfma_f32_16x16x32_bf16 v[108:111], v[220:223], a[56:59], v[108:111]
    ds_read_b64_tr_b16 a[120:121], v3 offset:384
    v_xor_b32 v242, s80, v226
    v_mfma_f32_16x16x32_bf16 v[108:111], a[76:79], a[60:63], v[108:111]
    s_add_u32 m0, s72, 61920
    ds_read_b64_tr_b16 a[122:123], v4 offset:384
    v_xor_b32 v243, s80, v227
    v_mfma_f32_16x16x32_bf16 v[28:31], v[244:247], a[60:63], v[28:31]
    s_waitcnt lgkmcnt(2)
    buffer_load_dwordx4 v1, s[8:11], s57 offen lds
    v_smfmac_f32_16x16x64_bf16 v[184:187], a[128:131], a[112:119], v250
    ds_read_b64_tr_b16 a[124:125], v3 offset:1408
    v_cvt_pk_bf16_f32 v192, v176, v180
    v_mfma_f32_16x16x32_bf16 v[28:31], a[76:79], a[56:59], v[28:31]
    s_add_u32 m0, s73, 61920
    ds_read_b64_tr_b16 a[126:127], v4 offset:1408
    v_cvt_pk_bf16_f32 v196, v177, v181
    v_mfma_f32_16x16x32_bf16 v[32:35], a[80:83], a[32:35], v[32:35]
    buffer_load_dwordx4 v1, s[8:11], s58 offen lds
    v_mfma_f32_16x16x32_bf16 v[32:35], v[240:243], a[36:39], v[32:35]
    ds_read_b64_tr_b16 a[96:97], v3 offset:2048
    v_cvt_pk_bf16_f32 v200, v178, v182
    v_mfma_f32_16x16x32_bf16 v[112:115], a[80:83], a[36:39], v[112:115]
    s_add_u32 m0, s74, 61920
    ds_read_b64_tr_b16 a[98:99], v4 offset:2048
    v_cvt_pk_bf16_f32 v204, v179, v183
    v_mfma_f32_16x16x32_bf16 v[112:115], v[224:227], a[32:35], v[112:115]
    s_waitcnt lgkmcnt(2)
    buffer_load_dwordx4 v1, s[8:11], s59 offen lds
    v_smfmac_f32_16x16x64_bf16 v[188:191], a[128:131], a[120:127], v250
    ds_read_b64_tr_b16 a[100:101], v3 offset:3072
    v_mov_b64 v[176:177], 0
    v_mfma_f32_16x16x32_bf16 v[116:119], v[224:227], a[40:43], v[116:119]
    s_add_u32 m0, s75, 61920
    ds_read_b64_tr_b16 a[102:103], v4 offset:3072
    v_mov_b64 v[178:179], 0
    v_mfma_f32_16x16x32_bf16 v[116:119], a[80:83], a[44:47], v[116:119]
    buffer_load_dwordx4 v1, s[8:11], s60 offen lds
    v_mfma_f32_16x16x32_bf16 v[36:39], v[240:243], a[44:47], v[36:39]
    ds_read_b64_tr_b16 a[104:105], v3 offset:2176
    v_mov_b64 v[180:181], 0
    v_mfma_f32_16x16x32_bf16 v[36:39], a[80:83], a[40:43], v[36:39]
    s_add_u32 m0, s76, 61920
    ds_read_b64_tr_b16 a[106:107], v4 offset:2176
    v_mov_b64 v[182:183], 0
    v_mfma_f32_16x16x32_bf16 v[40:43], a[80:83], a[48:51], v[40:43]
    s_waitcnt lgkmcnt(2)
    buffer_load_dwordx4 v1, s[8:11], s61 offen lds
    v_smfmac_f32_16x16x64_bf16 v[176:179], a[128:131], a[96:103], v250
    s_waitcnt vmcnt(19)
    ds_read_b64_tr_b16 a[108:109], v3 offset:3200
    v_cvt_pk_bf16_f32 v193, v184, v188
    v_mfma_f32_16x16x32_bf16 v[40:43], v[240:243], a[52:55], v[40:43]
    s_add_u32 m0, s77, 61920
    ds_read_b64_tr_b16 a[110:111], v4 offset:3200
    v_cvt_pk_bf16_f32 v197, v185, v189
    v_mfma_f32_16x16x32_bf16 v[120:123], a[80:83], a[52:55], v[120:123]
    buffer_load_dwordx4 v1, s[8:11], s62 offen lds
    v_xor_b32 v246, s80, v230
    v_mfma_f32_16x16x32_bf16 v[120:123], v[224:227], a[48:51], v[120:123]
    ds_read_b64_tr_b16 a[112:113], v3 offset:2304
    v_cvt_pk_bf16_f32 v201, v186, v190
    v_xor_b32 v247, s80, v231
    v_mfma_f32_16x16x32_bf16 v[124:127], v[224:227], a[56:59], v[124:127]
    s_add_u32 m0, s78, 61920
    ds_read_b64_tr_b16 a[114:115], v4 offset:2304
    v_cvt_pk_bf16_f32 v205, v187, v191
    v_mfma_f32_16x16x32_bf16 v[124:127], a[80:83], a[60:63], v[124:127]
    s_waitcnt lgkmcnt(2)
    buffer_load_dwordx4 v1, s[8:11], s63 offen lds
    v_smfmac_f32_16x16x64_bf16 v[180:183], a[128:131], a[104:111], v250
    ds_read_b64_tr_b16 a[116:117], v3 offset:3328
    v_xor_b32 v244, s80, v228
    v_mov_b64 v[186:187], 0
    v_mfma_f32_16x16x32_bf16 v[44:47], v[240:243], a[60:63], v[44:47]
    s_add_u32 m0, s79, 61920
    ds_read_b64_tr_b16 a[118:119], v4 offset:3328
    v_xor_b32 v245, s80, v229
    v_mfma_f32_16x16x32_bf16 v[44:47], a[80:83], a[56:59], v[44:47]
    buffer_load_dwordx4 v1, s[8:11], s64 offen lds
    v_mfma_f32_16x16x32_bf16 v[48:51], a[84:87], a[32:35], v[48:51]
    ds_read_b64_tr_b16 a[120:121], v3 offset:2432
    v_add_u32 v1, 0x10000, v1
    v_mfma_f32_16x16x32_bf16 v[48:51], v[244:247], a[36:39], v[48:51]
    ds_read_b64_tr_b16 a[122:123], v4 offset:2432
    v_mov_b64 v[184:185], 0
    v_mfma_f32_16x16x32_bf16 v[128:131], a[84:87], a[36:39], v[128:131]
    s_waitcnt lgkmcnt(2)
    buffer_load_dwordx4 a[64:67], v2, s[12:15], s44 offen offset:0 sc1
    v_smfmac_f32_16x16x64_bf16 v[184:187], a[128:131], a[112:119], v250
    ds_read_b64_tr_b16 a[124:125], v3 offset:3456
    v_cvt_pk_bf16_f32 v194, v176, v180
    v_mfma_f32_16x16x32_bf16 v[128:131], v[228:231], a[32:35], v[128:131]
    ds_read_b64_tr_b16 a[126:127], v4 offset:3456
    v_cvt_pk_bf16_f32 v198, v177, v181
    v_mfma_f32_16x16x32_bf16 v[132:135], v[228:231], a[40:43], v[132:135]
    buffer_load_dwordx4 v[208:211], v2, s[12:15], s44 offen offset:1024 sc1
    v_mfma_f32_16x16x32_bf16 v[132:135], a[84:87], a[44:47], v[132:135]
    v_cvt_pk_bf16_f32 v202, v178, v182
    v_cvt_pk_bf16_f32 v206, v179, v183
    v_mfma_f32_16x16x32_bf16 v[52:55], v[244:247], a[44:47], v[52:55]
    v_mov_b64 v[188:189], 0
    v_mov_b64 v[190:191], 0
    v_mfma_f32_16x16x32_bf16 v[52:55], a[84:87], a[40:43], v[52:55]
    s_waitcnt lgkmcnt(0)
    buffer_load_dwordx4 a[68:71], v2, s[12:15], s45 offen offset:0 sc1
    v_smfmac_f32_16x16x64_bf16 v[188:191], a[128:131], a[120:127], v250
    s_waitcnt vmcnt(23)
    v_xor_b32 v240, s80, v232
    v_xor_b32 v241, s80, v233
    v_mfma_f32_16x16x32_bf16 v[56:59], a[84:87], a[48:51], v[56:59]
    v_xor_b32 v242, s80, v234
    v_xor_b32 v243, s80, v235
    v_mfma_f32_16x16x32_bf16 v[56:59], v[244:247], a[52:55], v[56:59]
    v_mfma_f32_16x16x32_bf16 v[136:139], a[84:87], a[52:55], v[136:139]
    buffer_load_dwordx4 v[212:215], v2, s[12:15], s45 offen offset:1024 sc1
    v_mfma_f32_16x16x32_bf16 v[136:139], v[228:231], a[48:51], v[136:139]
    v_mfma_f32_16x16x32_bf16 v[140:143], v[228:231], a[56:59], v[140:143]
    v_cvt_pk_bf16_f32 v195, v184, v188
    v_cvt_pk_bf16_f32 v199, v185, v189
    v_mfma_f32_16x16x32_bf16 v[140:143], a[84:87], a[60:63], v[140:143]
    buffer_load_dwordx4 a[72:75], v2, s[12:15], s46 offen offset:0 sc1
    v_mfma_f32_16x16x32_bf16 v[60:63], v[244:247], a[60:63], v[60:63]
    v_cvt_pk_bf16_f32 v203, v186, v190
    v_cvt_pk_bf16_f32 v207, v187, v191
    v_mfma_f32_16x16x32_bf16 v[60:63], a[84:87], a[56:59], v[60:63]
    ds_write_b128 v5, v[192:195] offset:0
    v_mfma_f32_16x16x32_bf16 v[64:67], a[88:91], a[32:35], v[64:67]
    buffer_load_dwordx4 v[216:219], v2, s[12:15], s46 offen offset:1024 sc1
    v_mfma_f32_16x16x32_bf16 v[64:67], v[240:243], a[36:39], v[64:67]
    v_mfma_f32_16x16x32_bf16 v[144:147], a[88:91], a[36:39], v[144:147]
    ds_write_b128 v5, v[196:199] offset:1024
    v_mfma_f32_16x16x32_bf16 v[144:147], v[232:235], a[32:35], v[144:147]
    buffer_load_dwordx4 a[76:79], v2, s[12:15], s47 offen offset:0 sc1
    v_mfma_f32_16x16x32_bf16 v[148:151], v[232:235], a[40:43], v[148:151]
    v_mfma_f32_16x16x32_bf16 v[148:151], a[88:91], a[44:47], v[148:151]
    ds_write_b128 v5, v[200:203] offset:2048
    v_mfma_f32_16x16x32_bf16 v[68:71], v[240:243], a[44:47], v[68:71]
    buffer_load_dwordx4 v[220:223], v2, s[12:15], s47 offen offset:1024 sc1
    v_mfma_f32_16x16x32_bf16 v[68:71], a[88:91], a[40:43], v[68:71]
    s_waitcnt vmcnt(26)
    v_xor_b32 v244, s80, v236
    v_xor_b32 v245, s80, v237
    v_mfma_f32_16x16x32_bf16 v[72:75], a[88:91], a[48:51], v[72:75]
    ds_write_b128 v5, v[204:207] offset:3072
    v_mfma_f32_16x16x32_bf16 v[72:75], v[240:243], a[52:55], v[72:75]
    buffer_load_dwordx4 a[80:83], v2, s[12:15], s48 offen offset:0 sc1
    v_mfma_f32_16x16x32_bf16 v[152:155], a[88:91], a[52:55], v[152:155]
    v_xor_b32 v246, s80, v238
    v_xor_b32 v247, s80, v239
    v_mfma_f32_16x16x32_bf16 v[152:155], v[232:235], a[48:51], v[152:155]
    v_mfma_f32_16x16x32_bf16 v[156:159], v[232:235], a[56:59], v[156:159]
    buffer_load_dwordx4 v[224:227], v2, s[12:15], s48 offen offset:1024 sc1
    v_mfma_f32_16x16x32_bf16 v[156:159], a[88:91], a[60:63], v[156:159]
    v_add_u32 v2, 10240, v2
    v_mfma_f32_16x16x32_bf16 v[76:79], v[240:243], a[60:63], v[76:79]
    v_mfma_f32_16x16x32_bf16 v[76:79], a[88:91], a[56:59], v[76:79]
    s_waitcnt vmcnt(10) lgkmcnt(0)
    s_barrier
    v_mfma_f32_16x16x32_bf16 v[80:83], a[92:95], a[32:35], v[80:83]
    s_mov_b32 m0, s65
    ds_read_b128 a[0:3], v6 offset:0
    v_mov_b64 v[176:177], 0
    v_mfma_f32_16x16x32_bf16 v[80:83], v[244:247], a[36:39], v[80:83]
    buffer_load_dwordx4 v1, s[8:11], s50 offen lds
    v_mfma_f32_16x16x32_bf16 v[160:163], a[92:95], a[36:39], v[160:163]
    ds_read_b128 a[4:7], v6 offset:1024
    v_mov_b64 v[178:179], 0
    v_mfma_f32_16x16x32_bf16 v[160:163], v[236:239], a[32:35], v[160:163]
    ds_read_b128 a[8:11], v6 offset:4096
    v_mov_b64 v[180:181], 0
    v_mfma_f32_16x16x32_bf16 v[164:167], v[236:239], a[40:43], v[164:167]
    s_mov_b32 m0, s66
    ds_read_b128 a[12:15], v6 offset:5120
    v_mov_b64 v[182:183], 0
    v_mfma_f32_16x16x32_bf16 v[164:167], a[92:95], a[44:47], v[164:167]
    buffer_load_dwordx4 v1, s[8:11], s51 offen lds
    v_mfma_f32_16x16x32_bf16 v[84:87], v[244:247], a[44:47], v[84:87]
    s_waitcnt vmcnt(10)
    ds_read_b128 a[16:19], v6 offset:8192
    v_mov_b64 v[184:185], 0
    v_mfma_f32_16x16x32_bf16 v[84:87], a[92:95], a[40:43], v[84:87]
    s_mov_b32 m0, s67
    ds_read_b128 a[20:23], v6 offset:9216
    v_xor_b32 v240, s80, v208
    v_mfma_f32_16x16x32_bf16 v[88:91], a[92:95], a[48:51], v[88:91]
    buffer_load_dwordx4 v1, s[8:11], s52 offen lds
    v_mfma_f32_16x16x32_bf16 v[88:91], v[244:247], a[52:55], v[88:91]
    ds_read_b128 a[24:27], v6 offset:12288
    v_xor_b32 v241, s80, v209
    v_mfma_f32_16x16x32_bf16 v[168:171], a[92:95], a[52:55], v[168:171]
    ds_read_b128 a[28:31], v6 offset:13312
    v_xor_b32 v242, s80, v210
    v_mfma_f32_16x16x32_bf16 v[168:171], v[236:239], a[48:51], v[168:171]
    s_mov_b32 m0, s68
    ds_read_b64_tr_b16 a[96:97], v3 offset:61920
    v_xor_b32 v243, s80, v211
    v_mfma_f32_16x16x32_bf16 v[172:175], v[236:239], a[56:59], v[172:175]
    buffer_load_dwordx4 v1, s[8:11], s53 offen lds
    v_mfma_f32_16x16x32_bf16 v[172:175], a[92:95], a[60:63], v[172:175]
    ds_read_b64_tr_b16 a[98:99], v4 offset:61920
    v_mov_b64 v[186:187], 0
    v_mfma_f32_16x16x32_bf16 v[92:95], v[244:247], a[60:63], v[92:95]
    s_mov_b32 m0, s69
    ds_read_b64_tr_b16 a[100:101], v3 offset:62944
    v_mov_b64 v[188:189], 0
    v_mfma_f32_16x16x32_bf16 v[92:95], a[92:95], a[56:59], v[92:95]
    s_waitcnt lgkmcnt(3)
    buffer_load_dwordx4 v1, s[8:11], s54 offen lds
    v_mfma_f32_16x16x32_bf16 v[16:19], a[64:67], a[0:3], v[16:19]
    ds_read_b64_tr_b16 a[102:103], v4 offset:62944
    v_mov_b64 v[190:191], 0
    v_mfma_f32_16x16x32_bf16 v[16:19], v[240:243], a[4:7], v[16:19]
    s_mov_b32 m0, s70
    ds_read_b64_tr_b16 a[104:105], v3 offset:62048
    v_mfma_f32_16x16x32_bf16 v[96:99], a[64:67], a[4:7], v[96:99]
    buffer_load_dwordx4 v1, s[8:11], s55 offen lds
    v_mfma_f32_16x16x32_bf16 v[96:99], v[208:211], a[0:3], v[96:99]
    ds_read_b64_tr_b16 a[106:107], v4 offset:62048
    v_mfma_f32_16x16x32_bf16 v[100:103], v[208:211], a[8:11], v[100:103]
    s_waitcnt lgkmcnt(2)
    ds_read_b64_tr_b16 a[108:109], v3 offset:63072
    v_smfmac_f32_16x16x64_bf16 v[176:179], a[128:131], a[96:103], v250
    s_mov_b32 m0, s71
    ds_read_b64_tr_b16 a[110:111], v4 offset:63072
    v_mfma_f32_16x16x32_bf16 v[100:103], a[64:67], a[12:15], v[100:103]
    buffer_load_dwordx4 v1, s[8:11], s56 offen lds
    v_mfma_f32_16x16x32_bf16 v[20:23], v[240:243], a[12:15], v[20:23]
    ds_read_b64_tr_b16 a[112:113], v3 offset:62176
    v_mfma_f32_16x16x32_bf16 v[20:23], a[64:67], a[8:11], v[20:23]
    s_mov_b32 m0, s72
    ds_read_b64_tr_b16 a[114:115], v4 offset:62176
    v_mfma_f32_16x16x32_bf16 v[24:27], a[64:67], a[16:19], v[24:27]
    s_waitcnt vmcnt(13)
    buffer_load_dwordx4 v1, s[8:11], s57 offen lds
    v_mfma_f32_16x16x32_bf16 v[24:27], v[240:243], a[20:23], v[24:27]
    s_waitcnt lgkmcnt(2)
    ds_read_b64_tr_b16 a[116:117], v3 offset:63200
    v_xor_b32 v244, s80, v212
    v_smfmac_f32_16x16x64_bf16 v[180:183], a[128:131], a[104:111], v250
    ds_read_b64_tr_b16 a[118:119], v4 offset:63200
    v_xor_b32 v245, s80, v213
    v_mfma_f32_16x16x32_bf16 v[104:107], a[64:67], a[20:23], v[104:107]
    s_mov_b32 m0, s73
    ds_read_b64_tr_b16 a[120:121], v3 offset:62304
    v_xor_b32 v246, s80, v214
    v_mfma_f32_16x16x32_bf16 v[104:107], v[208:211], a[16:19], v[104:107]
    buffer_load_dwordx4 v1, s[8:11], s58 offen lds
    v_mfma_f32_16x16x32_bf16 v[108:111], v[208:211], a[24:27], v[108:111]
    ds_read_b64_tr_b16 a[122:123], v4 offset:62304
    v_xor_b32 v247, s80, v215
    v_mfma_f32_16x16x32_bf16 v[108:111], a[64:67], a[28:31], v[108:111]
    s_mov_b32 m0, s74
    ds_read_b64_tr_b16 a[124:125], v3 offset:63328
    v_mfma_f32_16x16x32_bf16 v[28:31], v[240:243], a[28:31], v[28:31]
    s_waitcnt lgkmcnt(3)
    buffer_load_dwordx4 v1, s[8:11], s59 offen lds
    v_smfmac_f32_16x16x64_bf16 v[184:187], a[128:131], a[112:119], v250
    ds_read_b64_tr_b16 a[126:127], v4 offset:63328
    v_cvt_pk_bf16_f32 v192, v176, v180
    v_mfma_f32_16x16x32_bf16 v[28:31], a[64:67], a[24:27], v[28:31]
    ds_read_b64_tr_b16 a[96:97], v3 offset:63968
    v_cvt_pk_bf16_f32 v196, v177, v181
    v_mfma_f32_16x16x32_bf16 v[32:35], a[68:71], a[0:3], v[32:35]
    s_mov_b32 m0, s75
    ds_read_b64_tr_b16 a[98:99], v4 offset:63968
    v_cvt_pk_bf16_f32 v200, v178, v182
    v_mfma_f32_16x16x32_bf16 v[32:35], v[244:247], a[4:7], v[32:35]
    buffer_load_dwordx4 v1, s[8:11], s60 offen lds
    v_mfma_f32_16x16x32_bf16 v[112:115], a[68:71], a[4:7], v[112:115]
    s_mov_b32 m0, s76
    ds_read_b64_tr_b16 a[100:101], v3 offset:64992
    v_cvt_pk_bf16_f32 v204, v179, v183
    v_mfma_f32_16x16x32_bf16 v[112:115], v[212:215], a[0:3], v[112:115]
    s_waitcnt lgkmcnt(3)
    ds_read_b64_tr_b16 a[102:103], v4 offset:64992
    v_mov_b64 v[176:177], 0
    v_smfmac_f32_16x16x64_bf16 v[188:191], a[128:131], a[120:127], v250
    buffer_load_dwordx4 v1, s[8:11], s61 offen lds
    v_mfma_f32_16x16x32_bf16 v[116:119], v[212:215], a[8:11], v[116:119]
    ds_read_b64_tr_b16 a[104:105], v3 offset:64096
    v_mov_b64 v[178:179], 0
    v_mfma_f32_16x16x32_bf16 v[116:119], a[68:71], a[12:15], v[116:119]
    ds_read_b64_tr_b16 a[106:107], v4 offset:64096
    v_mov_b64 v[180:181], 0
    v_mfma_f32_16x16x32_bf16 v[36:39], v[244:247], a[12:15], v[36:39]
    s_mov_b32 m0, s77
    ds_read_b64_tr_b16 a[108:109], v3 offset:65120
    v_mov_b64 v[182:183], 0
    v_mfma_f32_16x16x32_bf16 v[36:39], a[68:71], a[8:11], v[36:39]
    s_waitcnt vmcnt(16)
    buffer_load_dwordx4 v1, s[8:11], s62 offen lds
    v_mfma_f32_16x16x32_bf16 v[40:43], a[68:71], a[16:19], v[40:43]
    s_waitcnt lgkmcnt(3)
    ds_read_b64_tr_b16 a[110:111], v4 offset:65120
    v_cvt_pk_bf16_f32 v193, v184, v188
    v_smfmac_f32_16x16x64_bf16 v[176:179], a[128:131], a[96:103], v250
    s_mov_b32 m0, s78
    ds_read_b64_tr_b16 a[112:113], v3 offset:64224
    v_cvt_pk_bf16_f32 v197, v185, v189
    v_mfma_f32_16x16x32_bf16 v[40:43], v[244:247], a[20:23], v[40:43]
    buffer_load_dwordx4 v1, s[8:11], s63 offen lds
    v_xor_b32 v242, s80, v218
    v_mfma_f32_16x16x32_bf16 v[120:123], a[68:71], a[20:23], v[120:123]
    ds_read_b64_tr_b16 a[114:115], v4 offset:64224
    v_cvt_pk_bf16_f32 v201, v186, v190
    v_xor_b32 v243, s80, v219
    v_mfma_f32_16x16x32_bf16 v[120:123], v[212:215], a[16:19], v[120:123]
    s_mov_b32 m0, s79
    ds_read_b64_tr_b16 a[116:117], v3 offset:65248
    v_cvt_pk_bf16_f32 v205, v187, v191
    v_mfma_f32_16x16x32_bf16 v[124:127], v[212:215], a[24:27], v[124:127]
    buffer_load_dwordx4 v1, s[8:11], s64 offen lds
    v_mfma_f32_16x16x32_bf16 v[124:127], a[68:71], a[28:31], v[124:127]
    s_waitcnt lgkmcnt(3)
    ds_read_b64_tr_b16 a[118:119], v4 offset:65248
    v_add_u32 v1, 0x10000, v1
    v_smfmac_f32_16x16x64_bf16 v[180:183], a[128:131], a[104:111], v250
    ds_read_b64_tr_b16 a[120:121], v3 offset:64352
    v_xor_b32 v240, s80, v216
    v_mfma_f32_16x16x32_bf16 v[44:47], v[244:247], a[28:31], v[44:47]
    ds_read_b64_tr_b16 a[122:123], v4 offset:64352
    v_xor_b32 v241, s80, v217
    v_mfma_f32_16x16x32_bf16 v[44:47], a[68:71], a[24:27], v[44:47]
    buffer_load_dwordx4 a[84:87], v2, s[12:15], s44 offen offset:0 sc1
    v_mfma_f32_16x16x32_bf16 v[48:51], a[72:75], a[0:3], v[48:51]
    ds_read_b64_tr_b16 a[124:125], v3 offset:65376
    v_mov_b64 v[184:185], 0
    v_mfma_f32_16x16x32_bf16 v[48:51], v[240:243], a[4:7], v[48:51]
    ds_read_b64_tr_b16 a[126:127], v4 offset:65376
    v_mov_b64 v[186:187], 0
    v_mfma_f32_16x16x32_bf16 v[128:131], a[72:75], a[4:7], v[128:131]
    s_waitcnt lgkmcnt(4)
    buffer_load_dwordx4 v[228:231], v2, s[12:15], s44 offen offset:1024 sc1
    v_smfmac_f32_16x16x64_bf16 v[184:187], a[128:131], a[112:119], v250
    v_cvt_pk_bf16_f32 v194, v176, v180
    v_cvt_pk_bf16_f32 v198, v177, v181
    v_mfma_f32_16x16x32_bf16 v[128:131], v[216:219], a[0:3], v[128:131]
    v_cvt_pk_bf16_f32 v202, v178, v182
    v_cvt_pk_bf16_f32 v206, v179, v183
    v_mfma_f32_16x16x32_bf16 v[132:135], v[216:219], a[8:11], v[132:135]
    v_mov_b64 v[188:189], 0
    v_mov_b64 v[190:191], 0
    v_mfma_f32_16x16x32_bf16 v[132:135], a[72:75], a[12:15], v[132:135]
    buffer_load_dwordx4 a[88:91], v2, s[12:15], s45 offen offset:0 sc1
    v_mfma_f32_16x16x32_bf16 v[52:55], v[240:243], a[12:15], v[52:55]
    v_mfma_f32_16x16x32_bf16 v[52:55], a[72:75], a[8:11], v[52:55]
    s_waitcnt lgkmcnt(0)
    v_smfmac_f32_16x16x64_bf16 v[188:191], a[128:131], a[120:127], v250
    s_waitcnt vmcnt(20)
    buffer_load_dwordx4 v[232:235], v2, s[12:15], s45 offen offset:1024 sc1
    v_mfma_f32_16x16x32_bf16 v[56:59], a[72:75], a[16:19], v[56:59]
    v_xor_b32 v244, s80, v220
    v_xor_b32 v245, s80, v221
    v_mfma_f32_16x16x32_bf16 v[56:59], v[240:243], a[20:23], v[56:59]
    v_xor_b32 v246, s80, v222
    v_xor_b32 v247, s80, v223
    v_mfma_f32_16x16x32_bf16 v[136:139], a[72:75], a[20:23], v[136:139]
    v_mfma_f32_16x16x32_bf16 v[136:139], v[216:219], a[16:19], v[136:139]
    buffer_load_dwordx4 a[92:95], v2, s[12:15], s46 offen offset:0 sc1
    v_mfma_f32_16x16x32_bf16 v[140:143], v[216:219], a[24:27], v[140:143]
    v_cvt_pk_bf16_f32 v195, v184, v188
    v_cvt_pk_bf16_f32 v199, v185, v189
    v_mfma_f32_16x16x32_bf16 v[140:143], a[72:75], a[28:31], v[140:143]
    v_cvt_pk_bf16_f32 v203, v186, v190
    v_cvt_pk_bf16_f32 v207, v187, v191
    v_mfma_f32_16x16x32_bf16 v[60:63], v[240:243], a[28:31], v[60:63]
    buffer_load_dwordx4 v[236:239], v2, s[12:15], s46 offen offset:1024 sc1
    v_mfma_f32_16x16x32_bf16 v[60:63], a[72:75], a[24:27], v[60:63]
    ds_write_b128 v5, v[192:195] offset:16384
    v_mfma_f32_16x16x32_bf16 v[64:67], a[76:79], a[0:3], v[64:67]
    v_mfma_f32_16x16x32_bf16 v[64:67], v[244:247], a[4:7], v[64:67]
    buffer_load_dwordx4 a[64:67], v2, s[12:15], s47 offen offset:0 sc1
    v_mfma_f32_16x16x32_bf16 v[144:147], a[76:79], a[4:7], v[144:147]
    ds_write_b128 v5, v[196:199] offset:17408
    v_mfma_f32_16x16x32_bf16 v[144:147], v[220:223], a[0:3], v[144:147]
    v_mfma_f32_16x16x32_bf16 v[148:151], v[220:223], a[8:11], v[148:151]
    v_mfma_f32_16x16x32_bf16 v[148:151], a[76:79], a[12:15], v[148:151]
    buffer_load_dwordx4 v[208:211], v2, s[12:15], s47 offen offset:1024 sc1
    v_mfma_f32_16x16x32_bf16 v[68:71], v[244:247], a[12:15], v[68:71]
    ds_write_b128 v5, v[200:203] offset:18432
    v_mfma_f32_16x16x32_bf16 v[68:71], a[76:79], a[8:11], v[68:71]
    s_waitcnt vmcnt(23)
    v_xor_b32 v240, s80, v224
    v_xor_b32 v241, s80, v225
    v_mfma_f32_16x16x32_bf16 v[72:75], a[76:79], a[16:19], v[72:75]
    buffer_load_dwordx4 a[68:71], v2, s[12:15], s48 offen offset:0 sc1
    v_mfma_f32_16x16x32_bf16 v[72:75], v[244:247], a[20:23], v[72:75]
    ds_write_b128 v5, v[204:207] offset:19456
    v_mfma_f32_16x16x32_bf16 v[152:155], a[76:79], a[20:23], v[152:155]
    v_xor_b32 v242, s80, v226
    v_xor_b32 v243, s80, v227
    v_mfma_f32_16x16x32_bf16 v[152:155], v[220:223], a[16:19], v[152:155]
    v_mfma_f32_16x16x32_bf16 v[156:159], v[220:223], a[24:27], v[156:159]
    buffer_load_dwordx4 v[212:215], v2, s[12:15], s48 offen offset:1024 sc1
    v_mfma_f32_16x16x32_bf16 v[156:159], a[76:79], a[28:31], v[156:159]
    v_add_u32 v2, 10240, v2
    v_mfma_f32_16x16x32_bf16 v[76:79], v[244:247], a[28:31], v[76:79]
    v_mfma_f32_16x16x32_bf16 v[76:79], a[76:79], a[24:27], v[76:79]
    s_waitcnt vmcnt(10) lgkmcnt(0)
    s_barrier
    v_mfma_f32_16x16x32_bf16 v[80:83], a[80:83], a[0:3], v[80:83]
    s_add_u32 m0, s65, 61920
    ds_read_b128 a[32:35], v6 offset:16384
    v_mov_b64 v[176:177], 0
    v_mfma_f32_16x16x32_bf16 v[80:83], v[240:243], a[4:7], v[80:83]
    buffer_load_dwordx4 v1, s[8:11], s50 offen lds
    v_mfma_f32_16x16x32_bf16 v[160:163], a[80:83], a[4:7], v[160:163]
    ds_read_b128 a[36:39], v6 offset:17408
    v_mov_b64 v[178:179], 0
    v_mfma_f32_16x16x32_bf16 v[160:163], v[224:227], a[0:3], v[160:163]
    ds_read_b128 a[40:43], v6 offset:20480
    v_mov_b64 v[180:181], 0
    v_mfma_f32_16x16x32_bf16 v[164:167], v[224:227], a[8:11], v[164:167]
    s_add_u32 m0, s66, 61920
    ds_read_b128 a[44:47], v6 offset:21504
    v_mov_b64 v[182:183], 0
    v_mfma_f32_16x16x32_bf16 v[164:167], a[80:83], a[12:15], v[164:167]
    buffer_load_dwordx4 v1, s[8:11], s51 offen lds
    v_mfma_f32_16x16x32_bf16 v[84:87], v[240:243], a[12:15], v[84:87]
    s_waitcnt vmcnt(10)
    ds_read_b128 a[48:51], v6 offset:24576
    v_mov_b64 v[184:185], 0
    v_mfma_f32_16x16x32_bf16 v[84:87], a[80:83], a[8:11], v[84:87]
    s_add_u32 m0, s67, 61920
    ds_read_b128 a[52:55], v6 offset:25600
    v_xor_b32 v244, s80, v228
    v_mfma_f32_16x16x32_bf16 v[88:91], a[80:83], a[16:19], v[88:91]
    buffer_load_dwordx4 v1, s[8:11], s52 offen lds
    v_mfma_f32_16x16x32_bf16 v[88:91], v[240:243], a[20:23], v[88:91]
    ds_read_b128 a[56:59], v6 offset:28672
    v_xor_b32 v245, s80, v229
    v_mfma_f32_16x16x32_bf16 v[168:171], a[80:83], a[20:23], v[168:171]
    ds_read_b128 a[60:63], v6 offset:29696
    v_xor_b32 v246, s80, v230
    v_mfma_f32_16x16x32_bf16 v[168:171], v[224:227], a[16:19], v[168:171]
    s_add_u32 m0, s68, 61920
    ds_read_b64_tr_b16 a[96:97], v3 offset:0
    v_xor_b32 v247, s80, v231
    v_mfma_f32_16x16x32_bf16 v[172:175], v[224:227], a[24:27], v[172:175]
    buffer_load_dwordx4 v1, s[8:11], s53 offen lds
    v_mfma_f32_16x16x32_bf16 v[172:175], a[80:83], a[28:31], v[172:175]
    ds_read_b64_tr_b16 a[98:99], v4 offset:0
    v_mov_b64 v[186:187], 0
    v_mfma_f32_16x16x32_bf16 v[92:95], v[240:243], a[28:31], v[92:95]
    s_add_u32 m0, s69, 61920
    ds_read_b64_tr_b16 a[100:101], v3 offset:1024
    v_mov_b64 v[188:189], 0
    v_mfma_f32_16x16x32_bf16 v[92:95], a[80:83], a[24:27], v[92:95]
    s_waitcnt lgkmcnt(3)
    buffer_load_dwordx4 v1, s[8:11], s54 offen lds
    v_mfma_f32_16x16x32_bf16 v[16:19], a[84:87], a[32:35], v[16:19]
    ds_read_b64_tr_b16 a[102:103], v4 offset:1024
    v_mov_b64 v[190:191], 0
    v_mfma_f32_16x16x32_bf16 v[16:19], v[244:247], a[36:39], v[16:19]
    s_add_u32 m0, s70, 61920
    ds_read_b64_tr_b16 a[104:105], v3 offset:128
    v_mfma_f32_16x16x32_bf16 v[96:99], a[84:87], a[36:39], v[96:99]
    buffer_load_dwordx4 v1, s[8:11], s55 offen lds
    v_mfma_f32_16x16x32_bf16 v[96:99], v[228:231], a[32:35], v[96:99]
    ds_read_b64_tr_b16 a[106:107], v4 offset:128
    v_mfma_f32_16x16x32_bf16 v[100:103], v[228:231], a[40:43], v[100:103]
    s_waitcnt lgkmcnt(2)
    ds_read_b64_tr_b16 a[108:109], v3 offset:1152
    v_smfmac_f32_16x16x64_bf16 v[176:179], a[128:131], a[96:103], v250
    s_add_u32 m0, s71, 61920
    ds_read_b64_tr_b16 a[110:111], v4 offset:1152
    v_mfma_f32_16x16x32_bf16 v[100:103], a[84:87], a[44:47], v[100:103]
    buffer_load_dwordx4 v1, s[8:11], s56 offen lds
    v_mfma_f32_16x16x32_bf16 v[20:23], v[244:247], a[44:47], v[20:23]
    ds_read_b64_tr_b16 a[112:113], v3 offset:256
    v_mfma_f32_16x16x32_bf16 v[20:23], a[84:87], a[40:43], v[20:23]
    s_add_u32 m0, s72, 61920
    ds_read_b64_tr_b16 a[114:115], v4 offset:256
    v_mfma_f32_16x16x32_bf16 v[24:27], a[84:87], a[48:51], v[24:27]
    s_waitcnt vmcnt(13)
    buffer_load_dwordx4 v1, s[8:11], s57 offen lds
    v_mfma_f32_16x16x32_bf16 v[24:27], v[244:247], a[52:55], v[24:27]
    s_waitcnt lgkmcnt(2)
    ds_read_b64_tr_b16 a[116:117], v3 offset:1280
    v_xor_b32 v240, s80, v232
    v_smfmac_f32_16x16x64_bf16 v[180:183], a[128:131], a[104:111], v250
    ds_read_b64_tr_b16 a[118:119], v4 offset:1280
    v_xor_b32 v241, s80, v233
    v_mfma_f32_16x16x32_bf16 v[104:107], a[84:87], a[52:55], v[104:107]
    s_add_u32 m0, s73, 61920
    ds_read_b64_tr_b16 a[120:121], v3 offset:384
    v_xor_b32 v242, s80, v234
    v_mfma_f32_16x16x32_bf16 v[104:107], v[228:231], a[48:51], v[104:107]
    buffer_load_dwordx4 v1, s[8:11], s58 offen lds
    v_mfma_f32_16x16x32_bf16 v[108:111], v[228:231], a[56:59], v[108:111]
    ds_read_b64_tr_b16 a[122:123], v4 offset:384
    v_xor_b32 v243, s80, v235
    v_mfma_f32_16x16x32_bf16 v[108:111], a[84:87], a[60:63], v[108:111]
    s_add_u32 m0, s74, 61920
    ds_read_b64_tr_b16 a[124:125], v3 offset:1408
    v_mfma_f32_16x16x32_bf16 v[28:31], v[244:247], a[60:63], v[28:31]
    s_waitcnt lgkmcnt(3)
    buffer_load_dwordx4 v1, s[8:11], s59 offen lds
    v_smfmac_f32_16x16x64_bf16 v[184:187], a[128:131], a[112:119], v250
    ds_read_b64_tr_b16 a[126:127], v4 offset:1408
    v_cvt_pk_bf16_f32 v192, v176, v180
    v_mfma_f32_16x16x32_bf16 v[28:31], a[84:87], a[56:59], v[28:31]
    ds_read_b64_tr_b16 a[96:97], v3 offset:2048
    v_cvt_pk_bf16_f32 v196, v177, v181
    v_mfma_f32_16x16x32_bf16 v[32:35], a[88:91], a[32:35], v[32:35]
    s_add_u32 m0, s75, 61920
    ds_read_b64_tr_b16 a[98:99], v4 offset:2048
    v_cvt_pk_bf16_f32 v200, v178, v182
    v_mfma_f32_16x16x32_bf16 v[32:35], v[240:243], a[36:39], v[32:35]
    buffer_load_dwordx4 v1, s[8:11], s60 offen lds
    v_mfma_f32_16x16x32_bf16 v[112:115], a[88:91], a[36:39], v[112:115]
    s_add_u32 m0, s76, 61920
    ds_read_b64_tr_b16 a[100:101], v3 offset:3072
    v_cvt_pk_bf16_f32 v204, v179, v183
    v_mfma_f32_16x16x32_bf16 v[112:115], v[232:235], a[32:35], v[112:115]
    s_waitcnt lgkmcnt(3)
    ds_read_b64_tr_b16 a[102:103], v4 offset:3072
    v_mov_b64 v[176:177], 0
    v_smfmac_f32_16x16x64_bf16 v[188:191], a[128:131], a[120:127], v250
    buffer_load_dwordx4 v1, s[8:11], s61 offen lds
    v_mfma_f32_16x16x32_bf16 v[116:119], v[232:235], a[40:43], v[116:119]
    ds_read_b64_tr_b16 a[104:105], v3 offset:2176
    v_mov_b64 v[178:179], 0
    v_mfma_f32_16x16x32_bf16 v[116:119], a[88:91], a[44:47], v[116:119]
    ds_read_b64_tr_b16 a[106:107], v4 offset:2176
    v_mov_b64 v[180:181], 0
    v_mfma_f32_16x16x32_bf16 v[36:39], v[240:243], a[44:47], v[36:39]
    s_add_u32 m0, s77, 61920
    ds_read_b64_tr_b16 a[108:109], v3 offset:3200
    v_mov_b64 v[182:183], 0
    v_mfma_f32_16x16x32_bf16 v[36:39], a[88:91], a[40:43], v[36:39]
    s_waitcnt vmcnt(16)
    buffer_load_dwordx4 v1, s[8:11], s62 offen lds
    v_mfma_f32_16x16x32_bf16 v[40:43], a[88:91], a[48:51], v[40:43]
    s_waitcnt lgkmcnt(3)
    ds_read_b64_tr_b16 a[110:111], v4 offset:3200
    v_cvt_pk_bf16_f32 v193, v184, v188
    v_smfmac_f32_16x16x64_bf16 v[176:179], a[128:131], a[96:103], v250
    s_add_u32 m0, s78, 61920
    ds_read_b64_tr_b16 a[112:113], v3 offset:2304
    v_cvt_pk_bf16_f32 v197, v185, v189
    v_mfma_f32_16x16x32_bf16 v[40:43], v[240:243], a[52:55], v[40:43]
L_pad7:
    s_cbranch_execz L_back
    buffer_load_dwordx4 v1, s[8:11], s63 offen lds
    v_xor_b32 v246, s80, v238
    v_mfma_f32_16x16x32_bf16 v[120:123], a[88:91], a[52:55], v[120:123]
    ds_read_b64_tr_b16 a[114:115], v4 offset:2304
    v_cvt_pk_bf16_f32 v201, v186, v190
    v_xor_b32 v247, s80, v239
    v_mfma_f32_16x16x32_bf16 v[120:123], v[232:235], a[48:51], v[120:123]
    s_add_u32 m0, s79, 61920
    ds_read_b64_tr_b16 a[116:117], v3 offset:3328
    v_cvt_pk_bf16_f32 v205, v187, v191
    v_mfma_f32_16x16x32_bf16 v[124:127], v[232:235], a[56:59], v[124:127]
    buffer_load_dwordx4 v1, s[8:11], s64 offen lds
    v_mfma_f32_16x16x32_bf16 v[124:127], a[88:91], a[60:63], v[124:127]
    s_waitcnt lgkmcnt(3)
    ds_read_b64_tr_b16 a[118:119], v4 offset:3328
    v_add_u32 v1, 0x10000, v1
    v_smfmac_f32_16x16x64_bf16 v[180:183], a[128:131], a[104:111], v250
    ds_read_b64_tr_b16 a[120:121], v3 offset:2432
    v_xor_b32 v244, s80, v236
    v_mfma_f32_16x16x32_bf16 v[44:47], v[240:243], a[60:63], v[44:47]
    ds_read_b64_tr_b16 a[122:123], v4 offset:2432
    v_xor_b32 v245, s80, v237
    v_mfma_f32_16x16x32_bf16 v[44:47], a[88:91], a[56:59], v[44:47]
    buffer_load_dwordx4 a[72:75], v2, s[12:15], s44 offen offset:0 sc1
    v_mfma_f32_16x16x32_bf16 v[48:51], a[92:95], a[32:35], v[48:51]
    ds_read_b64_tr_b16 a[124:125], v3 offset:3456
    v_mov_b64 v[184:185], 0
    v_mfma_f32_16x16x32_bf16 v[48:51], v[244:247], a[36:39], v[48:51]
    ds_read_b64_tr_b16 a[126:127], v4 offset:3456
    v_mov_b64 v[186:187], 0
    v_mfma_f32_16x16x32_bf16 v[128:131], a[92:95], a[36:39], v[128:131]
    s_waitcnt lgkmcnt(4)
    buffer_load_dwordx4 v[216:219], v2, s[12:15], s44 offen offset:1024 sc1
    v_smfmac_f32_16x16x64_bf16 v[184:187], a[128:131], a[112:119], v250
    v_cvt_pk_bf16_f32 v194, v176, v180
    v_cvt_pk_bf16_f32 v198, v177, v181
    v_mfma_f32_16x16x32_bf16 v[128:131], v[236:239], a[32:35], v[128:131]
    v_cvt_pk_bf16_f32 v202, v178, v182
    v_cvt_pk_bf16_f32 v206, v179, v183
    v_mfma_f32_16x16x32_bf16 v[132:135], v[236:239], a[40:43], v[132:135]
    v_mov_b64 v[188:189], 0
    v_mov_b64 v[190:191], 0
    v_mfma_f32_16x16x32_bf16 v[132:135], a[92:95], a[44:47], v[132:135]
    buffer_load_dwordx4 a[76:79], v2, s[12:15], s45 offen offset:0 sc1
    v_mfma_f32_16x16x32_bf16 v[52:55], v[244:247], a[44:47], v[52:55]
    v_mfma_f32_16x16x32_bf16 v[52:55], a[92:95], a[40:43], v[52:55]
    s_waitcnt lgkmcnt(0)
    v_smfmac_f32_16x16x64_bf16 v[188:191], a[128:131], a[120:127], v250
    s_waitcnt vmcnt(20)
    buffer_load_dwordx4 v[220:223], v2, s[12:15], s45 offen offset:1024 sc1
    v_mfma_f32_16x16x32_bf16 v[56:59], a[92:95], a[48:51], v[56:59]
    v_xor_b32 v240, s80, v208
    v_xor_b32 v241, s80, v209
    v_mfma_f32_16x16x32_bf16 v[56:59], v[244:247], a[52:55], v[56:59]
    v_xor_b32 v242, s80, v210
    v_xor_b32 v243, s80, v211
    v_mfma_f32_16x16x32_bf16 v[136:139], a[92:95], a[52:55], v[136:139]
    v_mfma_f32_16x16x32_bf16 v[136:139], v[236:239], a[48:51], v[136:139]
    buffer_load_dwordx4 a[80:83], v2, s[12:15], s46 offen offset:0 sc1
    v_mfma_f32_16x16x32_bf16 v[140:143], v[236:239], a[56:59], v[140:143]
    v_cvt_pk_bf16_f32 v195, v184, v188
    v_cvt_pk_bf16_f32 v199, v185, v189
    v_mfma_f32_16x16x32_bf16 v[140:143], a[92:95], a[60:63], v[140:143]
    v_cvt_pk_bf16_f32 v203, v186, v190
    v_cvt_pk_bf16_f32 v207, v187, v191
    v_mfma_f32_16x16x32_bf16 v[60:63], v[244:247], a[60:63], v[60:63]
    buffer_load_dwordx4 v[224:227], v2, s[12:15], s46 offen offset:1024 sc1
    v_mfma_f32_16x16x32_bf16 v[60:63], a[92:95], a[56:59], v[60:63]
    ds_write_b128 v5, v[192:195] offset:0
    v_mfma_f32_16x16x32_bf16 v[64:67], a[64:67], a[32:35], v[64:67]
    v_mfma_f32_16x16x32_bf16 v[64:67], v[240:243], a[36:39], v[64:67]
    buffer_load_dwordx4 a[84:87], v2, s[12:15], s47 offen offset:0 sc1
    v_mfma_f32_16x16x32_bf16 v[144:147], a[64:67], a[36:39], v[144:147]
    ds_write_b128 v5, v[196:199] offset:1024
    v_mfma_f32_16x16x32_bf16 v[144:147], v[208:211], a[32:35], v[144:147]
    v_mfma_f32_16x16x32_bf16 v[148:151], v[208:211], a[40:43], v[148:151]
    v_mfma_f32_16x16x32_bf16 v[148:151], a[64:67], a[44:47], v[148:151]
    buffer_load_dwordx4 v[228:231], v2, s[12:15], s47 offen offset:1024 sc1
    v_mfma_f32_16x16x32_bf16 v[68:71], v[240:243], a[44:47], v[68:71]
    ds_write_b128 v5, v[200:203] offset:2048
    v_mfma_f32_16x16x32_bf16 v[68:71], a[64:67], a[40:43], v[68:71]
    s_waitcnt vmcnt(23)
    v_xor_b32 v244, s80, v212
    v_xor_b32 v245, s80, v213
    v_mfma_f32_16x16x32_bf16 v[72:75], a[64:67], a[48:51], v[72:75]
    buffer_load_dwordx4 a[88:91], v2, s[12:15], s48 offen offset:0 sc1
    v_mfma_f32_16x16x32_bf16 v[72:75], v[240:243], a[52:55], v[72:75]
    ds_write_b128 v5, v[204:207] offset:3072
    v_mfma_f32_16x16x32_bf16 v[152:155], a[64:67], a[52:55], v[152:155]
    v_xor_b32 v246, s80, v214
    v_xor_b32 v247, s80, v215
    v_mfma_f32_16x16x32_bf16 v[152:155], v[208:211], a[48:51], v[152:155]
    v_mfma_f32_16x16x32_bf16 v[156:159], v[208:211], a[56:59], v[156:159]
    buffer_load_dwordx4 v[232:235], v2, s[12:15], s48 offen offset:1024 sc1
    v_mfma_f32_16x16x32_bf16 v[156:159], a[64:67], a[60:63], v[156:159]
    v_add_u32 v2, 10240, v2
    v_mfma_f32_16x16x32_bf16 v[76:79], v[240:243], a[60:63], v[76:79]
    v_mfma_f32_16x16x32_bf16 v[76:79], a[64:67], a[56:59], v[76:79]
    s_waitcnt vmcnt(10) lgkmcnt(0)
    s_barrier
    v_mfma_f32_16x16x32_bf16 v[80:83], a[68:71], a[32:35], v[80:83]
    s_mov_b32 m0, s65
    ds_read_b128 a[0:3], v6 offset:0
    v_mov_b64 v[176:177], 0
    v_mfma_f32_16x16x32_bf16 v[80:83], v[244:247], a[36:39], v[80:83]
    buffer_load_dwordx4 v1, s[8:11], s50 offen lds
    v_mfma_f32_16x16x32_bf16 v[160:163], a[68:71], a[36:39], v[160:163]
    ds_read_b128 a[4:7], v6 offset:1024
    v_mov_b64 v[178:179], 0
    v_mfma_f32_16x16x32_bf16 v[160:163], v[212:215], a[32:35], v[160:163]
    ds_read_b128 a[8:11], v6 offset:4096
    v_mov_b64 v[180:181], 0
    v_mfma_f32_16x16x32_bf16 v[164:167], v[212:215], a[40:43], v[164:167]
    s_mov_b32 m0, s66
    ds_read_b128 a[12:15], v6 offset:5120
    v_mov_b64 v[182:183], 0
    v_mfma_f32_16x16x32_bf16 v[164:167], a[68:71], a[44:47], v[164:167]
    buffer_load_dwordx4 v1, s[8:11], s51 offen lds
    v_mfma_f32_16x16x32_bf16 v[84:87], v[244:247], a[44:47], v[84:87]
    s_waitcnt vmcnt(10)
    ds_read_b128 a[16:19], v6 offset:8192
    v_mov_b64 v[184:185], 0
    v_mfma_f32_16x16x32_bf16 v[84:87], a[68:71], a[40:43], v[84:87]
    s_mov_b32 m0, s67
    ds_read_b128 a[20:23], v6 offset:9216
    v_xor_b32 v240, s80, v216
    v_mfma_f32_16x16x32_bf16 v[88:91], a[68:71], a[48:51], v[88:91]
    buffer_load_dwordx4 v1, s[8:11], s52 offen lds
    v_mfma_f32_16x16x32_bf16 v[88:91], v[244:247], a[52:55], v[88:91]
    ds_read_b128 a[24:27], v6 offset:12288
    v_xor_b32 v241, s80, v217
    v_mfma_f32_16x16x32_bf16 v[168:171], a[68:71], a[52:55], v[168:171]
    ds_read_b128 a[28:31], v6 offset:13312
    v_xor_b32 v242, s80, v218
    v_mfma_f32_16x16x32_bf16 v[168:171], v[212:215], a[48:51], v[168:171]
    s_mov_b32 m0, s68
    ds_read_b64_tr_b16 a[96:97], v3 offset:61920
    v_xor_b32 v243, s80, v219
    v_mfma_f32_16x16x32_bf16 v[172:175], v[212:215], a[56:59], v[172:175]
    buffer_load_dwordx4 v1, s[8:11], s53 offen lds
    v_mfma_f32_16x16x32_bf16 v[172:175], a[68:71], a[60:63], v[172:175]
    ds_read_b64_tr_b16 a[98:99], v4 offset:61920
    v_mov_b64 v[186:187], 0
    v_mfma_f32_16x16x32_bf16 v[92:95], v[244:247], a[60:63], v[92:95]
    s_mov_b32 m0, s69
    ds_read_b64_tr_b16 a[100:101], v3 offset:62944
    v_mov_b64 v[188:189], 0
    v_mfma_f32_16x16x32_bf16 v[92:95], a[68:71], a[56:59], v[92:95]
    s_waitcnt lgkmcnt(3)
    buffer_load_dwordx4 v1, s[8:11], s54 offen lds
    v_mfma_f32_16x16x32_bf16 v[16:19], a[72:75], a[0:3], v[16:19]
    ds_read_b64_tr_b16 a[102:103], v4 offset:62944
    v_mov_b64 v[190:191], 0
    v_mfma_f32_16x16x32_bf16 v[16:19], v[240:243], a[4:7], v[16:19]
    s_mov_b32 m0, s70
    ds_read_b64_tr_b16 a[104:105], v3 offset:62048
    v_mfma_f32_16x16x32_bf16 v[96:99], a[72:75], a[4:7], v[96:99]
    buffer_load_dwordx4 v1, s[8:11], s55 offen lds
    v_mfma_f32_16x16x32_bf16 v[96:99], v[216:219], a[0:3], v[96:99]
    ds_read_b64_tr_b16 a[106:107], v4 offset:62048
    v_mfma_f32_16x16x32_bf16 v[100:103], v[216:219], a[8:11], v[100:103]
    s_waitcnt lgkmcnt(2)
    ds_read_b64_tr_b16 a[108:109], v3 offset:63072
    v_smfmac_f32_16x16x64_bf16 v[176:179], a[128:131], a[96:103], v250
    s_mov_b32 m0, s71
    ds_read_b64_tr_b16 a[110:111], v4 offset:63072
    v_mfma_f32_16x16x32_bf16 v[100:103], a[72:75], a[12:15], v[100:103]
    buffer_load_dwordx4 v1, s[8:11], s56 offen lds
    v_mfma_f32_16x16x32_bf16 v[20:23], v[240:243], a[12:15], v[20:23]
    ds_read_b64_tr_b16 a[112:113], v3 offset:62176
    v_mfma_f32_16x16x32_bf16 v[20:23], a[72:75], a[8:11], v[20:23]
    s_mov_b32 m0, s72
    ds_read_b64_tr_b16 a[114:115], v4 offset:62176
    v_mfma_f32_16x16x32_bf16 v[24:27], a[72:75], a[16:19], v[24:27]
    s_waitcnt vmcnt(13)
    buffer_load_dwordx4 v1, s[8:11], s57 offen lds
    v_mfma_f32_16x16x32_bf16 v[24:27], v[240:243], a[20:23], v[24:27]
    s_waitcnt lgkmcnt(2)
    ds_read_b64_tr_b16 a[116:117], v3 offset:63200
    v_xor_b32 v244, s80, v220
    v_smfmac_f32_16x16x64_bf16 v[180:183], a[128:131], a[104:111], v250
    ds_read_b64_tr_b16 a[118:119], v4 offset:63200
    v_xor_b32 v245, s80, v221
    v_mfma_f32_16x16x32_bf16 v[104:107], a[72:75], a[20:23], v[104:107]
    s_mov_b32 m0, s73
    ds_read_b64_tr_b16 a[120:121], v3 offset:62304
    v_xor_b32 v246, s80, v222
    v_mfma_f32_16x16x32_bf16 v[104:107], v[216:219], a[16:19], v[104:107]
    buffer_load_dwordx4 v1, s[8:11], s58 offen lds
    v_mfma_f32_16x16x32_bf16 v[108:111], v[216:219], a[24:27], v[108:111]
    ds_read_b64_tr_b16 a[122:123], v4 offset:62304
    v_xor_b32 v247, s80, v223
    v_mfma_f32_16x16x32_bf16 v[108:111], a[72:75], a[28:31], v[108:111]
    s_mov_b32 m0, s74
    ds_read_b64_tr_b16 a[124:125], v3 offset:63328
    v_mfma_f32_16x16x32_bf16 v[28:31], v[240:243], a[28:31], v[28:31]
    s_waitcnt lgkmcnt(3)
    buffer_load_dwordx4 v1, s[8:11], s59 offen lds
    v_smfmac_f32_16x16x64_bf16 v[184:187], a[128:131], a[112:119], v250
    ds_read_b64_tr_b16 a[126:127], v4 offset:63328
    v_cvt_pk_bf16_f32 v192, v176, v180
    v_mfma_f32_16x16x32_bf16 v[28:31], a[72:75], a[24:27], v[28:31]
    ds_read_b64_tr_b16 a[96:97], v3 offset:63968
    v_cvt_pk_bf16_f32 v196, v177, v181
    v_mfma_f32_16x16x32_bf16 v[32:35], a[76:79], a[0:3], v[32:35]
    s_mov_b32 m0, s75
    ds_read_b64_tr_b16 a[98:99], v4 offset:63968
    v_cvt_pk_bf16_f32 v200, v178, v182
    v_mfma_f32_16x16x32_bf16 v[32:35], v[244:247], a[4:7], v[32:35]
    buffer_load_dwordx4 v1, s[8:11], s60 offen lds
    v_mfma_f32_16x16x32_bf16 v[112:115], a[76:79], a[4:7], v[112:115]
    s_mov_b32 m0, s76
    ds_read_b64_tr_b16 a[100:101], v3 offset:64992
    v_cvt_pk_bf16_f32 v204, v179, v183
    v_mfma_f32_16x16x32_bf16 v[112:115], v[220:223], a[0:3], v[112:115]
    s_waitcnt lgkmcnt(3)
    ds_read_b64_tr_b16 a[102:103], v4 offset:64992
    v_mov_b64 v[176:177], 0
    v_smfmac_f32_16x16x64_bf16 v[188:191], a[128:131], a[120:127], v250
    buffer_load_dwordx4 v1, s[8:11], s61 offen lds
    v_mfma_f32_16x16x32_bf16 v[116:119], v[220:223], a[8:11], v[116:119]
    ds_read_b64_tr_b16 a[104:105], v3 offset:64096
    v_mov_b64 v[178:179], 0
    v_mfma_f32_16x16x32_bf16 v[116:119], a[76:79], a[12:15], v[116:119]
    ds_read_b64_tr_b16 a[106:107], v4 offset:64096
    v_mov_b64 v[180:181], 0
    v_mfma_f32_16x16x32_bf16 v[36:39], v[244:247], a[12:15], v[36:39]
    s_mov_b32 m0, s77
    ds_read_b64_tr_b16 a[108:109], v3 offset:65120
    v_mov_b64 v[182:183], 0
    v_mfma_f32_16x16x32_bf16 v[36:39], a[76:79], a[8:11], v[36:39]
    s_waitcnt vmcnt(16)
    buffer_load_dwordx4 v1, s[8:11], s62 offen lds
    v_mfma_f32_16x16x32_bf16 v[40:43], a[76:79], a[16:19], v[40:43]
    s_waitcnt lgkmcnt(3)
    ds_read_b64_tr_b16 a[110:111], v4 offset:65120
    v_cvt_pk_bf16_f32 v193, v184, v188
    v_smfmac_f32_16x16x64_bf16 v[176:179], a[128:131], a[96:103], v250
    s_mov_b32 m0, s78
    ds_read_b64_tr_b16 a[112:113], v3 offset:64224
    v_cvt_pk_bf16_f32 v197, v185, v189
    v_mfma_f32_16x16x32_bf16 v[40:43], v[244:247], a[20:23], v[40:43]
    buffer_load_dwordx4 v1, s[8:11], s63 offen lds
    v_xor_b32 v242, s80, v226
    v_mfma_f32_16x16x32_bf16 v[120:123], a[76:79], a[20:23], v[120:123]
    ds_read_b64_tr_b16 a[114:115], v4 offset:64224
    v_cvt_pk_bf16_f32 v201, v186, v190
    v_xor_b32 v243, s80, v227
    v_mfma_f32_16x16x32_bf16 v[120:123], v[220:223], a[16:19], v[120:123]
    s_mov_b32 m0, s79
    ds_read_b64_tr_b16 a[116:117], v3 offset:65248
    v_cvt_pk_bf16_f32 v205, v187, v191
    v_mfma_f32_16x16x32_bf16 v[124:127], v[220:223], a[24:27], v[124:127]
    buffer_load_dwordx4 v1, s[8:11], s64 offen lds
    v_mfma_f32_16x16x32_bf16 v[124:127], a[76:79], a[28:31], v[124:127]
    s_waitcnt lgkmcnt(3)
    ds_read_b64_tr_b16 a[118:119], v4 offset:65248
    v_add_u32 v1, 0x10000, v1
    v_smfmac_f32_16x16x64_bf16 v[180:183], a[128:131], a[104:111], v250
    ds_read_b64_tr_b16 a[120:121], v3 offset:64352
    v_xor_b32 v240, s80, v224
    v_mfma_f32_16x16x32_bf16 v[44:47], v[244:247], a[28:31], v[44:47]
    ds_read_b64_tr_b16 a[122:123], v4 offset:64352
    v_xor_b32 v241, s80, v225
    v_mfma_f32_16x16x32_bf16 v[44:47], a[76:79], a[24:27], v[44:47]
    buffer_load_dwordx4 a[92:95], v2, s[12:15], s44 offen offset:0 sc1
    v_mfma_f32_16x16x32_bf16 v[48:51], a[80:83], a[0:3], v[48:51]
    ds_read_b64_tr_b16 a[124:125], v3 offset:65376
    v_mov_b64 v[184:185], 0
    v_mfma_f32_16x16x32_bf16 v[48:51], v[240:243], a[4:7], v[48:51]
    ds_read_b64_tr_b16 a[126:127], v4 offset:65376
    v_mov_b64 v[186:187], 0
    v_mfma_f32_16x16x32_bf16 v[128:131], a[80:83], a[4:7], v[128:131]
    s_waitcnt lgkmcnt(4)
    buffer_load_dwordx4 v[236:239], v2, s[12:15], s44 offen offset:1024 sc1
    v_smfmac_f32_16x16x64_bf16 v[184:187], a[128:131], a[112:119], v250
    v_cvt_pk_bf16_f32 v194, v176, v180
    v_cvt_pk_bf16_f32 v198, v177, v181
    v_mfma_f32_16x16x32_bf16 v[128:131], v[224:227], a[0:3], v[128:131]
    v_cvt_pk_bf16_f32 v202, v178, v182
    v_cvt_pk_bf16_f32 v206, v179, v183
    v_mfma_f32_16x16x32_bf16 v[132:135], v[224:227], a[8:11], v[132:135]
    v_mov_b64 v[188:189], 0
    v_mov_b64 v[190:191], 0
    v_mfma_f32_16x16x32_bf16 v[132:135], a[80:83], a[12:15], v[132:135]
    buffer_load_dwordx4 a[64:67], v2, s[12:15], s45 offen offset:0 sc1
    v_mfma_f32_16x16x32_bf16 v[52:55], v[240:243], a[12:15], v[52:55]
    v_mfma_f32_16x16x32_bf16 v[52:55], a[80:83], a[8:11], v[52:55]
    s_waitcnt lgkmcnt(0)
    v_smfmac_f32_16x16x64_bf16 v[188:191], a[128:131], a[120:127], v250
    s_waitcnt vmcnt(20)
    buffer_load_dwordx4 v[208:211], v2, s[12:15], s45 offen offset:1024 sc1
    v_mfma_f32_16x16x32_bf16 v[56:59], a[80:83], a[16:19], v[56:59]
    v_xor_b32 v244, s80, v228
    v_xor_b32 v245, s80, v229
    v_mfma_f32_16x16x32_bf16 v[56:59], v[240:243], a[20:23], v[56:59]
    v_xor_b32 v246, s80, v230
    v_xor_b32 v247, s80, v231
    v_mfma_f32_16x16x32_bf16 v[136:139], a[80:83], a[20:23], v[136:139]
    v_mfma_f32_16x16x32_bf16 v[136:139], v[224:227], a[16:19], v[136:139]
    buffer_load_dwordx4 a[68:71], v2, s[12:15], s46 offen offset:0 sc1
    v_mfma_f32_16x16x32_bf16 v[140:143], v[224:227], a[24:27], v[140:143]
    v_cvt_pk_bf16_f32 v195, v184, v188
    v_cvt_pk_bf16_f32 v199, v185, v189
    v_mfma_f32_16x16x32_bf16 v[140:143], a[80:83], a[28:31], v[140:143]
    v_cvt_pk_bf16_f32 v203, v186, v190
    v_cvt_pk_bf16_f32 v207, v187, v191
    v_mfma_f32_16x16x32_bf16 v[60:63], v[240:243], a[28:31], v[60:63]
    buffer_load_dwordx4 v[212:215], v2, s[12:15], s46 offen offset:1024 sc1
    v_mfma_f32_16x16x32_bf16 v[60:63], a[80:83], a[24:27], v[60:63]
    ds_write_b128 v5, v[192:195] offset:16384
    v_mfma_f32_16x16x32_bf16 v[64:67], a[84:87], a[0:3], v[64:67]
    v_mfma_f32_16x16x32_bf16 v[64:67], v[244:247], a[4:7], v[64:67]
    buffer_load_dwordx4 a[72:75], v2, s[12:15], s47 offen offset:0 sc1
    v_mfma_f32_16x16x32_bf16 v[144:147], a[84:87], a[4:7], v[144:147]
    ds_write_b128 v5, v[196:199] offset:17408
    v_mfma_f32_16x16x32_bf16 v[144:147], v[228:231], a[0:3], v[144:147]
    v_mfma_f32_16x16x32_bf16 v[148:151], v[228:231], a[8:11], v[148:151]
    v_mfma_f32_16x16x32_bf16 v[148:151], a[84:87], a[12:15], v[148:151]
    buffer_load_dwordx4 v[216:219], v2, s[12:15], s47 offen offset:1024 sc1
    v_mfma_f32_16x16x32_bf16 v[68:71], v[244:247], a[12:15], v[68:71]
    ds_write_b128 v5, v[200:203] offset:18432
    v_mfma_f32_16x16x32_bf16 v[68:71], a[84:87], a[8:11], v[68:71]
    s_waitcnt vmcnt(23)
    v_xor_b32 v240, s80, v232
    v_xor_b32 v241, s80, v233
    v_mfma_f32_16x16x32_bf16 v[72:75], a[84:87], a[16:19], v[72:75]
    buffer_load_dwordx4 a[76:79], v2, s[12:15], s48 offen offset:0 sc1
    v_mfma_f32_16x16x32_bf16 v[72:75], v[244:247], a[20:23], v[72:75]
    ds_write_b128 v5, v[204:207] offset:19456
    v_mfma_f32_16x16x32_bf16 v[152:155], a[84:87], a[20:23], v[152:155]
    v_xor_b32 v242, s80, v234
    v_xor_b32 v243, s80, v235
    v_mfma_f32_16x16x32_bf16 v[152:155], v[228:231], a[16:19], v[152:155]
    v_mfma_f32_16x16x32_bf16 v[156:159], v[228:231], a[24:27], v[156:159]
    buffer_load_dwordx4 v[220:223], v2, s[12:15], s48 offen offset:1024 sc1
    v_mfma_f32_16x16x32_bf16 v[156:159], a[84:87], a[28:31], v[156:159]
    v_add_u32 v2, 10240, v2
    v_mfma_f32_16x16x32_bf16 v[76:79], v[244:247], a[28:31], v[76:79]
    v_mfma_f32_16x16x32_bf16 v[76:79], a[84:87], a[24:27], v[76:79]
    s_waitcnt vmcnt(10) lgkmcnt(0)
    s_barrier
    v_mfma_f32_16x16x32_bf16 v[80:83], a[88:91], a[0:3], v[80:83]
    ds_read_b128 a[32:35], v6 offset:16384
    v_mov_b64 v[176:177], 0
    v_mfma_f32_16x16x32_bf16 v[80:83], v[240:243], a[4:7], v[80:83]
    s_mov_b32 s95, 32768
    s_mov_b32 s100, 1
    buffer_load_dword v10, v9, s[40:43], s95 offen sc1
    v_mfma_f32_16x16x32_bf16 v[160:163], a[88:91], a[4:7], v[160:163]
    ds_read_b128 a[36:39], v6 offset:17408
    v_mov_b64 v[178:179], 0
    v_mfma_f32_16x16x32_bf16 v[160:163], v[232:235], a[0:3], v[160:163]
    s_add_u32 m0, s65, 61920
    ds_read_b128 a[40:43], v6 offset:20480
    v_mov_b64 v[180:181], 0
    v_mfma_f32_16x16x32_bf16 v[164:167], v[232:235], a[8:11], v[164:167]
    buffer_load_dwordx4 v1, s[8:11], s50 offen lds
    v_mfma_f32_16x16x32_bf16 v[164:167], a[88:91], a[12:15], v[164:167]
    ds_read_b128 a[44:47], v6 offset:21504
    v_mov_b64 v[182:183], 0
    v_mfma_f32_16x16x32_bf16 v[84:87], v[240:243], a[12:15], v[84:87]
    s_waitcnt vmcnt(10)
    ds_read_b128 a[48:51], v6 offset:24576
    v_mov_b64 v[184:185], 0
    v_mfma_f32_16x16x32_bf16 v[84:87], a[88:91], a[8:11], v[84:87]
    s_add_u32 m0, s66, 61920
    ds_read_b128 a[52:55], v6 offset:25600
    v_xor_b32 v244, s80, v236
    v_mfma_f32_16x16x32_bf16 v[88:91], a[88:91], a[16:19], v[88:91]
    buffer_load_dwordx4 v1, s[8:11], s51 offen lds
    v_mfma_f32_16x16x32_bf16 v[88:91], v[240:243], a[20:23], v[88:91]
    ds_read_b128 a[56:59], v6 offset:28672
    v_xor_b32 v245, s80, v237
    v_mfma_f32_16x16x32_bf16 v[168:171], a[88:91], a[20:23], v[168:171]
    s_add_u32 m0, s67, 61920
    ds_read_b128 a[60:63], v6 offset:29696
    v_xor_b32 v246, s80, v238
    v_mfma_f32_16x16x32_bf16 v[168:171], v[232:235], a[16:19], v[168:171]
    buffer_load_dwordx4 v1, s[8:11], s52 offen lds
    v_mfma_f32_16x16x32_bf16 v[172:175], v[232:235], a[24:27], v[172:175]
    ds_read_b64_tr_b16 a[96:97], v3 offset:0
    v_xor_b32 v247, s80, v239
    v_mfma_f32_16x16x32_bf16 v[172:175], a[88:91], a[28:31], v[172:175]
    s_add_u32 m0, s68, 61920
    ds_read_b64_tr_b16 a[98:99], v4 offset:0
    v_mov_b64 v[186:187], 0
    v_mfma_f32_16x16x32_bf16 v[92:95], v[240:243], a[28:31], v[92:95]
    buffer_load_dwordx4 v1, s[8:11], s53 offen lds
    v_mfma_f32_16x16x32_bf16 v[92:95], a[88:91], a[24:27], v[92:95]
    s_waitcnt lgkmcnt(2)
    ds_read_b64_tr_b16 a[100:101], v3 offset:1024
    v_mov_b64 v[188:189], 0
    v_mfma_f32_16x16x32_bf16 v[16:19], a[92:95], a[32:35], v[16:19]
    ds_read_b64_tr_b16 a[102:103], v4 offset:1024
    v_mov_b64 v[190:191], 0
    v_mfma_f32_16x16x32_bf16 v[16:19], v[244:247], a[36:39], v[16:19]
    s_add_u32 m0, s69, 61920
    ds_read_b64_tr_b16 a[104:105], v3 offset:128
    v_mfma_f32_16x16x32_bf16 v[96:99], a[92:95], a[36:39], v[96:99]
    buffer_load_dwordx4 v1, s[8:11], s54 offen lds
    v_mfma_f32_16x16x32_bf16 v[96:99], v[236:239], a[32:35], v[96:99]
    s_add_u32 m0, s70, 61920
    ds_read_b64_tr_b16 a[106:107], v4 offset:128
    v_mfma_f32_16x16x32_bf16 v[100:103], v[236:239], a[40:43], v[100:103]
    s_waitcnt lgkmcnt(2)
    ds_read_b64_tr_b16 a[108:109], v3 offset:1152
    v_smfmac_f32_16x16x64_bf16 v[176:179], a[128:131], a[96:103], v250
    buffer_load_dwordx4 v1, s[8:11], s55 offen lds
    v_mfma_f32_16x16x32_bf16 v[100:103], a[92:95], a[44:47], v[100:103]
    ds_read_b64_tr_b16 a[110:111], v4 offset:1152
    v_mfma_f32_16x16x32_bf16 v[20:23], v[244:247], a[44:47], v[20:23]
    s_add_u32 m0, s71, 61920
    ds_read_b64_tr_b16 a[112:113], v3 offset:256
    v_mfma_f32_16x16x32_bf16 v[20:23], a[92:95], a[40:43], v[20:23]
    buffer_load_dwordx4 v1, s[8:11], s56 offen lds
    v_mfma_f32_16x16x32_bf16 v[24:27], a[92:95], a[48:51], v[24:27]
    s_waitcnt vmcnt(14)
    ds_read_b64_tr_b16 a[114:115], v4 offset:256
    v_mfma_f32_16x16x32_bf16 v[24:27], v[244:247], a[52:55], v[24:27]
    s_waitcnt lgkmcnt(2)
    ds_read_b64_tr_b16 a[116:117], v3 offset:1280
    v_xor_b32 v240, s80, v208
    v_smfmac_f32_16x16x64_bf16 v[180:183], a[128:131], a[104:111], v250
    s_add_u32 m0, s72, 61920
    ds_read_b64_tr_b16 a[118:119], v4 offset:1280
    v_xor_b32 v241, s80, v209
    v_mfma_f32_16x16x32_bf16 v[104:107], a[92:95], a[52:55], v[104:107]
    buffer_load_dwordx4 v1, s[8:11], s57 offen lds
    v_mfma_f32_16x16x32_bf16 v[104:107], v[236:239], a[48:51], v[104:107]
    ds_read_b64_tr_b16 a[120:121], v3 offset:384
    v_xor_b32 v242, s80, v210
    v_mfma_f32_16x16x32_bf16 v[108:111], v[236:239], a[56:59], v[108:111]
    s_add_u32 m0, s73, 61920
    ds_read_b64_tr_b16 a[122:123], v4 offset:384
    v_xor_b32 v243, s80, v211
    v_mfma_f32_16x16x32_bf16 v[108:111], a[92:95], a[60:63], v[108:111]
    buffer_load_dwordx4 v1, s[8:11], s58 offen lds
    v_mfma_f32_16x16x32_bf16 v[28:31], v[244:247], a[60:63], v[28:31]
    s_waitcnt lgkmcnt(2)
    ds_read_b64_tr_b16 a[124:125], v3 offset:1408
    v_cvt_pk_bf16_f32 v192, v176, v180
    v_smfmac_f32_16x16x64_bf16 v[184:187], a[128:131], a[112:119], v250
    s_add_u32 m0, s74, 61920
    ds_read_b64_tr_b16 a[126:127], v4 offset:1408
    v_cvt_pk_bf16_f32 v196, v177, v181
    v_mfma_f32_16x16x32_bf16 v[28:31], a[92:95], a[56:59], v[28:31]
    buffer_load_dwordx4 v1, s[8:11], s59 offen lds
    v_mfma_f32_16x16x32_bf16 v[32:35], a[64:67], a[32:35], v[32:35]
    ds_read_b64_tr_b16 a[96:97], v3 offset:2048
    v_cvt_pk_bf16_f32 v200, v178, v182
    v_mfma_f32_16x16x32_bf16 v[32:35], v[240:243], a[36:39], v[32:35]
    ds_read_b64_tr_b16 a[98:99], v4 offset:2048
    v_cvt_pk_bf16_f32 v204, v179, v183
    v_mfma_f32_16x16x32_bf16 v[112:115], a[64:67], a[36:39], v[112:115]
    s_add_u32 m0, s75, 61920
    ds_read_b64_tr_b16 a[100:101], v3 offset:3072
    v_mov_b64 v[176:177], 0
    v_mfma_f32_16x16x32_bf16 v[112:115], v[208:211], a[32:35], v[112:115]
    s_waitcnt lgkmcnt(3)
    buffer_load_dwordx4 v1, s[8:11], s60 offen lds
    v_smfmac_f32_16x16x64_bf16 v[188:191], a[128:131], a[120:127], v250
    ds_read_b64_tr_b16 a[102:103], v4 offset:3072
    v_mov_b64 v[178:179], 0
    v_mfma_f32_16x16x32_bf16 v[116:119], v[208:211], a[40:43], v[116:119]
    s_add_u32 m0, s76, 61920
    ds_read_b64_tr_b16 a[104:105], v3 offset:2176
    v_mov_b64 v[180:181], 0
    v_mfma_f32_16x16x32_bf16 v[116:119], a[64:67], a[44:47], v[116:119]
    buffer_load_dwordx4 v1, s[8:11], s61 offen lds
    v_mfma_f32_16x16x32_bf16 v[36:39], v[240:243], a[44:47], v[36:39]
    ds_read_b64_tr_b16 a[106:107], v4 offset:2176
    v_mov_b64 v[182:183], 0
    v_mfma_f32_16x16x32_bf16 v[36:39], a[64:67], a[40:43], v[36:39]
    s_add_u32 m0, s77, 61920
    ds_read_b64_tr_b16 a[108:109], v3 offset:3200
    v_mfma_f32_16x16x32_bf16 v[40:43], a[64:67], a[48:51], v[40:43]
    s_waitcnt lgkmcnt(3)
    buffer_load_dwordx4 v1, s[8:11], s62 offen lds
    v_smfmac_f32_16x16x64_bf16 v[176:179], a[128:131], a[96:103], v250
    s_waitcnt vmcnt(18)
    ds_read_b64_tr_b16 a[110:111], v4 offset:3200
    v_cvt_pk_bf16_f32 v193, v184, v188
    v_mfma_f32_16x16x32_bf16 v[40:43], v[240:243], a[52:55], v[40:43]
    s_add_u32 m0, s78, 61920
    ds_read_b64_tr_b16 a[112:113], v3 offset:2304
    v_cvt_pk_bf16_f32 v197, v185, v189
    v_mfma_f32_16x16x32_bf16 v[120:123], a[64:67], a[52:55], v[120:123]
    buffer_load_dwordx4 v1, s[8:11], s63 offen lds
    v_xor_b32 v245, s80, v213
    v_mfma_f32_16x16x32_bf16 v[120:123], v[208:211], a[48:51], v[120:123]
    ds_read_b64_tr_b16 a[114:115], v4 offset:2304
    v_cvt_pk_bf16_f32 v201, v186, v190
    v_xor_b32 v246, s80, v214
    v_mfma_f32_16x16x32_bf16 v[124:127], v[208:211], a[56:59], v[124:127]
    s_add_u32 m0, s79, 61920
    ds_read_b64_tr_b16 a[116:117], v3 offset:3328
    v_cvt_pk_bf16_f32 v205, v187, v191
    v_mfma_f32_16x16x32_bf16 v[124:127], a[64:67], a[60:63], v[124:127]
    s_waitcnt lgkmcnt(3)
    ds_read_b64_tr_b16 a[118:119], v4 offset:3328
    v_xor_b32 v244, s80, v212
    v_smfmac_f32_16x16x64_bf16 v[180:183], a[128:131], a[104:111], v250
    buffer_load_dwordx4 v1, s[8:11], s64 offen lds
    v_xor_b32 v247, s80, v215
    v_mfma_f32_16x16x32_bf16 v[44:47], v[240:243], a[60:63], v[44:47]
    ds_read_b64_tr_b16 a[120:121], v3 offset:2432
    v_add_u32 v1, 0x10000, v1
    v_mfma_f32_16x16x32_bf16 v[44:47], a[64:67], a[56:59], v[44:47]
    ds_read_b64_tr_b16 a[122:123], v4 offset:2432
    v_mov_b64 v[184:185], 0
    v_mfma_f32_16x16x32_bf16 v[48:51], a[68:71], a[32:35], v[48:51]
    buffer_load_dwordx4 a[80:83], v2, s[12:15], s44 offen offset:0 sc1
    v_mfma_f32_16x16x32_bf16 v[48:51], v[244:247], a[36:39], v[48:51]
    ds_read_b64_tr_b16 a[124:125], v3 offset:3456
    v_mov_b64 v[186:187], 0
    v_mfma_f32_16x16x32_bf16 v[128:131], a[68:71], a[36:39], v[128:131]
    s_waitcnt lgkmcnt(3)
    ds_read_b64_tr_b16 a[126:127], v4 offset:3456
    v_cvt_pk_bf16_f32 v194, v176, v180
    v_smfmac_f32_16x16x64_bf16 v[184:187], a[128:131], a[112:119], v250
    buffer_load_dwordx4 v[224:227], v2, s[12:15], s44 offen offset:1024 sc1
    v_mfma_f32_16x16x32_bf16 v[128:131], v[212:215], a[32:35], v[128:131]
    v_cvt_pk_bf16_f32 v198, v177, v181
    v_cvt_pk_bf16_f32 v202, v178, v182
    v_mfma_f32_16x16x32_bf16 v[132:135], v[212:215], a[40:43], v[132:135]
    v_cvt_pk_bf16_f32 v206, v179, v183
    v_mov_b64 v[188:189], 0
    v_mfma_f32_16x16x32_bf16 v[132:135], a[68:71], a[44:47], v[132:135]
    v_mov_b64 v[190:191], 0
    v_mfma_f32_16x16x32_bf16 v[52:55], v[244:247], a[44:47], v[52:55]
    buffer_load_dwordx4 a[84:87], v2, s[12:15], s45 offen offset:0 sc1
    v_mfma_f32_16x16x32_bf16 v[52:55], a[68:71], a[40:43], v[52:55]
    s_waitcnt lgkmcnt(0)
    v_smfmac_f32_16x16x64_bf16 v[188:191], a[128:131], a[120:127], v250
    s_waitcnt vmcnt(21)
    v_xor_b32 v240, s80, v216
    v_xor_b32 v241, s80, v217
    v_mfma_f32_16x16x32_bf16 v[56:59], a[68:71], a[48:51], v[56:59]
    buffer_load_dwordx4 v[228:231], v2, s[12:15], s45 offen offset:1024 sc1
    v_mfma_f32_16x16x32_bf16 v[56:59], v[244:247], a[52:55], v[56:59]
    v_xor_b32 v242, s80, v218
    v_xor_b32 v243, s80, v219
    v_mfma_f32_16x16x32_bf16 v[136:139], a[68:71], a[52:55], v[136:139]
    v_mfma_f32_16x16x32_bf16 v[136:139], v[212:215], a[48:51], v[136:139]
    buffer_load_dwordx4 a[88:91], v2, s[12:15], s46 offen offset:0 sc1
    v_mfma_f32_16x16x32_bf16 v[140:143], v[212:215], a[56:59], v[140:143]
    v_cvt_pk_bf16_f32 v195, v184, v188
    v_cvt_pk_bf16_f32 v199, v185, v189
    v_mfma_f32_16x16x32_bf16 v[140:143], a[68:71], a[60:63], v[140:143]
    v_cvt_pk_bf16_f32 v203, v186, v190
    v_cvt_pk_bf16_f32 v207, v187, v191
    v_mfma_f32_16x16x32_bf16 v[60:63], v[244:247], a[60:63], v[60:63]
    ds_write_b128 v5, v[192:195] offset:0
    v_mfma_f32_16x16x32_bf16 v[60:63], a[68:71], a[56:59], v[60:63]
    buffer_load_dwordx4 v[232:235], v2, s[12:15], s46 offen offset:1024 sc1
    v_mfma_f32_16x16x32_bf16 v[64:67], a[72:75], a[32:35], v[64:67]
    v_mfma_f32_16x16x32_bf16 v[64:67], v[240:243], a[36:39], v[64:67]
    ds_write_b128 v5, v[196:199] offset:1024
    v_mfma_f32_16x16x32_bf16 v[144:147], a[72:75], a[36:39], v[144:147]
    buffer_load_dwordx4 a[92:95], v2, s[12:15], s47 offen offset:0 sc1
    v_mfma_f32_16x16x32_bf16 v[144:147], v[216:219], a[32:35], v[144:147]
    v_mfma_f32_16x16x32_bf16 v[148:151], v[216:219], a[40:43], v[148:151]
    ds_write_b128 v5, v[200:203] offset:2048
    v_mfma_f32_16x16x32_bf16 v[148:151], a[72:75], a[44:47], v[148:151]
    buffer_load_dwordx4 v[236:239], v2, s[12:15], s47 offen offset:1024 sc1
    v_mfma_f32_16x16x32_bf16 v[68:71], v[240:243], a[44:47], v[68:71]
    v_mfma_f32_16x16x32_bf16 v[68:71], a[72:75], a[40:43], v[68:71]
    s_waitcnt vmcnt(24)
    ds_write_b128 v5, v[204:207] offset:3072
    v_mfma_f32_16x16x32_bf16 v[72:75], a[72:75], a[48:51], v[72:75]
    v_xor_b32 v244, s80, v220
    v_xor_b32 v245, s80, v221
    v_mfma_f32_16x16x32_bf16 v[72:75], v[240:243], a[52:55], v[72:75]
    buffer_load_dwordx4 a[64:67], v2, s[12:15], s48 offen offset:0 sc1
    v_mfma_f32_16x16x32_bf16 v[152:155], a[72:75], a[52:55], v[152:155]
    v_xor_b32 v246, s80, v222
    v_xor_b32 v247, s80, v223
    v_mfma_f32_16x16x32_bf16 v[152:155], v[216:219], a[48:51], v[152:155]
    v_mfma_f32_16x16x32_bf16 v[156:159], v[216:219], a[56:59], v[156:159]
    buffer_load_dwordx4 v[208:211], v2, s[12:15], s48 offen offset:1024 sc1
    v_mfma_f32_16x16x32_bf16 v[156:159], a[72:75], a[60:63], v[156:159]
L_pad8:
    s_cbranch_execz L_back
    v_add_u32 v2, 10240, v2
    v_mfma_f32_16x16x32_bf16 v[76:79], v[240:243], a[60:63], v[76:79]
    v_mfma_f32_16x16x32_bf16 v[76:79], a[72:75], a[56:59], v[76:79]
    s_waitcnt vmcnt(10) lgkmcnt(0)
    s_cmp_lg_u32 s36, 0
    s_cbranch_scc1 L_pd6
    s_mov_b32 s39, 0
L_pl6:
    v_cmp_ne_u32 vcc, s100, v10
    s_add_u32 s39, s39, 1
    s_nop 0
    s_and_b32 s38, vcc_lo, 204
    s_cbranch_scc0 L_pd6
    s_cmp_ge_u32 s39, 200000
    s_cbranch_scc1 L_pd6
    buffer_load_dword v10, v9, s[40:43], s95 offen sc1
    s_waitcnt vmcnt(0)
    s_branch L_pl6
L_pd6:
    s_barrier
    v_mfma_f32_16x16x32_bf16 v[80:83], a[76:79], a[32:35], v[80:83]
    ds_read_b128 a[0:3], v6 offset:0
    v_add_u32 v13, 4294823936, v2
    v_add_u32 v14, 4294834176, v2
    v_mfma_f32_16x16x32_bf16 v[80:83], v[244:247], a[36:39], v[80:83]
    ds_read_b128 a[4:7], v6 offset:1024
    v_mov_b64 v[176:177], 0
    v_mfma_f32_16x16x32_bf16 v[160:163], a[76:79], a[36:39], v[160:163]
    buffer_load_dwordx4 a[248:251], v248, s[4:7], s94 offen offset:0 sc1
    v_mfma_f32_16x16x32_bf16 v[160:163], v[220:223], a[32:35], v[160:163]
    ds_read_b128 a[8:11], v6 offset:4096
    v_mov_b64 v[178:179], 0
    v_mfma_f32_16x16x32_bf16 v[164:167], v[220:223], a[40:43], v[164:167]
    ds_read_b128 a[12:15], v6 offset:5120
    v_mov_b64 v[180:181], 0
    v_mfma_f32_16x16x32_bf16 v[164:167], a[76:79], a[44:47], v[164:167]
    ds_read_b128 a[16:19], v6 offset:8192
    v_mov_b64 v[182:183], 0
    v_mfma_f32_16x16x32_bf16 v[84:87], v[244:247], a[44:47], v[84:87]
    ds_read_b128 a[20:23], v6 offset:9216
    v_mov_b64 v[184:185], 0
    v_mfma_f32_16x16x32_bf16 v[84:87], a[76:79], a[40:43], v[84:87]
    s_waitcnt vmcnt(9)
    buffer_load_dwordx4 a[252:255], v248, s[4:7], s94 offen offset:1024 sc1
    v_mfma_f32_16x16x32_bf16 v[88:91], a[76:79], a[48:51], v[88:91]
    ds_read_b128 a[24:27], v6 offset:12288
    v_xor_b32 v240, s80, v224
    v_mfma_f32_16x16x32_bf16 v[88:91], v[244:247], a[52:55], v[88:91]
    ds_read_b128 a[28:31], v6 offset:13312
    v_xor_b32 v241, s80, v225
    v_mfma_f32_16x16x32_bf16 v[168:171], a[76:79], a[52:55], v[168:171]
    ds_read_b64_tr_b16 a[96:97], v3 offset:61920
    v_xor_b32 v242, s80, v226
    v_mfma_f32_16x16x32_bf16 v[168:171], v[220:223], a[48:51], v[168:171]
    buffer_load_dwordx4 a[248:251], v248, s[4:7], s94 offen offset:2048 sc1
    v_mfma_f32_16x16x32_bf16 v[172:175], v[220:223], a[56:59], v[172:175]
    ds_read_b64_tr_b16 a[98:99], v4 offset:61920
    v_xor_b32 v243, s80, v227
    v_mfma_f32_16x16x32_bf16 v[172:175], a[76:79], a[60:63], v[172:175]
    ds_read_b64_tr_b16 a[100:101], v3 offset:62944
    v_mov_b64 v[186:187], 0
    v_mfma_f32_16x16x32_bf16 v[92:95], v[244:247], a[60:63], v[92:95]
    ds_read_b64_tr_b16 a[102:103], v4 offset:62944
    v_mov_b64 v[188:189], 0
    v_mfma_f32_16x16x32_bf16 v[92:95], a[76:79], a[56:59], v[92:95]
    s_waitcnt lgkmcnt(4)
    ds_read_b64_tr_b16 a[104:105], v3 offset:62048
    v_mov_b64 v[190:191], 0
    v_mfma_f32_16x16x32_bf16 v[16:19], a[80:83], a[0:3], v[16:19]
    buffer_load_dwordx4 a[252:255], v248, s[4:7], s94 offen offset:3072 sc1
    v_mfma_f32_16x16x32_bf16 v[16:19], v[240:243], a[4:7], v[16:19]
    ds_read_b64_tr_b16 a[106:107], v4 offset:62048
    v_mfma_f32_16x16x32_bf16 v[96:99], a[80:83], a[4:7], v[96:99]
    ds_read_b64_tr_b16 a[108:109], v3 offset:63072
    v_mfma_f32_16x16x32_bf16 v[96:99], v[224:227], a[0:3], v[96:99]
    ds_read_b64_tr_b16 a[110:111], v4 offset:63072
    v_mfma_f32_16x16x32_bf16 v[100:103], v[224:227], a[8:11], v[100:103]
    s_waitcnt lgkmcnt(4)
    v_smfmac_f32_16x16x64_bf16 v[176:179], a[128:131], a[96:103], v250
    buffer_load_dwordx4 a[68:71], v2, s[12:15], s44 offen offset:0 sc1
    v_mfma_f32_16x16x32_bf16 v[100:103], a[80:83], a[12:15], v[100:103]
    ds_read_b64_tr_b16 a[112:113], v3 offset:62176
    v_mfma_f32_16x16x32_bf16 v[20:23], v[240:243], a[12:15], v[20:23]
    ds_read_b64_tr_b16 a[114:115], v4 offset:62176
    v_mfma_f32_16x16x32_bf16 v[20:23], a[80:83], a[8:11], v[20:23]
    ds_read_b64_tr_b16 a[116:117], v3 offset:63200
    v_mfma_f32_16x16x32_bf16 v[24:27], a[80:83], a[16:19], v[24:27]
    s_waitcnt vmcnt(11)
    ds_read_b64_tr_b16 a[118:119], v4 offset:63200
    v_mfma_f32_16x16x32_bf16 v[24:27], v[240:243], a[20:23], v[24:27]
    s_waitcnt lgkmcnt(4)
    buffer_load_dwordx4 v[212:215], v2, s[12:15], s44 offen offset:1024 sc1
    v_smfmac_f32_16x16x64_bf16 v[180:183], a[128:131], a[104:111], v250
    ds_read_b64_tr_b16 a[120:121], v3 offset:62304
    v_xor_b32 v244, s80, v228
    v_mfma_f32_16x16x32_bf16 v[104:107], a[80:83], a[20:23], v[104:107]
    ds_read_b64_tr_b16 a[122:123], v4 offset:62304
    v_xor_b32 v245, s80, v229
    v_mfma_f32_16x16x32_bf16 v[104:107], v[224:227], a[16:19], v[104:107]
    ds_read_b64_tr_b16 a[124:125], v3 offset:63328
    v_xor_b32 v246, s80, v230
    v_mfma_f32_16x16x32_bf16 v[108:111], v[224:227], a[24:27], v[108:111]
    ds_read_b64_tr_b16 a[126:127], v4 offset:63328
    v_xor_b32 v247, s80, v231
    v_mfma_f32_16x16x32_bf16 v[108:111], a[80:83], a[28:31], v[108:111]
    buffer_load_dwordx4 a[72:75], v13, s[12:15], s44 offen offset:0 sc1
    v_mfma_f32_16x16x32_bf16 v[28:31], v[240:243], a[28:31], v[28:31]
    s_waitcnt lgkmcnt(4)
    v_cvt_pk_bf16_f32 v192, v176, v180
    v_cvt_pk_bf16_f32 v196, v177, v181
    v_smfmac_f32_16x16x64_bf16 v[184:187], a[128:131], a[112:119], v250
    ds_read_b64_tr_b16 a[96:97], v3 offset:63968
    v_cvt_pk_bf16_f32 v200, v178, v182
    v_mfma_f32_16x16x32_bf16 v[28:31], a[80:83], a[24:27], v[28:31]
    ds_read_b64_tr_b16 a[98:99], v4 offset:63968
    v_cvt_pk_bf16_f32 v204, v179, v183
    v_mfma_f32_16x16x32_bf16 v[32:35], a[84:87], a[0:3], v[32:35]
    buffer_load_dwordx4 v[216:219], v13, s[12:15], s44 offen offset:1024 sc1
    v_mfma_f32_16x16x32_bf16 v[32:35], v[244:247], a[4:7], v[32:35]
    ds_read_b64_tr_b16 a[100:101], v3 offset:64992
    v_mov_b64 v[176:177], 0
    v_mfma_f32_16x16x32_bf16 v[112:115], a[84:87], a[4:7], v[112:115]
    ds_read_b64_tr_b16 a[102:103], v4 offset:64992
    v_mov_b64 v[178:179], 0
    v_mfma_f32_16x16x32_bf16 v[112:115], v[228:231], a[0:3], v[112:115]
    s_waitcnt lgkmcnt(4)
    ds_write_b128 v12, a[152:155] offset:0
    v_smfmac_f32_16x16x64_bf16 v[188:191], a[128:131], a[120:127], v250
    ds_read_b64_tr_b16 a[104:105], v3 offset:64096
    v_mov_b64 v[180:181], 0
    v_mfma_f32_16x16x32_bf16 v[116:119], v[228:231], a[8:11], v[116:119]
    buffer_load_dwordx4 a[76:79], v14, s[12:15], s44 offen offset:0 sc1
    v_mfma_f32_16x16x32_bf16 v[116:119], a[84:87], a[12:15], v[116:119]
    ds_read_b64_tr_b16 a[106:107], v4 offset:64096
    v_mov_b64 v[182:183], 0
    v_mfma_f32_16x16x32_bf16 v[36:39], v[244:247], a[12:15], v[36:39]
    ds_read_b64_tr_b16 a[108:109], v3 offset:65120
    v_mfma_f32_16x16x32_bf16 v[36:39], a[84:87], a[8:11], v[36:39]
    ds_read_b64_tr_b16 a[110:111], v4 offset:65120
    v_mfma_f32_16x16x32_bf16 v[40:43], a[84:87], a[16:19], v[40:43]
    s_waitcnt lgkmcnt(5)
    v_cvt_pk_bf16_f32 v193, v184, v188
    v_cvt_pk_bf16_f32 v197, v185, v189
    v_smfmac_f32_16x16x64_bf16 v[176:179], a[128:131], a[96:103], v250
    s_waitcnt vmcnt(13)
    buffer_load_dwordx4 v[220:223], v14, s[12:15], s44 offen offset:1024 sc1
    v_mfma_f32_16x16x32_bf16 v[40:43], v[244:247], a[20:23], v[40:43]
    ds_read_b64_tr_b16 a[112:113], v3 offset:64224
    v_cvt_pk_bf16_f32 v201, v186, v190
    v_mfma_f32_16x16x32_bf16 v[120:123], a[84:87], a[20:23], v[120:123]
    ds_read_b64_tr_b16 a[114:115], v4 offset:64224
    v_cvt_pk_bf16_f32 v205, v187, v191
    v_mov_b64 v[188:189], 0
    v_mfma_f32_16x16x32_bf16 v[120:123], v[228:231], a[16:19], v[120:123]
    ds_read_b64_tr_b16 a[116:117], v3 offset:65248
    v_xor_b32 v240, s80, v232
    v_mov_b64 v[190:191], 0
    v_mfma_f32_16x16x32_bf16 v[124:127], v[228:231], a[24:27], v[124:127]
    ds_read_b64_tr_b16 a[118:119], v4 offset:65248
    v_xor_b32 v241, s80, v233
    v_mfma_f32_16x16x32_bf16 v[124:127], a[84:87], a[28:31], v[124:127]
    s_waitcnt lgkmcnt(4)
    buffer_load_dwordx4 a[80:83], v2, s[12:15], s45 offen offset:0 sc1
    v_smfmac_f32_16x16x64_bf16 v[180:183], a[128:131], a[104:111], v250
    ds_read_b64_tr_b16 a[120:121], v3 offset:64352
    v_xor_b32 v242, s80, v234
    v_mfma_f32_16x16x32_bf16 v[44:47], v[244:247], a[28:31], v[44:47]
    ds_read_b64_tr_b16 a[122:123], v4 offset:64352
    v_xor_b32 v243, s80, v235
    v_mfma_f32_16x16x32_bf16 v[44:47], a[84:87], a[24:27], v[44:47]
    ds_read_b64_tr_b16 a[124:125], v3 offset:65376
    v_mov_b64 v[184:185], 0
    v_mfma_f32_16x16x32_bf16 v[48:51], a[88:91], a[0:3], v[48:51]
    buffer_load_dwordx4 v[224:227], v2, s[12:15], s45 offen offset:1024 sc1
    v_mfma_f32_16x16x32_bf16 v[48:51], v[240:243], a[4:7], v[48:51]
    ds_read_b64_tr_b16 a[126:127], v4 offset:65376
    v_mov_b64 v[186:187], 0
    v_mfma_f32_16x16x32_bf16 v[128:131], a[88:91], a[4:7], v[128:131]
    s_waitcnt lgkmcnt(4)
    v_cvt_pk_bf16_f32 v194, v176, v180
    v_cvt_pk_bf16_f32 v198, v177, v181
    v_smfmac_f32_16x16x64_bf16 v[184:187], a[128:131], a[112:119], v250
    v_cvt_pk_bf16_f32 v202, v178, v182
    v_cvt_pk_bf16_f32 v206, v179, v183
    v_mfma_f32_16x16x32_bf16 v[128:131], v[232:235], a[0:3], v[128:131]
    ds_write_b128 v12, a[156:159] offset:1024
    v_mfma_f32_16x16x32_bf16 v[132:135], v[232:235], a[8:11], v[132:135]
    buffer_load_dwordx4 a[84:87], v13, s[12:15], s45 offen offset:0 sc1
    v_mfma_f32_16x16x32_bf16 v[132:135], a[88:91], a[12:15], v[132:135]
    ds_write_b128 v12, a[160:163] offset:2048
    v_mfma_f32_16x16x32_bf16 v[52:55], v[240:243], a[12:15], v[52:55]
    ds_write_b128 v12, a[164:167] offset:3072
    v_mfma_f32_16x16x32_bf16 v[52:55], a[88:91], a[8:11], v[52:55]
    s_waitcnt lgkmcnt(3)
    ds_write_b128 v12, a[168:171] offset:16384
    v_smfmac_f32_16x16x64_bf16 v[188:191], a[128:131], a[120:127], v250
    s_waitcnt vmcnt(15)
    ds_write_b128 v12, a[172:175] offset:17408
    v_mfma_f32_16x16x32_bf16 v[56:59], a[88:91], a[16:19], v[56:59]
    buffer_load_dwordx4 v[228:231], v13, s[12:15], s45 offen offset:1024 sc1
    v_xor_b32 v246, s80, v238
    v_mfma_f32_16x16x32_bf16 v[56:59], v[240:243], a[20:23], v[56:59]
    ds_write_b128 v12, a[176:179] offset:18432
    v_xor_b32 v247, s80, v239
    v_mfma_f32_16x16x32_bf16 v[136:139], a[88:91], a[20:23], v[136:139]
    ds_write_b128 v12, a[180:183] offset:19456
    v_mfma_f32_16x16x32_bf16 v[136:139], v[232:235], a[16:19], v[136:139]
    v_xor_b32 v244, s80, v236
    v_xor_b32 v245, s80, v237
    v_mfma_f32_16x16x32_bf16 v[140:143], v[232:235], a[24:27], v[140:143]
    v_cvt_pk_bf16_f32 v195, v184, v188
    v_cvt_pk_bf16_f32 v199, v185, v189
    v_mfma_f32_16x16x32_bf16 v[140:143], a[88:91], a[28:31], v[140:143]
    s_mov_b32 s49, 0
    buffer_load_dwordx4 a[184:187], v248, s[4:7], s49 offen offset:0 sc1
    v_mfma_f32_16x16x32_bf16 v[60:63], v[240:243], a[28:31], v[60:63]
    v_cvt_pk_bf16_f32 v203, v186, v190
    v_cvt_pk_bf16_f32 v207, v187, v191
    v_mfma_f32_16x16x32_bf16 v[60:63], a[88:91], a[24:27], v[60:63]
    ds_write_b128 v5, v[192:195] offset:16384
    v_mfma_f32_16x16x32_bf16 v[64:67], a[92:95], a[0:3], v[64:67]
    v_mfma_f32_16x16x32_bf16 v[64:67], v[244:247], a[4:7], v[64:67]
    v_mfma_f32_16x16x32_bf16 v[144:147], a[92:95], a[4:7], v[144:147]
    buffer_load_dwordx4 a[188:191], v248, s[4:7], s49 offen offset:1024 sc1
    v_mfma_f32_16x16x32_bf16 v[144:147], v[236:239], a[0:3], v[144:147]
    ds_write_b128 v5, v[196:199] offset:17408
    v_mfma_f32_16x16x32_bf16 v[148:151], v[236:239], a[8:11], v[148:151]
    v_mfma_f32_16x16x32_bf16 v[148:151], a[92:95], a[12:15], v[148:151]
    v_mfma_f32_16x16x32_bf16 v[68:71], v[244:247], a[12:15], v[68:71]
    buffer_load_dwordx4 a[192:195], v248, s[4:7], s49 offen offset:2048 sc1
    v_mfma_f32_16x16x32_bf16 v[68:71], a[92:95], a[8:11], v[68:71]
    s_waitcnt vmcnt(17)
    ds_write_b128 v5, v[200:203] offset:18432
    v_mfma_f32_16x16x32_bf16 v[72:75], a[92:95], a[16:19], v[72:75]
    v_xor_b32 v240, s80, v208
    v_xor_b32 v241, s80, v209
    v_mfma_f32_16x16x32_bf16 v[72:75], v[244:247], a[20:23], v[72:75]
    v_xor_b32 v242, s80, v210
    v_xor_b32 v243, s80, v211
    v_mfma_f32_16x16x32_bf16 v[152:155], a[92:95], a[20:23], v[152:155]
    ds_write_b128 v5, v[204:207] offset:19456
    v_mfma_f32_16x16x32_bf16 v[152:155], v[236:239], a[16:19], v[152:155]
    buffer_load_dwordx4 a[196:199], v248, s[4:7], s49 offen offset:3072 sc1
    v_mfma_f32_16x16x32_bf16 v[156:159], v[236:239], a[24:27], v[156:159]
    v_mfma_f32_16x16x32_bf16 v[156:159], a[92:95], a[28:31], v[156:159]
    v_mfma_f32_16x16x32_bf16 v[76:79], v[244:247], a[28:31], v[76:79]
    v_mfma_f32_16x16x32_bf16 v[76:79], a[92:95], a[24:27], v[76:79]
    s_waitcnt lgkmcnt(0)
    s_barrier
    v_mfma_f32_16x16x32_bf16 v[80:83], a[64:67], a[0:3], v[80:83]
    s_add_u32 s16, s26, 16777216
    ds_read_b128 a[32:35], v6 offset:16384
    v_mfma_f32_16x16x32_bf16 v[80:83], v[240:243], a[4:7], v[80:83]
    s_addc_u32 s17, s27, 0
    ds_read_b128 a[36:39], v6 offset:17408
    v_mfma_f32_16x16x32_bf16 v[160:163], a[64:67], a[4:7], v[160:163]
    s_mov_b32 s18, 21667840
    ds_read_b128 a[40:43], v6 offset:20480
    v_mfma_f32_16x16x32_bf16 v[160:163], v[208:211], a[0:3], v[160:163]
    s_mov_b32 s19, 0x20000
    buffer_load_dwordx4 a[88:91], v14, s[12:15], s45 offen offset:0 sc1
    v_mfma_f32_16x16x32_bf16 v[164:167], v[208:211], a[8:11], v[164:167]
    s_and_b32 s38, s36, 1
    ds_read_b128 a[44:47], v6 offset:21504
    v_mfma_f32_16x16x32_bf16 v[164:167], a[64:67], a[12:15], v[164:167]
    s_mul_i32 s38, s38, 10833920
    ds_read_b128 a[48:51], v6 offset:24576
    v_mfma_f32_16x16x32_bf16 v[84:87], v[240:243], a[12:15], v[84:87]
    s_lshr_b32 s39, s36, 1
    ds_read_b128 a[52:55], v6 offset:25600
    v_mfma_f32_16x16x32_bf16 v[84:87], a[64:67], a[8:11], v[84:87]
    s_waitcnt vmcnt(13)
    s_lshl_b32 s37, s32, 1
    buffer_load_dwordx4 v[232:235], v14, s[12:15], s45 offen offset:1024 sc1
    v_mfma_f32_16x16x32_bf16 v[88:91], a[64:67], a[16:19], v[88:91]
    s_add_u32 s39, s39, s37
    ds_read_b128 a[56:59], v6 offset:28672
    v_xor_b32 v244, s80, v212
    v_mfma_f32_16x16x32_bf16 v[88:91], v[240:243], a[20:23], v[88:91]
    s_lshl_b32 s39, s39, 12
    ds_read_b128 a[60:63], v6 offset:29696
    v_xor_b32 v245, s80, v213
    v_mfma_f32_16x16x32_bf16 v[168:171], a[64:67], a[20:23], v[168:171]
    s_add_u32 s38, s38, s39
    ds_read_b128 a[96:99], v15 offset:0
    v_xor_b32 v246, s80, v214
    v_mfma_f32_16x16x32_bf16 v[168:171], v[208:211], a[16:19], v[168:171]
    s_lshl_b32 s39, s33, 8
    buffer_load_dwordx4 a[92:95], v2, s[12:15], s46 offen offset:0 sc1
    v_mfma_f32_16x16x32_bf16 v[172:175], v[208:211], a[24:27], v[172:175]
    s_add_u32 s38, s38, s39
    ds_read_b128 a[100:103], v15 offset:1024
    v_xor_b32 v247, s80, v215
    v_mfma_f32_16x16x32_bf16 v[172:175], a[64:67], a[28:31], v[172:175]
    s_mul_i32 s68, s44, 1058
    ds_read_b128 a[104:107], v15 offset:4096
    v_mfma_f32_16x16x32_bf16 v[92:95], v[240:243], a[28:31], v[92:95]
    s_add_u32 s68, s68, s38
    ds_read_b128 a[108:111], v15 offset:5120
    v_mfma_f32_16x16x32_bf16 v[92:95], a[64:67], a[24:27], v[92:95]
    s_waitcnt lgkmcnt(4)
    s_mul_i32 s69, s45, 1058
    buffer_load_dwordx4 v[236:239], v2, s[12:15], s46 offen offset:1024 sc1
    v_mfma_f32_16x16x32_bf16 v[16:19], a[68:71], a[32:35], v[16:19]
    s_add_u32 s69, s69, s38
    ds_read_b128 a[112:115], v15 offset:8192
    v_mfma_f32_16x16x32_bf16 v[16:19], v[244:247], a[36:39], v[16:19]
    s_mul_i32 s70, s46, 1058
    ds_read_b128 a[116:119], v15 offset:9216
    v_mfma_f32_16x16x32_bf16 v[96:99], a[68:71], a[36:39], v[96:99]
    s_add_u32 s70, s70, s38
    ds_read_b128 a[120:123], v15 offset:12288
    v_mfma_f32_16x16x32_bf16 v[96:99], v[212:215], a[32:35], v[96:99]
    s_mul_i32 s71, s47, 1058
    buffer_load_dwordx4 a[64:67], v13, s[12:15], s46 offen offset:0 sc1
    v_mfma_f32_16x16x32_bf16 v[100:103], v[212:215], a[40:43], v[100:103]
    s_add_u32 s71, s71, s38
    ds_read_b128 a[124:127], v15 offset:13312
    v_mfma_f32_16x16x32_bf16 v[100:103], a[68:71], a[44:47], v[100:103]
    s_mul_i32 s72, s48, 1058
    ds_read_b128 a[0:3], v15 offset:16384
    v_mfma_f32_16x16x32_bf16 v[20:23], v[244:247], a[44:47], v[20:23]
    s_add_u32 s72, s72, s38
    ds_read_b128 a[4:7], v15 offset:17408
    v_mfma_f32_16x16x32_bf16 v[20:23], a[68:71], a[40:43], v[20:23]
    s_waitcnt vmcnt(15)
    s_and_b32 s31, s96, 7
    buffer_load_dwordx4 v[208:211], v13, s[12:15], s46 offen offset:1024 sc1
    v_mfma_f32_16x16x32_bf16 v[24:27], a[68:71], a[48:51], v[24:27]
    s_lshr_b32 s51, s96, 3
    ds_read_b128 a[8:11], v15 offset:20480
    v_xor_b32 v240, s80, v216
    v_mfma_f32_16x16x32_bf16 v[24:27], v[244:247], a[52:55], v[24:27]
    s_lshl_b32 s51, s51, 1
    ds_read_b128 a[12:15], v15 offset:21504
    v_xor_b32 v241, s80, v217
    v_mfma_f32_16x16x32_bf16 v[104:107], a[68:71], a[52:55], v[104:107]
    s_and_b32 s30, s29, 1
    ds_read_b128 a[16:19], v15 offset:24576
    v_xor_b32 v242, s80, v218
    v_mfma_f32_16x16x32_bf16 v[104:107], v[212:215], a[48:51], v[104:107]
    s_add_u32 s51, s51, s30
    ds_read_b128 a[20:23], v15 offset:25600
    v_xor_b32 v243, s80, v219
    v_mfma_f32_16x16x32_bf16 v[108:111], v[212:215], a[56:59], v[108:111]
    s_mul_i32 s53, s31, 41
    ds_read_b128 a[24:27], v15 offset:28672
    v_mfma_f32_16x16x32_bf16 v[108:111], a[68:71], a[60:63], v[108:111]
    s_lshr_b32 s53, s53, 6
    ds_read_b128 a[28:31], v15 offset:29696
    v_mfma_f32_16x16x32_bf16 v[28:31], v[244:247], a[60:63], v[28:31]
    s_lshr_b32 s50, s29, 2
    s_mov_b32 s49, 4096
    buffer_load_dwordx4 a[200:203], v248, s[4:7], s49 offen offset:0 sc1
    v_mfma_f32_16x16x32_bf16 v[28:31], a[68:71], a[56:59], v[28:31]
    s_waitcnt lgkmcnt(8)
    s_bfe_u32 s52, s29, 0x10001
    v_mfma_f32_16x16x32_bf16 v[16:19], a[72:75], a[96:99], v[16:19]
    s_lshl_b32 s50, s50, 3
    buffer_load_dwordx4 a[68:71], v14, s[12:15], s46 offen offset:0 sc1
    v_mfma_f32_16x16x32_bf16 v[16:19], v[240:243], a[100:103], v[16:19]
    s_add_u32 s50, s50, s51
    buffer_load_dwordx4 a[204:207], v248, s[4:7], s49 offen offset:1024 sc1
    v_mfma_f32_16x16x32_bf16 v[96:99], a[72:75], a[100:103], v[96:99]
    s_mul_i32 s57, s51, 5
    buffer_load_dwordx4 a[208:211], v248, s[4:7], s49 offen offset:2048 sc1
    v_mfma_f32_16x16x32_bf16 v[96:99], v[216:219], a[96:99], v[96:99]
    s_add_u32 s57, s57, s53
    v_mfma_f32_16x16x32_bf16 v[100:103], v[216:219], a[104:107], v[100:103]
    s_mul_i32 s60, s50, 5
    buffer_load_dwordx4 v[212:215], v14, s[12:15], s46 offen offset:1024 sc1
    v_mfma_f32_16x16x32_bf16 v[100:103], a[72:75], a[108:111], v[100:103]
    s_add_u32 s60, s60, s53
    v_mfma_f32_16x16x32_bf16 v[20:23], v[240:243], a[108:111], v[20:23]
    s_lshl_b32 s60, s60, 1
    v_mfma_f32_16x16x32_bf16 v[20:23], a[72:75], a[104:107], v[20:23]
    s_waitcnt vmcnt(19)
    s_add_u32 s60, s60, s52
    v_xor_b32 v244, s80, v220
    v_xor_b32 v245, s80, v221
    v_mfma_f32_16x16x32_bf16 v[24:27], a[72:75], a[112:115], v[24:27]
    s_mul_i32 s60, s60, 135424
    v_xor_b32 v246, s80, v222
    v_xor_b32 v247, s80, v223
    v_mfma_f32_16x16x32_bf16 v[24:27], v[240:243], a[116:119], v[24:27]
    s_add_u32 s64, s60, 270848
    v_mfma_f32_16x16x32_bf16 v[104:107], a[72:75], a[116:119], v[104:107]
    s_cmp_gt_u32 s89, 24
    s_cselect_b32 s64, s64, 0x40000000
    s_addc_u32 s57, s57, 0
    v_mfma_f32_16x16x32_bf16 v[104:107], v[216:219], a[112:115], v[104:107]
    s_add_u32 s61, s60, 32768
    v_mfma_f32_16x16x32_bf16 v[108:111], v[216:219], a[120:123], v[108:111]
    s_add_u32 s65, s64, 32768
    v_mfma_f32_16x16x32_bf16 v[108:111], a[72:75], a[124:127], v[108:111]
    s_add_u32 s62, s60, 65536
    v_mfma_f32_16x16x32_bf16 v[28:31], v[240:243], a[124:127], v[28:31]
    s_add_u32 s66, s64, 65536
    v_mfma_f32_16x16x32_bf16 v[28:31], a[72:75], a[120:123], v[28:31]
    s_waitcnt lgkmcnt(0)
    s_add_u32 s63, s60, 98304
    v_mfma_f32_16x16x32_bf16 v[16:19], a[76:79], a[0:3], v[16:19]
    s_add_u32 s67, s64, 98304
    buffer_load_dwordx4 a[72:75], v2, s[12:15], s47 offen offset:0 sc1
    v_mfma_f32_16x16x32_bf16 v[16:19], v[244:247], a[4:7], v[16:19]
    s_mul_i32 s55, s50, 512000
    buffer_load_dwordx4 a[212:215], v248, s[4:7], s49 offen offset:3072 sc1
    v_mfma_f32_16x16x32_bf16 v[96:99], a[76:79], a[4:7], v[96:99]
    s_add_u32 s10, s55, 512000
    v_mfma_f32_16x16x32_bf16 v[96:99], v[220:223], a[0:3], v[96:99]
    s_lshl_b32 s54, s31, 6
    v_mfma_f32_16x16x32_bf16 v[100:103], v[220:223], a[8:11], v[100:103]
    s_add_u32 s54, s54, s52
    buffer_load_dwordx4 v[216:219], v2, s[12:15], s47 offen offset:1024 sc1
    v_mfma_f32_16x16x32_bf16 v[100:103], a[76:79], a[12:15], v[100:103]
    s_lshl_b32 s54, s54, 10
    v_mfma_f32_16x16x32_bf16 v[20:23], v[244:247], a[12:15], v[20:23]
    s_add_u32 s54, s54, s55
    v_mfma_f32_16x16x32_bf16 v[20:23], a[76:79], a[8:11], v[20:23]
    s_waitcnt vmcnt(20)
    s_mov_b32 s8, s22
    v_xor_b32 v240, s80, v224
    v_xor_b32 v241, s80, v225
    v_mfma_f32_16x16x32_bf16 v[24:27], a[76:79], a[16:19], v[24:27]
    s_mov_b32 s9, s23
    v_xor_b32 v242, s80, v226
    v_xor_b32 v243, s80, v227
    v_mfma_f32_16x16x32_bf16 v[24:27], v[244:247], a[20:23], v[24:27]
    s_mov_b32 s11, 0x20000
    v_mfma_f32_16x16x32_bf16 v[104:107], a[76:79], a[20:23], v[104:107]
    s_lshl_b32 s56, s36, 10
    v_mfma_f32_16x16x32_bf16 v[104:107], v[220:223], a[16:19], v[104:107]
    s_mov_b32 s35, 0x42200000
    v_mfma_f32_16x16x32_bf16 v[108:111], v[220:223], a[24:27], v[108:111]
    v_mfma_f32_16x16x32_bf16 v[108:111], a[76:79], a[28:31], v[108:111]
    v_mfma_f32_16x16x32_bf16 v[28:31], v[244:247], a[28:31], v[28:31]
    v_mfma_f32_16x16x32_bf16 v[28:31], a[76:79], a[24:27], v[28:31]
    v_mfma_f32_16x16x32_bf16 v[32:35], a[80:83], a[32:35], v[32:35]
    buffer_load_dwordx4 a[76:79], v13, s[12:15], s47 offen offset:0 sc1
    v_mfma_f32_16x16x32_bf16 v[32:35], v[240:243], a[36:39], v[32:35]
    v_mfma_f32_16x16x32_bf16 v[112:115], a[80:83], a[36:39], v[112:115]
    v_mfma_f32_16x16x32_bf16 v[112:115], v[224:227], a[32:35], v[112:115]
    v_cvt_pk_bf16_f32 v176, v16, v20
    v_cvt_pk_bf16_f32 v178, v96, v100
    v_mfma_f32_16x16x32_bf16 v[116:119], v[224:227], a[40:43], v[116:119]
    buffer_load_dwordx4 v[220:223], v13, s[12:15], s47 offen offset:1024 sc1
    v_mfma_f32_16x16x32_bf16 v[116:119], a[80:83], a[44:47], v[116:119]
    v_cvt_pk_bf16_f32 v179, v104, v108
    v_cvt_pk_bf16_f32 v177, v24, v28
    v_mfma_f32_16x16x32_bf16 v[36:39], v[240:243], a[44:47], v[36:39]
    s_add_u32 s39, s68, 0
    buffer_store_dwordx4 v[176:179], v7, s[16:19], s39 offen sc1
    v_mfma_f32_16x16x32_bf16 v[36:39], a[80:83], a[40:43], v[36:39]
    s_waitcnt vmcnt(21)
    v_xor_b32 v244, s80, v228
    v_xor_b32 v245, s80, v229
    v_mfma_f32_16x16x32_bf16 v[40:43], a[80:83], a[48:51], v[40:43]
    v_xor_b32 v246, s80, v230
    v_xor_b32 v247, s80, v231
    v_mfma_f32_16x16x32_bf16 v[40:43], v[240:243], a[52:55], v[40:43]
    v_mfma_f32_16x16x32_bf16 v[120:123], a[80:83], a[52:55], v[120:123]
    v_cvt_pk_bf16_f32 v180, v17, v21
    v_cvt_pk_bf16_f32 v182, v97, v101
    v_mfma_f32_16x16x32_bf16 v[120:123], v[224:227], a[48:51], v[120:123]
    v_cvt_pk_bf16_f32 v183, v105, v109
    v_cvt_pk_bf16_f32 v181, v25, v29
    v_mfma_f32_16x16x32_bf16 v[124:127], v[224:227], a[56:59], v[124:127]
    s_add_u32 s39, s68, 135424
    buffer_store_dwordx4 v[180:183], v7, s[16:19], s39 offen sc1
    v_mfma_f32_16x16x32_bf16 v[124:127], a[80:83], a[60:63], v[124:127]
    v_mfma_f32_16x16x32_bf16 v[44:47], v[240:243], a[60:63], v[44:47]
    v_mfma_f32_16x16x32_bf16 v[44:47], a[80:83], a[56:59], v[44:47]
    v_mfma_f32_16x16x32_bf16 v[32:35], a[84:87], a[96:99], v[32:35]
    buffer_load_dwordx4 a[80:83], v14, s[12:15], s47 offen offset:0 sc1
    v_mfma_f32_16x16x32_bf16 v[32:35], v[244:247], a[100:103], v[32:35]
    v_mfma_f32_16x16x32_bf16 v[112:115], a[84:87], a[100:103], v[112:115]
    v_mfma_f32_16x16x32_bf16 v[112:115], v[228:231], a[96:99], v[112:115]
    v_mfma_f32_16x16x32_bf16 v[116:119], v[228:231], a[104:107], v[116:119]
    buffer_load_dwordx4 v[224:227], v14, s[12:15], s47 offen offset:1024 sc1
    v_mfma_f32_16x16x32_bf16 v[116:119], a[84:87], a[108:111], v[116:119]
    v_cvt_pk_bf16_f32 v184, v18, v22
    v_cvt_pk_bf16_f32 v186, v98, v102
    v_mfma_f32_16x16x32_bf16 v[36:39], v[244:247], a[108:111], v[36:39]
    v_cvt_pk_bf16_f32 v187, v106, v110
    v_cvt_pk_bf16_f32 v185, v26, v30
    v_mfma_f32_16x16x32_bf16 v[36:39], a[84:87], a[104:107], v[36:39]
    s_waitcnt vmcnt(18)
    v_xor_b32 v240, s80, v232
    v_xor_b32 v241, s80, v233
    v_mfma_f32_16x16x32_bf16 v[40:43], a[84:87], a[112:115], v[40:43]
    s_add_u32 s39, s68, 270848
    buffer_store_dwordx4 v[184:187], v7, s[16:19], s39 offen sc1
    v_xor_b32 v242, s80, v234
    v_xor_b32 v243, s80, v235
    v_mfma_f32_16x16x32_bf16 v[40:43], v[244:247], a[116:119], v[40:43]
    v_mfma_f32_16x16x32_bf16 v[120:123], a[84:87], a[116:119], v[120:123]
    v_mfma_f32_16x16x32_bf16 v[120:123], v[228:231], a[112:115], v[120:123]
    v_mfma_f32_16x16x32_bf16 v[124:127], v[228:231], a[120:123], v[124:127]
    v_mfma_f32_16x16x32_bf16 v[124:127], a[84:87], a[124:127], v[124:127]
    v_mfma_f32_16x16x32_bf16 v[44:47], v[244:247], a[124:127], v[44:47]
    v_cvt_pk_bf16_f32 v188, v19, v23
    v_cvt_pk_bf16_f32 v190, v99, v103
    v_mfma_f32_16x16x32_bf16 v[44:47], a[84:87], a[120:123], v[44:47]
    v_cvt_pk_bf16_f32 v191, v107, v111
    v_cvt_pk_bf16_f32 v189, v27, v31
    v_mfma_f32_16x16x32_bf16 v[32:35], a[88:91], a[0:3], v[32:35]
    buffer_load_dwordx4 a[84:87], v2, s[12:15], s48 offen offset:0 sc1
    v_mfma_f32_16x16x32_bf16 v[32:35], v[240:243], a[4:7], v[32:35]
    s_add_u32 s39, s68, 406272
    buffer_store_dwordx4 v[188:191], v7, s[16:19], s39 offen sc1
    v_mfma_f32_16x16x32_bf16 v[112:115], a[88:91], a[4:7], v[112:115]
    v_mfma_f32_16x16x32_bf16 v[112:115], v[232:235], a[0:3], v[112:115]
    v_mfma_f32_16x16x32_bf16 v[116:119], v[232:235], a[8:11], v[116:119]
    buffer_load_dwordx4 v[228:231], v2, s[12:15], s48 offen offset:1024 sc1
    v_mfma_f32_16x16x32_bf16 v[116:119], a[88:91], a[12:15], v[116:119]
    v_mfma_f32_16x16x32_bf16 v[36:39], v[240:243], a[12:15], v[36:39]
    v_mfma_f32_16x16x32_bf16 v[36:39], a[88:91], a[8:11], v[36:39]
    s_waitcnt vmcnt(20)
    v_xor_b32 v244, s80, v236
    v_xor_b32 v245, s80, v237
    v_mfma_f32_16x16x32_bf16 v[40:43], a[88:91], a[16:19], v[40:43]
    v_xor_b32 v246, s80, v238
    v_xor_b32 v247, s80, v239
    v_mfma_f32_16x16x32_bf16 v[40:43], v[240:243], a[20:23], v[40:43]
    v_mfma_f32_16x16x32_bf16 v[120:123], a[88:91], a[20:23], v[120:123]
    v_mfma_f32_16x16x32_bf16 v[120:123], v[232:235], a[16:19], v[120:123]
    v_mfma_f32_16x16x32_bf16 v[124:127], v[232:235], a[24:27], v[124:127]
    v_mfma_f32_16x16x32_bf16 v[124:127], a[88:91], a[28:31], v[124:127]
    v_mfma_f32_16x16x32_bf16 v[44:47], v[240:243], a[28:31], v[44:47]
    v_mfma_f32_16x16x32_bf16 v[44:47], a[88:91], a[24:27], v[44:47]
    v_mfma_f32_16x16x32_bf16 v[48:51], a[92:95], a[32:35], v[48:51]
    buffer_load_dwordx4 a[88:91], v13, s[12:15], s48 offen offset:0 sc1
    v_mfma_f32_16x16x32_bf16 v[48:51], v[244:247], a[36:39], v[48:51]
    v_mfma_f32_16x16x32_bf16 v[128:131], a[92:95], a[36:39], v[128:131]
    v_mfma_f32_16x16x32_bf16 v[128:131], v[236:239], a[32:35], v[128:131]
    v_cvt_pk_bf16_f32 v192, v32, v36
    v_cvt_pk_bf16_f32 v194, v112, v116
    v_mfma_f32_16x16x32_bf16 v[132:135], v[236:239], a[40:43], v[132:135]
    buffer_load_dwordx4 v[232:235], v13, s[12:15], s48 offen offset:1024 sc1
    v_mfma_f32_16x16x32_bf16 v[132:135], a[92:95], a[44:47], v[132:135]
    v_cvt_pk_bf16_f32 v195, v120, v124
    v_cvt_pk_bf16_f32 v193, v40, v44
    v_mfma_f32_16x16x32_bf16 v[52:55], v[244:247], a[44:47], v[52:55]
    s_add_u32 s39, s69, 0
    buffer_store_dwordx4 v[192:195], v7, s[16:19], s39 offen sc1
    v_mfma_f32_16x16x32_bf16 v[52:55], a[92:95], a[40:43], v[52:55]
    s_waitcnt vmcnt(21)
    v_xor_b32 v240, s80, v208
    v_xor_b32 v241, s80, v209
    v_mfma_f32_16x16x32_bf16 v[56:59], a[92:95], a[48:51], v[56:59]
    v_xor_b32 v242, s80, v210
    v_xor_b32 v243, s80, v211
    v_mfma_f32_16x16x32_bf16 v[56:59], v[244:247], a[52:55], v[56:59]
    v_mfma_f32_16x16x32_bf16 v[136:139], a[92:95], a[52:55], v[136:139]
    v_cvt_pk_bf16_f32 v196, v33, v37
    v_cvt_pk_bf16_f32 v198, v113, v117
    v_mfma_f32_16x16x32_bf16 v[136:139], v[236:239], a[48:51], v[136:139]
    v_cvt_pk_bf16_f32 v199, v121, v125
    v_cvt_pk_bf16_f32 v197, v41, v45
    v_mfma_f32_16x16x32_bf16 v[140:143], v[236:239], a[56:59], v[140:143]
    s_add_u32 s39, s69, 135424
    buffer_store_dwordx4 v[196:199], v7, s[16:19], s39 offen sc1
    v_mfma_f32_16x16x32_bf16 v[140:143], a[92:95], a[60:63], v[140:143]
    v_mfma_f32_16x16x32_bf16 v[60:63], v[244:247], a[60:63], v[60:63]
    v_mfma_f32_16x16x32_bf16 v[60:63], a[92:95], a[56:59], v[60:63]
    v_mfma_f32_16x16x32_bf16 v[48:51], a[64:67], a[96:99], v[48:51]
    buffer_load_dwordx4 a[92:95], v14, s[12:15], s48 offen offset:0 sc1
    v_mfma_f32_16x16x32_bf16 v[48:51], v[240:243], a[100:103], v[48:51]
    v_mfma_f32_16x16x32_bf16 v[128:131], a[64:67], a[100:103], v[128:131]
    v_mfma_f32_16x16x32_bf16 v[128:131], v[208:211], a[96:99], v[128:131]
    v_mfma_f32_16x16x32_bf16 v[132:135], v[208:211], a[104:107], v[132:135]
    buffer_load_dwordx4 v[236:239], v14, s[12:15], s48 offen offset:1024 sc1
    v_mfma_f32_16x16x32_bf16 v[132:135], a[64:67], a[108:111], v[132:135]
    v_cvt_pk_bf16_f32 v200, v34, v38
    v_cvt_pk_bf16_f32 v202, v114, v118
    v_mfma_f32_16x16x32_bf16 v[52:55], v[240:243], a[108:111], v[52:55]
    v_cvt_pk_bf16_f32 v203, v122, v126
    v_cvt_pk_bf16_f32 v201, v42, v46
    v_mfma_f32_16x16x32_bf16 v[52:55], a[64:67], a[104:107], v[52:55]
    s_waitcnt vmcnt(19)
    v_xor_b32 v244, s80, v212
    v_xor_b32 v245, s80, v213
    v_mfma_f32_16x16x32_bf16 v[56:59], a[64:67], a[112:115], v[56:59]
    s_add_u32 s39, s69, 270848
    buffer_store_dwordx4 v[200:203], v7, s[16:19], s39 offen sc1
    v_xor_b32 v246, s80, v214
    v_xor_b32 v247, s80, v215
    v_mfma_f32_16x16x32_bf16 v[56:59], v[240:243], a[116:119], v[56:59]
    v_mfma_f32_16x16x32_bf16 v[136:139], a[64:67], a[116:119], v[136:139]
    v_mfma_f32_16x16x32_bf16 v[136:139], v[208:211], a[112:115], v[136:139]
    v_mfma_f32_16x16x32_bf16 v[140:143], v[208:211], a[120:123], v[140:143]
L_pad9:
    s_cbranch_execz L_back
    v_mfma_f32_16x16x32_bf16 v[140:143], a[64:67], a[124:127], v[140:143]
    v_mfma_f32_16x16x32_bf16 v[60:63], v[240:243], a[124:127], v[60:63]
    v_cvt_pk_bf16_f32 v204, v35, v39
    v_cvt_pk_bf16_f32 v206, v115, v119
    v_mfma_f32_16x16x32_bf16 v[60:63], a[64:67], a[120:123], v[60:63]
    v_cvt_pk_bf16_f32 v207, v123, v127
    v_cvt_pk_bf16_f32 v205, v43, v47
    v_mfma_f32_16x16x32_bf16 v[48:51], a[68:71], a[0:3], v[48:51]
    s_add_u32 s39, s69, 406272
    buffer_store_dwordx4 v[204:207], v7, s[16:19], s39 offen sc1
    v_mfma_f32_16x16x32_bf16 v[48:51], v[244:247], a[4:7], v[48:51]
    v_mfma_f32_16x16x32_bf16 v[128:131], a[68:71], a[4:7], v[128:131]
    v_mfma_f32_16x16x32_bf16 v[128:131], v[212:215], a[0:3], v[128:131]
    v_mfma_f32_16x16x32_bf16 v[132:135], v[212:215], a[8:11], v[132:135]
    v_mfma_f32_16x16x32_bf16 v[132:135], a[68:71], a[12:15], v[132:135]
    v_mfma_f32_16x16x32_bf16 v[52:55], v[244:247], a[12:15], v[52:55]
    v_mfma_f32_16x16x32_bf16 v[52:55], a[68:71], a[8:11], v[52:55]
    s_waitcnt vmcnt(18)
    v_xor_b32 v240, s80, v216
    v_xor_b32 v241, s80, v217
    v_mfma_f32_16x16x32_bf16 v[56:59], a[68:71], a[16:19], v[56:59]
    v_xor_b32 v242, s80, v218
    v_xor_b32 v243, s80, v219
    v_mfma_f32_16x16x32_bf16 v[56:59], v[244:247], a[20:23], v[56:59]
    v_mfma_f32_16x16x32_bf16 v[136:139], a[68:71], a[20:23], v[136:139]
    v_mfma_f32_16x16x32_bf16 v[136:139], v[212:215], a[16:19], v[136:139]
    v_mfma_f32_16x16x32_bf16 v[140:143], v[212:215], a[24:27], v[140:143]
    v_mfma_f32_16x16x32_bf16 v[140:143], a[68:71], a[28:31], v[140:143]
    v_mfma_f32_16x16x32_bf16 v[60:63], v[244:247], a[28:31], v[60:63]
    v_mfma_f32_16x16x32_bf16 v[60:63], a[68:71], a[24:27], v[60:63]
    v_mfma_f32_16x16x32_bf16 v[64:67], a[72:75], a[32:35], v[64:67]
    v_mfma_f32_16x16x32_bf16 v[64:67], v[240:243], a[36:39], v[64:67]
    v_mfma_f32_16x16x32_bf16 v[144:147], a[72:75], a[36:39], v[144:147]
    v_mfma_f32_16x16x32_bf16 v[144:147], v[216:219], a[32:35], v[144:147]
    v_cvt_pk_bf16_f32 v176, v48, v52
    v_cvt_pk_bf16_f32 v178, v128, v132
    v_mfma_f32_16x16x32_bf16 v[148:151], v[216:219], a[40:43], v[148:151]
    v_cvt_pk_bf16_f32 v179, v136, v140
    v_cvt_pk_bf16_f32 v177, v56, v60
    v_mfma_f32_16x16x32_bf16 v[148:151], a[72:75], a[44:47], v[148:151]
    s_add_u32 s39, s70, 0
    buffer_store_dwordx4 v[176:179], v7, s[16:19], s39 offen sc1
    v_mfma_f32_16x16x32_bf16 v[68:71], v[240:243], a[44:47], v[68:71]
    v_mfma_f32_16x16x32_bf16 v[68:71], a[72:75], a[40:43], v[68:71]
    s_waitcnt vmcnt(17)
    v_xor_b32 v244, s80, v220
    v_xor_b32 v245, s80, v221
    v_mfma_f32_16x16x32_bf16 v[72:75], a[72:75], a[48:51], v[72:75]
    v_xor_b32 v246, s80, v222
    v_xor_b32 v247, s80, v223
    v_mfma_f32_16x16x32_bf16 v[72:75], v[240:243], a[52:55], v[72:75]
    v_mfma_f32_16x16x32_bf16 v[152:155], a[72:75], a[52:55], v[152:155]
    v_cvt_pk_bf16_f32 v180, v49, v53
    v_cvt_pk_bf16_f32 v182, v129, v133
    v_mfma_f32_16x16x32_bf16 v[152:155], v[216:219], a[48:51], v[152:155]
    v_cvt_pk_bf16_f32 v183, v137, v141
    v_cvt_pk_bf16_f32 v181, v57, v61
    v_mfma_f32_16x16x32_bf16 v[156:159], v[216:219], a[56:59], v[156:159]
    s_add_u32 s39, s70, 135424
    buffer_store_dwordx4 v[180:183], v7, s[16:19], s39 offen sc1
    v_mfma_f32_16x16x32_bf16 v[156:159], a[72:75], a[60:63], v[156:159]
    v_mfma_f32_16x16x32_bf16 v[76:79], v[240:243], a[60:63], v[76:79]
    v_mfma_f32_16x16x32_bf16 v[76:79], a[72:75], a[56:59], v[76:79]
    v_mfma_f32_16x16x32_bf16 v[64:67], a[76:79], a[96:99], v[64:67]
    v_mfma_f32_16x16x32_bf16 v[64:67], v[244:247], a[100:103], v[64:67]
    v_mfma_f32_16x16x32_bf16 v[144:147], a[76:79], a[100:103], v[144:147]
    v_mfma_f32_16x16x32_bf16 v[144:147], v[220:223], a[96:99], v[144:147]
    v_mfma_f32_16x16x32_bf16 v[148:151], v[220:223], a[104:107], v[148:151]
    v_cvt_pk_bf16_f32 v184, v50, v54
    v_cvt_pk_bf16_f32 v186, v130, v134
    v_mfma_f32_16x16x32_bf16 v[148:151], a[76:79], a[108:111], v[148:151]
    v_cvt_pk_bf16_f32 v187, v138, v142
    v_cvt_pk_bf16_f32 v185, v58, v62
    v_mfma_f32_16x16x32_bf16 v[68:71], v[244:247], a[108:111], v[68:71]
    s_add_u32 s39, s70, 270848
    buffer_store_dwordx4 v[184:187], v7, s[16:19], s39 offen sc1
    v_mfma_f32_16x16x32_bf16 v[68:71], a[76:79], a[104:107], v[68:71]
    s_waitcnt vmcnt(15)
    v_xor_b32 v240, s80, v224
    v_xor_b32 v241, s80, v225
    v_mfma_f32_16x16x32_bf16 v[72:75], a[76:79], a[112:115], v[72:75]
    v_xor_b32 v242, s80, v226
    v_xor_b32 v243, s80, v227
    v_mfma_f32_16x16x32_bf16 v[72:75], v[244:247], a[116:119], v[72:75]
    v_mfma_f32_16x16x32_bf16 v[152:155], a[76:79], a[116:119], v[152:155]
    v_mfma_f32_16x16x32_bf16 v[152:155], v[220:223], a[112:115], v[152:155]
    v_mfma_f32_16x16x32_bf16 v[156:159], v[220:223], a[120:123], v[156:159]
    v_mfma_f32_16x16x32_bf16 v[156:159], a[76:79], a[124:127], v[156:159]
    v_mfma_f32_16x16x32_bf16 v[76:79], v[244:247], a[124:127], v[76:79]
    v_cvt_pk_bf16_f32 v188, v51, v55
    v_cvt_pk_bf16_f32 v190, v131, v135
    v_mfma_f32_16x16x32_bf16 v[76:79], a[76:79], a[120:123], v[76:79]
    v_cvt_pk_bf16_f32 v191, v139, v143
    v_cvt_pk_bf16_f32 v189, v59, v63
    v_mfma_f32_16x16x32_bf16 v[64:67], a[80:83], a[0:3], v[64:67]
    s_add_u32 s39, s70, 406272
    buffer_store_dwordx4 v[188:191], v7, s[16:19], s39 offen sc1
    v_mfma_f32_16x16x32_bf16 v[64:67], v[240:243], a[4:7], v[64:67]
    v_mfma_f32_16x16x32_bf16 v[144:147], a[80:83], a[4:7], v[144:147]
    v_mfma_f32_16x16x32_bf16 v[144:147], v[224:227], a[0:3], v[144:147]
    v_mfma_f32_16x16x32_bf16 v[148:151], v[224:227], a[8:11], v[148:151]
    v_mfma_f32_16x16x32_bf16 v[148:151], a[80:83], a[12:15], v[148:151]
    v_mfma_f32_16x16x32_bf16 v[68:71], v[240:243], a[12:15], v[68:71]
    v_mfma_f32_16x16x32_bf16 v[68:71], a[80:83], a[8:11], v[68:71]
    s_waitcnt vmcnt(12)
    v_xor_b32 v244, s80, v228
    v_xor_b32 v245, s80, v229
    v_mfma_f32_16x16x32_bf16 v[72:75], a[80:83], a[16:19], v[72:75]
    v_xor_b32 v246, s80, v230
    v_xor_b32 v247, s80, v231
    v_mfma_f32_16x16x32_bf16 v[72:75], v[240:243], a[20:23], v[72:75]
    v_mfma_f32_16x16x32_bf16 v[152:155], a[80:83], a[20:23], v[152:155]
    v_mfma_f32_16x16x32_bf16 v[152:155], v[224:227], a[16:19], v[152:155]
    v_mfma_f32_16x16x32_bf16 v[156:159], v[224:227], a[24:27], v[156:159]
    v_mfma_f32_16x16x32_bf16 v[156:159], a[80:83], a[28:31], v[156:159]
    v_mfma_f32_16x16x32_bf16 v[76:79], v[240:243], a[28:31], v[76:79]
    v_mfma_f32_16x16x32_bf16 v[76:79], a[80:83], a[24:27], v[76:79]
    v_mfma_f32_16x16x32_bf16 v[80:83], a[84:87], a[32:35], v[80:83]
    v_mfma_f32_16x16x32_bf16 v[80:83], v[244:247], a[36:39], v[80:83]
    v_mfma_f32_16x16x32_bf16 v[160:163], a[84:87], a[36:39], v[160:163]
    v_mfma_f32_16x16x32_bf16 v[160:163], v[228:231], a[32:35], v[160:163]
    v_cvt_pk_bf16_f32 v192, v64, v68
    v_cvt_pk_bf16_f32 v194, v144, v148
    v_mfma_f32_16x16x32_bf16 v[164:167], v[228:231], a[40:43], v[164:167]
    v_cvt_pk_bf16_f32 v195, v152, v156
    v_cvt_pk_bf16_f32 v193, v72, v76
    v_mfma_f32_16x16x32_bf16 v[164:167], a[84:87], a[44:47], v[164:167]
    s_add_u32 s39, s71, 0
    buffer_store_dwordx4 v[192:195], v7, s[16:19], s39 offen sc1
    v_mfma_f32_16x16x32_bf16 v[84:87], v[244:247], a[44:47], v[84:87]
    v_mfma_f32_16x16x32_bf16 v[84:87], a[84:87], a[40:43], v[84:87]
    s_waitcnt vmcnt(11)
    v_xor_b32 v240, s80, v232
    v_xor_b32 v241, s80, v233
    v_mfma_f32_16x16x32_bf16 v[88:91], a[84:87], a[48:51], v[88:91]
    v_xor_b32 v242, s80, v234
    v_xor_b32 v243, s80, v235
    v_mfma_f32_16x16x32_bf16 v[88:91], v[244:247], a[52:55], v[88:91]
    v_mfma_f32_16x16x32_bf16 v[168:171], a[84:87], a[52:55], v[168:171]
    v_cvt_pk_bf16_f32 v196, v65, v69
    v_cvt_pk_bf16_f32 v198, v145, v149
    v_mfma_f32_16x16x32_bf16 v[168:171], v[228:231], a[48:51], v[168:171]
    v_cvt_pk_bf16_f32 v199, v153, v157
    v_cvt_pk_bf16_f32 v197, v73, v77
    v_mfma_f32_16x16x32_bf16 v[172:175], v[228:231], a[56:59], v[172:175]
    s_add_u32 s39, s71, 135424
    buffer_store_dwordx4 v[196:199], v7, s[16:19], s39 offen sc1
    s_mov_b32 s49, 8192
    buffer_load_dwordx4 a[136:139], v248, s[4:7], s49 offen offset:0 sc1
    v_mfma_f32_16x16x32_bf16 v[172:175], a[84:87], a[60:63], v[172:175]
    v_mfma_f32_16x16x32_bf16 v[92:95], v[244:247], a[60:63], v[92:95]
    v_mfma_f32_16x16x32_bf16 v[92:95], a[84:87], a[56:59], v[92:95]
    v_mfma_f32_16x16x32_bf16 v[80:83], a[88:91], a[96:99], v[80:83]
    v_mfma_f32_16x16x32_bf16 v[80:83], v[240:243], a[100:103], v[80:83]
    v_mfma_f32_16x16x32_bf16 v[160:163], a[88:91], a[100:103], v[160:163]
    v_mfma_f32_16x16x32_bf16 v[160:163], v[232:235], a[96:99], v[160:163]
    v_mfma_f32_16x16x32_bf16 v[164:167], v[232:235], a[104:107], v[164:167]
    v_cvt_pk_bf16_f32 v200, v66, v70
    v_cvt_pk_bf16_f32 v202, v146, v150
    v_mfma_f32_16x16x32_bf16 v[164:167], a[88:91], a[108:111], v[164:167]
    v_cvt_pk_bf16_f32 v203, v154, v158
    v_cvt_pk_bf16_f32 v201, v74, v78
    v_mfma_f32_16x16x32_bf16 v[84:87], v[240:243], a[108:111], v[84:87]
    s_add_u32 s39, s71, 270848
    buffer_store_dwordx4 v[200:203], v7, s[16:19], s39 offen sc1
    buffer_load_dwordx4 a[140:143], v248, s[4:7], s49 offen offset:1024 sc1
    v_mfma_f32_16x16x32_bf16 v[84:87], a[88:91], a[104:107], v[84:87]
    s_waitcnt vmcnt(11)
    v_xor_b32 v244, s80, v236
    v_xor_b32 v245, s80, v237
    v_mfma_f32_16x16x32_bf16 v[88:91], a[88:91], a[112:115], v[88:91]
    v_xor_b32 v246, s80, v238
    v_xor_b32 v247, s80, v239
    v_mfma_f32_16x16x32_bf16 v[88:91], v[240:243], a[116:119], v[88:91]
    v_mfma_f32_16x16x32_bf16 v[168:171], a[88:91], a[116:119], v[168:171]
    v_mfma_f32_16x16x32_bf16 v[168:171], v[232:235], a[112:115], v[168:171]
    v_mfma_f32_16x16x32_bf16 v[172:175], v[232:235], a[120:123], v[172:175]
    v_mfma_f32_16x16x32_bf16 v[172:175], a[88:91], a[124:127], v[172:175]
    v_mfma_f32_16x16x32_bf16 v[92:95], v[240:243], a[124:127], v[92:95]
    v_cvt_pk_bf16_f32 v204, v67, v71
    v_cvt_pk_bf16_f32 v206, v147, v151
    v_mfma_f32_16x16x32_bf16 v[92:95], a[88:91], a[120:123], v[92:95]
    v_cvt_pk_bf16_f32 v207, v155, v159
    v_cvt_pk_bf16_f32 v205, v75, v79
    v_mfma_f32_16x16x32_bf16 v[80:83], a[92:95], a[0:3], v[80:83]
    s_add_u32 s39, s71, 406272
    buffer_store_dwordx4 v[204:207], v7, s[16:19], s39 offen sc1
    buffer_load_dwordx4 a[144:147], v248, s[4:7], s49 offen offset:2048 sc1
    v_mfma_f32_16x16x32_bf16 v[80:83], v[244:247], a[4:7], v[80:83]
    v_mfma_f32_16x16x32_bf16 v[160:163], a[92:95], a[4:7], v[160:163]
    v_mfma_f32_16x16x32_bf16 v[160:163], v[236:239], a[0:3], v[160:163]
    v_mfma_f32_16x16x32_bf16 v[164:167], v[236:239], a[8:11], v[164:167]
    v_mfma_f32_16x16x32_bf16 v[164:167], a[92:95], a[12:15], v[164:167]
    v_mfma_f32_16x16x32_bf16 v[84:87], v[244:247], a[12:15], v[84:87]
    v_mfma_f32_16x16x32_bf16 v[84:87], a[92:95], a[8:11], v[84:87]
    v_mfma_f32_16x16x32_bf16 v[88:91], a[92:95], a[16:19], v[88:91]
    v_mfma_f32_16x16x32_bf16 v[88:91], v[244:247], a[20:23], v[88:91]
    v_mfma_f32_16x16x32_bf16 v[168:171], a[92:95], a[20:23], v[168:171]
    v_mfma_f32_16x16x32_bf16 v[168:171], v[236:239], a[16:19], v[168:171]
    v_mfma_f32_16x16x32_bf16 v[172:175], v[236:239], a[24:27], v[172:175]
    v_mfma_f32_16x16x32_bf16 v[172:175], a[92:95], a[28:31], v[172:175]
    v_mfma_f32_16x16x32_bf16 v[92:95], v[244:247], a[28:31], v[92:95]
    v_mfma_f32_16x16x32_bf16 v[92:95], a[92:95], a[24:27], v[92:95]
    s_nop 4
    v_cvt_pk_bf16_f32 v176, v80, v84
    v_cvt_pk_bf16_f32 v178, v160, v164
    v_cvt_pk_bf16_f32 v179, v168, v172
    v_cvt_pk_bf16_f32 v177, v88, v92
    s_add_u32 s39, s72, 0
    buffer_store_dwordx4 v[176:179], v7, s[16:19], s39 offen sc1
    buffer_load_dwordx4 a[148:151], v248, s[4:7], s49 offen offset:3072 sc1
    v_cvt_pk_bf16_f32 v180, v81, v85
    v_cvt_pk_bf16_f32 v182, v161, v165
    v_cvt_pk_bf16_f32 v183, v169, v173
    v_cvt_pk_bf16_f32 v181, v89, v93
    s_add_u32 s39, s72, 135424
    buffer_store_dwordx4 v[180:183], v7, s[16:19], s39 offen sc1
    s_mov_b32 s49, 12288
    buffer_load_dwordx4 a[152:155], v248, s[4:7], s49 offen offset:0 sc1
    v_cvt_pk_bf16_f32 v184, v82, v86
    v_cvt_pk_bf16_f32 v186, v162, v166
    v_cvt_pk_bf16_f32 v187, v170, v174
    v_cvt_pk_bf16_f32 v185, v90, v94
    s_add_u32 s39, s72, 270848
    buffer_store_dwordx4 v[184:187], v7, s[16:19], s39 offen sc1
    buffer_load_dwordx4 a[156:159], v248, s[4:7], s49 offen offset:1024 sc1
    v_cvt_pk_bf16_f32 v188, v83, v87
    v_cvt_pk_bf16_f32 v190, v163, v167
    v_cvt_pk_bf16_f32 v191, v171, v175
    v_cvt_pk_bf16_f32 v189, v91, v95
    s_add_u32 s39, s72, 406272
    buffer_store_dwordx4 v[188:191], v7, s[16:19], s39 offen sc1
    s_waitcnt vmcnt(14)
    s_barrier
    s_cmp_lg_u32 s36, 0
    s_cbranch_scc1 L_se7
    s_mov_b32 s38, 65536
    s_mov_b64 exec, 0xff
    buffer_atomic_add v11, v8, s[40:43], s38 offen sc1
    s_mov_b64 exec, -1
L_se7:
    buffer_load_dwordx4 a[160:163], v248, s[4:7], s49 offen offset:2048 sc1
    buffer_load_dwordx4 a[164:167], v248, s[4:7], s49 offen offset:3072 sc1
    s_mov_b32 s49, 16384
    buffer_load_dwordx4 a[168:171], v248, s[4:7], s49 offen offset:0 sc1
    buffer_load_dwordx4 a[172:175], v248, s[4:7], s49 offen offset:1024 sc1
    buffer_load_dwordx4 a[176:179], v248, s[4:7], s49 offen offset:2048 sc1
    buffer_load_dwordx4 a[180:183], v248, s[4:7], s49 offen offset:3072 sc1
    s_mov_b32 s49, 20480
    buffer_load_dwordx4 a[96:99], v248, s[4:7], s49 offen offset:0 sc1
    buffer_load_dwordx4 a[100:103], v248, s[4:7], s49 offen offset:1024 sc1
    s_waitcnt vmcnt(8)
    s_barrier
    s_mov_b32 s95, 16384
    s_mov_b32 s100, 31
    s_mov_b32 s38, 49408
    v_mov_b32 v10, 1
    s_mov_b64 exec, 1
    buffer_atomic_add v10, v9, s[40:43], s38 offen sc0 sc1
    s_mov_b64 exec, -1
    buffer_load_dwordx4 a[104:107], v248, s[4:7], s49 offen offset:2048 sc1
    buffer_load_dwordx4 a[108:111], v248, s[4:7], s49 offen offset:3072 sc1
    s_mov_b32 s49, 24576
    buffer_load_dwordx4 a[112:115], v248, s[4:7], s49 offen offset:0 sc1
    buffer_load_dwordx4 a[116:119], v248, s[4:7], s49 offen offset:1024 sc1
    s_waitcnt vmcnt(4)
    v_readfirstlane_b32 s39, v10
    s_cmp_lg_u32 s36, 0
    s_cbranch_scc1 L_pb9
    s_cmp_lg_u32 s39, s100
    s_cbranch_scc1 L_pb9
    s_mov_b64 exec, 0xff
    buffer_store_dword v11, v8, s[40:43], s95 offen sc1
    s_mov_b64 exec, -1
L_pb9:
    s_barrier
    buffer_load_dwordx4 a[120:123], v248, s[4:7], s49 offen offset:2048 sc1
    buffer_load_dwordx4 a[124:127], v248, s[4:7], s49 offen offset:3072 sc1
    s_mov_b32 s49, 28672
    buffer_load_dwordx4 a[0:3], v248, s[4:7], s49 offen offset:0 sc1
    buffer_load_dwordx4 a[4:7], v248, s[4:7], s49 offen offset:1024 sc1
    buffer_load_dwordx4 a[8:11], v248, s[4:7], s49 offen offset:2048 sc1
    buffer_load_dwordx4 a[12:15], v248, s[4:7], s49 offen offset:3072 sc1
    s_mov_b32 s49, 32768
    buffer_load_dwordx4 a[16:19], v248, s[4:7], s49 offen offset:0 sc1
    buffer_load_dwordx4 a[20:23], v248, s[4:7], s49 offen offset:1024 sc1
    buffer_load_dwordx4 a[24:27], v248, s[4:7], s49 offen offset:2048 sc1
    buffer_load_dwordx4 a[28:31], v248, s[4:7], s49 offen offset:3072 sc1
    s_mov_b32 s49, 36864
    buffer_load_dwordx4 a[32:35], v248, s[4:7], s49 offen offset:0 sc1
    buffer_load_dwordx4 a[36:39], v248, s[4:7], s49 offen offset:1024 sc1
    buffer_load_dwordx4 a[40:43], v248, s[4:7], s49 offen offset:2048 sc1
    buffer_load_dwordx4 a[44:47], v248, s[4:7], s49 offen offset:3072 sc1
    s_mov_b32 s49, 40960
    buffer_load_dwordx4 a[48:51], v248, s[4:7], s49 offen offset:0 sc1
    buffer_load_dwordx4 a[52:55], v248, s[4:7], s49 offen offset:1024 sc1
    buffer_load_dwordx4 a[56:59], v248, s[4:7], s49 offen offset:2048 sc1
    buffer_load_dwordx4 a[60:63], v248, s[4:7], s49 offen offset:3072 sc1
    s_mov_b32 s49, 45056
    buffer_load_dwordx4 v[16:19], v248, s[4:7], s49 offen offset:0 sc1
    buffer_load_dwordx4 v[20:23], v248, s[4:7], s49 offen offset:1024 sc1
    buffer_load_dwordx4 v[24:27], v248, s[4:7], s49 offen offset:2048 sc1
    buffer_load_dwordx4 v[28:31], v248, s[4:7], s49 offen offset:3072 sc1
    s_mov_b32 s49, 49152
    buffer_load_dwordx4 v[96:99], v248, s[4:7], s49 offen offset:0 sc1
    buffer_load_dwordx4 v[100:103], v248, s[4:7], s49 offen offset:1024 sc1
    buffer_load_dwordx4 v[104:107], v248, s[4:7], s49 offen offset:2048 sc1
    buffer_load_dwordx4 v[108:111], v248, s[4:7], s49 offen offset:3072 sc1
    s_cmp_lt_u32 s57, 24
    s_cselect_b32 s95, 4, 1
    s_cselect_b32 s100, 32, 1
    s_lshl_b32 s95, s95, 14
    buffer_load_dword v10, v9, s[40:43], s95 offen sc1
    s_mov_b32 s49, 53248
    buffer_load_dwordx4 v[32:35], v248, s[4:7], s49 offen offset:0 sc1
    buffer_load_dwordx4 v[36:39], v248, s[4:7], s49 offen offset:1024 sc1
    buffer_load_dwordx4 v[40:43], v248, s[4:7], s49 offen offset:2048 sc1
    buffer_load_dwordx4 v[44:47], v248, s[4:7], s49 offen offset:3072 sc1
    s_mov_b32 s49, 57344
    buffer_load_dwordx4 v[112:115], v248, s[4:7], s49 offen offset:0 sc1
    buffer_load_dwordx4 v[116:119], v248, s[4:7], s49 offen offset:1024 sc1
    buffer_load_dwordx4 v[120:123], v248, s[4:7], s49 offen offset:2048 sc1
    buffer_load_dwordx4 v[124:127], v248, s[4:7], s49 offen offset:3072 sc1
    s_waitcnt vmcnt(8)
    s_cmp_lg_u32 s36, 0
    s_cbranch_scc1 L_pd10
    s_mov_b32 s39, 0
L_pl10:
    v_cmp_ne_u32 vcc, s100, v10
    s_add_u32 s39, s39, 1
    s_nop 0
    s_and_b32 s38, vcc_lo, 255
    s_cbranch_scc0 L_pd10
    s_cmp_ge_u32 s39, 200000
    s_cbranch_scc1 L_pd10
    buffer_load_dword v10, v9, s[40:43], s95 offen sc1
    s_waitcnt vmcnt(0)
    s_branch L_pl10
L_pd10:
    s_barrier
    s_add_u32 m0, s56, 32768
    s_nop 0
    buffer_load_dwordx4 v249, s[16:19], s60 offen offset:0 sc1 lds
    s_add_u32 m0, s56, 36864
    s_nop 0
    buffer_load_dwordx4 v249, s[16:19], s61 offen offset:0 sc1 lds
    s_add_u32 m0, s56, 40960
    s_nop 0
    buffer_load_dwordx4 v249, s[16:19], s62 offen offset:0 sc1 lds
    s_add_u32 m0, s56, 45056
    s_nop 0
    buffer_load_dwordx4 v249, s[16:19], s63 offen offset:0 sc1 lds
    s_add_u32 m0, s56, 49152
    s_nop 0
    buffer_load_dwordx4 v249, s[16:19], s64 offen offset:0 sc1 lds
    s_add_u32 m0, s56, 53248
    s_nop 0
    buffer_load_dwordx4 v249, s[16:19], s65 offen offset:0 sc1 lds
    s_add_u32 m0, s56, 57344
    s_nop 0
    buffer_load_dwordx4 v249, s[16:19], s66 offen offset:0 sc1 lds
    s_add_u32 m0, s56, 61440
    s_nop 0
    buffer_load_dwordx4 v249, s[16:19], s67 offen offset:0 sc1 lds
    s_add_u32 m0, s56, 65280
    s_nop 0
    buffer_load_dwordx4 v249, s[16:19], s60 offen offset:256 sc1 lds
    s_add_u32 m0, s56, 69376
    s_nop 0
    buffer_load_dwordx4 v249, s[16:19], s61 offen offset:256 sc1 lds
    s_add_u32 m0, s56, 73472
    s_nop 0
    buffer_load_dwordx4 v249, s[16:19], s62 offen offset:256 sc1 lds
    s_add_u32 m0, s56, 77568
    s_nop 0
    buffer_load_dwordx4 v249, s[16:19], s63 offen offset:256 sc1 lds
    s_add_u32 m0, s56, 81664
    s_nop 0
    buffer_load_dwordx4 v249, s[16:19], s64 offen offset:256 sc1 lds
    s_add_u32 m0, s56, 85760
    s_nop 0
    buffer_load_dwordx4 v249, s[16:19], s65 offen offset:256 sc1 lds
    s_add_u32 m0, s56, 89856
    s_nop 0
    buffer_load_dwordx4 v249, s[16:19], s66 offen offset:256 sc1 lds
    s_add_u32 m0, s56, 93952
    s_nop 0
    buffer_load_dwordx4 v249, s[16:19], s67 offen offset:256 sc1 lds
    v_add_u32 v1, 0x10000, v253
    v_lshl_add_u32 v250, v0, 4, s56
    s_waitcnt vmcnt(8)
    s_barrier
    ds_read_b64_tr_b16 a[64:65], v253 offset:0
    ds_read_b64_tr_b16 a[66:67], v253 offset:1024
    ds_read_b64_tr_b16 a[68:69], v253 offset:4096
    ds_read_b64_tr_b16 a[70:71], v253 offset:5120
    ds_read_b64_tr_b16 a[72:73], v253 offset:8192
    ds_read_b64_tr_b16 a[74:75], v253 offset:9216
    ds_read_b64_tr_b16 a[76:77], v253 offset:12288
    ds_read_b64_tr_b16 a[78:79], v253 offset:13312
    s_waitcnt lgkmcnt(6)
    s_add_u32 m0, s56, 97792
    v_mfma_f32_32x32x16_bf16 v[160:175], a[64:67], a[216:219], 0
    buffer_load_dwordx4 v249, s[16:19], s60 offen offset:512 sc1 lds
    ds_read_b64_tr_b16 a[80:81], v253 offset:16384
    ds_read_b64_tr_b16 a[82:83], v253 offset:17408
    s_waitcnt lgkmcnt(6)
    s_add_u32 m0, s56, 101888
    v_mfma_f32_32x32x16_bf16 v[160:175], a[68:71], a[220:223], v[160:175]
    buffer_load_dwordx4 v249, s[16:19], s61 offen offset:512 sc1 lds
    ds_read_b64_tr_b16 a[84:85], v253 offset:20480
    ds_read_b64_tr_b16 a[86:87], v253 offset:21504
    s_waitcnt lgkmcnt(6)
    s_add_u32 m0, s56, 105984
    v_mfma_f32_32x32x16_bf16 v[160:175], a[72:75], a[224:227], v[160:175]
    buffer_load_dwordx4 v249, s[16:19], s62 offen offset:512 sc1 lds
    ds_read_b64_tr_b16 a[88:89], v253 offset:24576
    ds_read_b64_tr_b16 a[90:91], v253 offset:25600
    s_waitcnt lgkmcnt(6)
    s_add_u32 m0, s56, 110080
    v_mfma_f32_32x32x16_bf16 v[160:175], a[76:79], a[228:231], v[160:175]
    buffer_load_dwordx4 v249, s[16:19], s63 offen offset:512 sc1 lds
    ds_read_b64_tr_b16 a[92:93], v253 offset:28672
    ds_read_b64_tr_b16 a[94:95], v253 offset:29696
    s_waitcnt lgkmcnt(6)
    s_add_u32 m0, s56, 114176
    v_mfma_f32_32x32x16_bf16 v[160:175], a[80:83], a[232:235], v[160:175]
    buffer_load_dwordx4 v249, s[16:19], s64 offen offset:512 sc1 lds
    s_waitcnt lgkmcnt(4)
    s_add_u32 m0, s56, 118272
    v_mfma_f32_32x32x16_bf16 v[160:175], a[84:87], a[236:239], v[160:175]
    buffer_load_dwordx4 v249, s[16:19], s65 offen offset:512 sc1 lds
    s_waitcnt lgkmcnt(2)
    s_add_u32 m0, s56, 122368
    v_mfma_f32_32x32x16_bf16 v[160:175], a[88:91], a[240:243], v[160:175]
    buffer_load_dwordx4 v249, s[16:19], s66 offen offset:512 sc1 lds
    s_waitcnt lgkmcnt(0)
    s_add_u32 m0, s56, 126464
    v_mfma_f32_32x32x16_bf16 v[160:175], a[92:95], a[244:247], v[160:175]
    buffer_load_dwordx4 v249, s[16:19], s67 offen offset:512 sc1 lds
    s_waitcnt vmcnt(8)
    s_barrier
    ds_read_b64_tr_b16 a[64:65], v253 offset:32768
    ds_read_b64_tr_b16 a[66:67], v253 offset:33792
    ds_read_b64_tr_b16 a[68:69], v253 offset:36864
    ds_read_b64_tr_b16 a[70:71], v253 offset:37888
    ds_read_b64_tr_b16 a[72:73], v253 offset:40960
    ds_read_b64_tr_b16 a[74:75], v253 offset:41984
    ds_read_b64_tr_b16 a[76:77], v253 offset:45056
    ds_read_b64_tr_b16 a[78:79], v253 offset:46080
    s_nop 0
    v_min_f32 v160, s35, v160
    v_min_f32 v161, s35, v161
    v_min_f32 v162, s35, v162
    v_min_f32 v163, s35, v163
    v_exp_f32 v160, v160
    v_exp_f32 v168, v168
    v_exp_f32 v161, v161
    v_exp_f32 v169, v169
    v_exp_f32 v162, v162
    v_exp_f32 v170, v170
    v_exp_f32 v163, v163
    v_exp_f32 v171, v171
    v_add_f32 v240, 1.0, v160
    v_add_f32 v241, 1.0, v161
    v_add_f32 v242, 1.0, v162
    v_add_f32 v243, 1.0, v163
    s_waitcnt lgkmcnt(6)
    v_mfma_f32_32x32x16_bf16 v[80:95], a[64:67], a[216:219], 0
    s_waitcnt lgkmcnt(4)
    s_add_u32 m0, s56, 130304
    ds_read_b64_tr_b16 a[80:81], v253 offset:49152
    buffer_load_dwordx4 v249, s[16:19], s60 offen offset:768 sc1 lds
    ds_read_b64_tr_b16 a[82:83], v253 offset:50176
    v_fma_f32 v168, v240, v168, v240
    v_fma_f32 v169, v241, v169, v241
    v_fma_f32 v170, v242, v170, v242
    v_fma_f32 v171, v243, v171, v243
    v_min_f32 v164, s35, v164
    v_rcp_f32 v168, v168
    v_rcp_f32 v169, v169
    v_rcp_f32 v170, v170
    v_rcp_f32 v171, v171
    v_fma_f32 v160, -v160, v168, v168
    v_fma_f32 v161, -v161, v169, v169
    v_fma_f32 v162, -v162, v170, v170
    v_fma_f32 v163, -v163, v171, v171
    v_cvt_pk_bf16_f32 v12, v160, v161
    v_cvt_pk_bf16_f32 v13, v162, v163
    v_min_f32 v165, s35, v165
    v_min_f32 v166, s35, v166
    v_mfma_f32_32x32x16_bf16 v[80:95], a[68:71], a[220:223], v[80:95]
    s_waitcnt lgkmcnt(4)
    s_add_u32 m0, s56, 134400
    ds_read_b64_tr_b16 a[84:85], v253 offset:53248
    buffer_load_dwordx4 v249, s[16:19], s61 offen offset:768 sc1 lds
    ds_read_b64_tr_b16 a[86:87], v253 offset:54272
    v_min_f32 v167, s35, v167
    v_exp_f32 v164, v164
    v_exp_f32 v172, v172
    v_add_f32 v244, 1.0, v164
    v_exp_f32 v165, v165
    v_exp_f32 v173, v173
    v_exp_f32 v166, v166
    v_exp_f32 v174, v174
    v_exp_f32 v167, v167
    v_exp_f32 v175, v175
    v_add_f32 v245, 1.0, v165
    v_add_f32 v246, 1.0, v166
    v_mfma_f32_32x32x16_bf16 v[80:95], a[72:75], a[224:227], v[80:95]
    s_waitcnt lgkmcnt(4)
    s_add_u32 m0, s56, 138496
    ds_read_b64_tr_b16 a[88:89], v253 offset:57344
    buffer_load_dwordx4 v249, s[16:19], s62 offen offset:768 sc1 lds
    ds_read_b64_tr_b16 a[90:91], v253 offset:58368
    v_add_f32 v247, 1.0, v167
    v_fma_f32 v172, v244, v172, v244
    v_fma_f32 v173, v245, v173, v245
    v_fma_f32 v174, v246, v174, v246
    v_fma_f32 v175, v247, v175, v247
    v_rcp_f32 v172, v172
    v_rcp_f32 v173, v173
    v_rcp_f32 v174, v174
    v_rcp_f32 v175, v175
    v_fma_f32 v164, -v164, v172, v172
    v_fma_f32 v165, -v165, v173, v173
    v_fma_f32 v166, -v166, v174, v174
    v_fma_f32 v167, -v167, v175, v175
    v_cvt_pk_bf16_f32 v14, v164, v165
    v_cvt_pk_bf16_f32 v15, v166, v167
    v_mfma_f32_32x32x16_bf16 v[80:95], a[76:79], a[228:231], v[80:95]
    s_waitcnt lgkmcnt(4)
    s_add_u32 m0, s56, 142592
    ds_read_b64_tr_b16 a[92:93], v253 offset:61440
    buffer_load_dwordx4 v249, s[16:19], s63 offen offset:768 sc1 lds
    ds_read_b64_tr_b16 a[94:95], v253 offset:62464
    v_mfma_f32_32x32x16_bf16 v[80:95], a[80:83], a[232:235], v[80:95]
    s_waitcnt lgkmcnt(4)
    s_add_u32 m0, s56, 146688
    s_nop 0
    buffer_load_dwordx4 v249, s[16:19], s64 offen offset:768 sc1 lds
    v_mfma_f32_32x32x16_bf16 v[80:95], a[84:87], a[236:239], v[80:95]
    s_waitcnt lgkmcnt(0)
    s_add_u32 m0, s56, 150784
    s_nop 0
    buffer_load_dwordx4 v249, s[16:19], s65 offen offset:768 sc1 lds
    v_mfma_f32_32x32x16_bf16 v[80:95], a[88:91], a[240:243], v[80:95]
    s_add_u32 m0, s56, 154880
    s_nop 0
    buffer_load_dwordx4 v249, s[16:19], s66 offen offset:768 sc1 lds
    v_mfma_f32_32x32x16_bf16 v[80:95], a[92:95], a[244:247], v[80:95]
    s_add_u32 m0, s56, 158976
    s_nop 0
    buffer_load_dwordx4 v249, s[16:19], s67 offen offset:768 sc1 lds
    ds_write_b128 v250, v[12:15] offset:0
    s_mov_b32 s49, 61440
    buffer_load_dwordx4 v[48:51], v248, s[4:7], s49 offen offset:0 sc1
    buffer_load_dwordx4 v[52:55], v248, s[4:7], s49 offen offset:1024 sc1
    buffer_load_dwordx4 v[56:59], v248, s[4:7], s49 offen offset:2048 sc1
    buffer_load_dwordx4 v[60:63], v248, s[4:7], s49 offen offset:3072 sc1
    s_waitcnt vmcnt(12) lgkmcnt(0)
    s_barrier
    ds_read_b64_tr_b16 a[64:65], v1 offset:0
    ds_read_b64_tr_b16 a[66:67], v1 offset:1024
    ds_read_b64_tr_b16 a[68:69], v1 offset:4096
    ds_read_b64_tr_b16 a[70:71], v1 offset:5120
    ds_read_b64_tr_b16 a[72:73], v1 offset:8192
    ds_read_b64_tr_b16 a[74:75], v1 offset:9216
    ds_read_b64_tr_b16 a[76:77], v1 offset:12288
    ds_read_b64_tr_b16 a[78:79], v1 offset:13312
    v_min_f32 v80, s35, v80
    v_min_f32 v81, s35, v81
    v_min_f32 v82, s35, v82
    v_min_f32 v83, s35, v83
    v_exp_f32 v80, v80
    v_exp_f32 v88, v88
    v_exp_f32 v81, v81
    v_exp_f32 v89, v89
    v_exp_f32 v82, v82
    v_exp_f32 v90, v90
    v_exp_f32 v83, v83
    v_exp_f32 v91, v91
    v_add_f32 v240, 1.0, v80
    v_add_f32 v241, 1.0, v81
    v_add_f32 v242, 1.0, v82
    v_add_f32 v243, 1.0, v83
    s_waitcnt lgkmcnt(6)
    v_mfma_f32_32x32x16_bf16 v[160:175], a[64:67], a[216:219], 0
    s_waitcnt lgkmcnt(4)
    s_add_u32 m0, s56, 31744
    ds_read_b64_tr_b16 a[80:81], v1 offset:16384
    buffer_load_dwordx4 v249, s[16:19], s60 offen offset:1024 sc1 lds
    ds_read_b64_tr_b16 a[82:83], v1 offset:17408
    v_fma_f32 v88, v240, v88, v240
    v_fma_f32 v89, v241, v89, v241
    v_fma_f32 v90, v242, v90, v242
    v_mfma_f32_32x32x16_bf16 v[160:175], a[68:71], a[220:223], v[160:175]
    s_waitcnt lgkmcnt(4)
    s_add_u32 m0, s56, 35840
    ds_read_b64_tr_b16 a[84:85], v1 offset:20480
    ds_read_b64_tr_b16 a[86:87], v1 offset:21504
    ds_read_b128 a[128:131], v251 offset:0
    v_fma_f32 v91, v243, v91, v243
    v_rcp_f32 v88, v88
    v_mfma_f32_32x32x16_bf16 v[160:175], a[72:75], a[224:227], v[160:175]
    s_waitcnt lgkmcnt(5)
    buffer_load_dwordx4 v249, s[16:19], s61 offen offset:1024 sc1 lds
L_pad10:
    s_cbranch_execz L_back
    ds_read_b64_tr_b16 a[88:89], v1 offset:24576
    ds_read_b64_tr_b16 a[90:91], v1 offset:25600
    ds_read_b128 a[248:251], v251 offset:2048
    v_rcp_f32 v89, v89
    v_mfma_f32_32x32x16_bf16 v[160:175], a[76:79], a[228:231], v[160:175]
    s_waitcnt lgkmcnt(6)
    s_add_u32 m0, s56, 39936
    ds_read_b64_tr_b16 a[92:93], v1 offset:28672
    buffer_load_dwordx4 v249, s[16:19], s62 offen offset:1024 sc1 lds
    ds_read_b64_tr_b16 a[94:95], v1 offset:29696
    ds_read_b128 a[252:255], v251 offset:2304
    v_rcp_f32 v90, v90
    v_mfma_f32_32x32x16_bf16 v[160:175], a[80:83], a[232:235], v[160:175]
    s_waitcnt lgkmcnt(7)
    s_add_u32 m0, s56, 44032
    s_nop 0
    buffer_load_dwordx4 v249, s[16:19], s63 offen offset:1024 sc1 lds
    ds_read_b128 a[132:135], v251 offset:256
    v_rcp_f32 v91, v91
    v_fma_f32 v80, -v80, v88, v88
    v_fma_f32 v81, -v81, v89, v89
    v_mfma_f32_32x32x16_bf16 v[160:175], a[84:87], a[236:239], v[160:175]
    s_waitcnt lgkmcnt(2)
    s_add_u32 m0, s56, 48128
    v_fma_f32 v82, -v82, v90, v90
    v_fma_f32 v83, -v83, v91, v91
    v_cvt_pk_bf16_f32 v12, v80, v81
    v_cvt_pk_bf16_f32 v13, v82, v83
    v_min_f32 v84, s35, v84
    v_min_f32 v85, s35, v85
    v_mfma_f32_32x32x16_bf16 v[160:175], a[88:91], a[240:243], v[160:175]
    buffer_load_dwordx4 v249, s[16:19], s64 offen offset:1024 sc1 lds
    v_min_f32 v86, s35, v86
    v_min_f32 v87, s35, v87
    v_exp_f32 v84, v84
    v_mfma_f32_32x32x16_bf16 v[160:175], a[92:95], a[244:247], v[160:175]
    s_waitcnt lgkmcnt(0)
    s_add_u32 m0, s56, 52224
    s_nop 0
    buffer_load_dwordx4 v249, s[16:19], s65 offen offset:1024 sc1 lds
    v_add_f32 v244, 1.0, v84
    v_exp_f32 v92, v92
    v_exp_f32 v85, v85
    v_mfma_f32_16x16x32_bf16 v[176:179], a[128:131], a[184:187], 0
    s_add_u32 m0, s56, 56320
    v_exp_f32 v93, v93
    v_mfma_f32_16x16x32_bf16 v[176:179], a[248:251], a[188:191], v[176:179]
    buffer_load_dwordx4 v249, s[16:19], s66 offen offset:1024 sc1 lds
    v_add_f32 v245, 1.0, v85
    v_mfma_f32_16x16x32_bf16 v[208:211], a[252:255], a[188:191], 0
    s_add_u32 m0, s56, 60416
    v_exp_f32 v86, v86
    v_mfma_f32_16x16x32_bf16 v[208:211], a[132:135], a[184:187], v[208:211]
    v_exp_f32 v94, v94
    v_mfma_f32_16x16x32_bf16 v[212:215], a[132:135], a[192:195], 0
    buffer_load_dwordx4 v249, s[16:19], s67 offen offset:1024 sc1 lds
    v_add_f32 v246, 1.0, v86
    v_mfma_f32_16x16x32_bf16 v[212:215], a[252:255], a[196:199], v[212:215]
    v_exp_f32 v87, v87
    v_mfma_f32_16x16x32_bf16 v[180:183], a[248:251], a[196:199], 0
    s_mov_b32 s49, 65536
    buffer_load_dwordx4 v[128:131], v248, s[4:7], s49 offen offset:0 sc1
    v_add_f32 v247, 1.0, v87
    v_mfma_f32_16x16x32_bf16 v[180:183], a[128:131], a[192:195], v[180:183]
    v_exp_f32 v95, v95
    v_mfma_f32_16x16x32_bf16 v[184:187], a[128:131], a[200:203], 0
    v_fma_f32 v92, v244, v92, v244
    v_fma_f32 v93, v245, v93, v245
    v_mfma_f32_16x16x32_bf16 v[184:187], a[248:251], a[204:207], v[184:187]
    buffer_load_dwordx4 v[132:135], v248, s[4:7], s49 offen offset:1024 sc1
    v_fma_f32 v94, v246, v94, v246
    v_mfma_f32_16x16x32_bf16 v[216:219], a[252:255], a[204:207], 0
    v_rcp_f32 v92, v92
    v_mfma_f32_16x16x32_bf16 v[216:219], a[132:135], a[200:203], v[216:219]
    v_fma_f32 v95, v247, v95, v247
    v_fma_f32 v84, -v84, v92, v92
    v_mfma_f32_16x16x32_bf16 v[220:223], a[132:135], a[208:211], 0
    buffer_load_dwordx4 v[136:139], v248, s[4:7], s49 offen offset:2048 sc1
    v_mfma_f32_16x16x32_bf16 v[220:223], a[252:255], a[212:215], v[220:223]
    v_rcp_f32 v93, v93
    v_mfma_f32_16x16x32_bf16 v[188:191], a[248:251], a[212:215], 0
    buffer_load_dwordx4 v[140:143], v248, s[4:7], s49 offen offset:3072 sc1
    v_fma_f32 v85, -v85, v93, v93
    v_mfma_f32_16x16x32_bf16 v[188:191], a[128:131], a[208:211], v[188:191]
    v_rcp_f32 v94, v94
    v_mfma_f32_16x16x32_bf16 v[192:195], a[128:131], a[136:139], 0
    v_fma_f32 v86, -v86, v94, v94
    v_rcp_f32 v95, v95
    v_mfma_f32_16x16x32_bf16 v[192:195], a[248:251], a[140:143], v[192:195]
    s_mov_b32 s49, 69632
    buffer_load_dwordx4 v[64:67], v248, s[4:7], s49 offen offset:0 sc1
    v_fma_f32 v87, -v87, v95, v95
    v_mfma_f32_16x16x32_bf16 v[224:227], a[252:255], a[140:143], 0
    v_cvt_pk_bf16_f32 v14, v84, v85
    v_cvt_pk_bf16_f32 v15, v86, v87
    v_mfma_f32_16x16x32_bf16 v[224:227], a[132:135], a[136:139], v[224:227]
    ds_write_b128 v250, v[12:15] offset:4096
    v_mfma_f32_16x16x32_bf16 v[228:231], a[132:135], a[144:147], 0
    buffer_load_dwordx4 v[68:71], v248, s[4:7], s49 offen offset:1024 sc1
    v_min_f32 v160, s35, v160
    v_mfma_f32_16x16x32_bf16 v[228:231], a[252:255], a[148:151], v[228:231]
    v_min_f32 v161, s35, v161
    v_min_f32 v162, s35, v162
    v_mfma_f32_16x16x32_bf16 v[196:199], a[248:251], a[148:151], 0
    buffer_load_dwordx4 v[72:75], v248, s[4:7], s49 offen offset:2048 sc1
    v_min_f32 v163, s35, v163
    v_mfma_f32_16x16x32_bf16 v[196:199], a[128:131], a[144:147], v[196:199]
    v_exp_f32 v160, v160
    s_waitcnt vmcnt(19) lgkmcnt(0)
    s_barrier
    v_mfma_f32_16x16x32_bf16 v[200:203], a[128:131], a[152:155], 0
    s_add_u32 m0, s56, 64256
    ds_read_b64_tr_b16 a[64:65], v1 offset:32768
    v_add_f32 v240, 1.0, v160
    v_mfma_f32_16x16x32_bf16 v[200:203], a[248:251], a[156:159], v[200:203]
    buffer_load_dwordx4 v249, s[16:19], s60 offen offset:1280 sc1 lds
    ds_read_b64_tr_b16 a[66:67], v1 offset:33792
    v_mfma_f32_16x16x32_bf16 v[232:235], a[252:255], a[156:159], 0
    s_add_u32 m0, s56, 68352
    ds_read_b64_tr_b16 a[68:69], v1 offset:36864
    v_min_f32 v164, s35, v164
    v_mfma_f32_16x16x32_bf16 v[232:235], a[132:135], a[152:155], v[232:235]
    ds_read_b64_tr_b16 a[70:71], v1 offset:37888
    v_exp_f32 v168, v168
    v_mfma_f32_16x16x32_bf16 v[236:239], a[132:135], a[160:163], 0
    buffer_load_dwordx4 v249, s[16:19], s61 offen offset:1280 sc1 lds
    ds_read_b64_tr_b16 a[72:73], v1 offset:40960
    v_mfma_f32_16x16x32_bf16 v[236:239], a[252:255], a[164:167], v[236:239]
    s_add_u32 m0, s56, 72448
    ds_read_b64_tr_b16 a[74:75], v1 offset:41984
    v_fma_f32 v168, v240, v168, v240
    v_mfma_f32_16x16x32_bf16 v[204:207], a[248:251], a[164:167], 0
    ds_read_b64_tr_b16 a[76:77], v1 offset:45056
    v_min_f32 v165, s35, v165
    v_mfma_f32_16x16x32_bf16 v[204:207], a[128:131], a[160:163], v[204:207]
    s_waitcnt lgkmcnt(5)
    ds_read_b64_tr_b16 a[78:79], v1 offset:46080
    v_exp_f32 v161, v161
    v_mfma_f32_32x32x16_bf16 v[80:95], a[64:67], a[216:219], 0
    s_waitcnt lgkmcnt(4)
    buffer_load_dwordx4 v249, s[16:19], s62 offen offset:1280 sc1 lds
    ds_read_b64_tr_b16 a[80:81], v1 offset:49152
    ds_read_b64_tr_b16 a[82:83], v1 offset:50176
    v_add_f32 v241, 1.0, v161
    v_exp_f32 v169, v169
    v_mfma_f32_32x32x16_bf16 v[80:95], a[68:71], a[220:223], v[80:95]
    s_waitcnt lgkmcnt(4)
    s_add_u32 m0, s56, 76544
    ds_read_b64_tr_b16 a[84:85], v1 offset:53248
    buffer_load_dwordx4 v249, s[16:19], s63 offen offset:1280 sc1 lds
    ds_read_b64_tr_b16 a[86:87], v1 offset:54272
    ds_read_b128 a[128:131], v251 offset:4096
    v_exp_f32 v162, v162
    v_mfma_f32_32x32x16_bf16 v[80:95], a[72:75], a[224:227], v[80:95]
    s_waitcnt lgkmcnt(5)
    s_add_u32 m0, s56, 80640
    ds_read_b64_tr_b16 a[88:89], v1 offset:57344
    ds_read_b64_tr_b16 a[90:91], v1 offset:58368
    ds_read_b128 a[248:251], v251 offset:6144
    v_exp_f32 v170, v170
    v_exp_f32 v163, v163
    v_mfma_f32_32x32x16_bf16 v[80:95], a[76:79], a[228:231], v[80:95]
    s_waitcnt lgkmcnt(6)
    buffer_load_dwordx4 v249, s[16:19], s64 offen offset:1280 sc1 lds
    ds_read_b64_tr_b16 a[92:93], v1 offset:61440
    ds_read_b64_tr_b16 a[94:95], v1 offset:62464
    ds_read_b128 a[252:255], v251 offset:6400
    v_exp_f32 v171, v171
    v_mfma_f32_32x32x16_bf16 v[80:95], a[80:83], a[232:235], v[80:95]
    s_waitcnt lgkmcnt(7)
    s_add_u32 m0, s56, 84736
    s_nop 0
    buffer_load_dwordx4 v249, s[16:19], s65 offen offset:1280 sc1 lds
    ds_read_b128 a[132:135], v251 offset:4352
    v_add_f32 v242, 1.0, v162
    v_add_f32 v243, 1.0, v163
    v_fma_f32 v169, v241, v169, v241
    v_fma_f32 v170, v242, v170, v242
    v_mfma_f32_32x32x16_bf16 v[80:95], a[84:87], a[236:239], v[80:95]
    s_waitcnt lgkmcnt(2)
    s_add_u32 m0, s56, 88832
    v_fma_f32 v171, v243, v171, v243
    v_min_f32 v166, s35, v166
    v_rcp_f32 v168, v168
    v_rcp_f32 v169, v169
    v_mfma_f32_32x32x16_bf16 v[80:95], a[88:91], a[240:243], v[80:95]
    buffer_load_dwordx4 v249, s[16:19], s66 offen offset:1280 sc1 lds
    v_rcp_f32 v170, v170
    v_rcp_f32 v171, v171
    v_fma_f32 v160, -v160, v168, v168
    v_fma_f32 v161, -v161, v169, v169
    v_mfma_f32_32x32x16_bf16 v[80:95], a[92:95], a[244:247], v[80:95]
    s_waitcnt lgkmcnt(0)
    s_add_u32 m0, s56, 92928
    v_fma_f32 v162, -v162, v170, v170
    v_fma_f32 v163, -v163, v171, v171
    v_cvt_pk_bf16_f32 v12, v160, v161
    v_cvt_pk_bf16_f32 v13, v162, v163
    v_exp_f32 v164, v164
    v_mfma_f32_16x16x32_bf16 v[176:179], a[128:131], a[168:171], v[176:179]
    buffer_load_dwordx4 v249, s[16:19], s67 offen offset:1280 sc1 lds
    v_min_f32 v167, s35, v167
    v_mfma_f32_16x16x32_bf16 v[176:179], a[248:251], a[172:175], v[176:179]
    v_add_f32 v244, 1.0, v164
    v_exp_f32 v172, v172
    v_mfma_f32_16x16x32_bf16 v[208:211], a[252:255], a[172:175], v[208:211]
    v_exp_f32 v165, v165
    v_mfma_f32_16x16x32_bf16 v[208:211], a[132:135], a[168:171], v[208:211]
    buffer_load_dwordx4 v[76:79], v248, s[4:7], s49 offen offset:3072 sc1
    v_add_f32 v245, 1.0, v165
    v_mfma_f32_16x16x32_bf16 v[212:215], a[132:135], a[176:179], v[212:215]
    v_exp_f32 v173, v173
    v_mfma_f32_16x16x32_bf16 v[212:215], a[252:255], a[180:183], v[212:215]
    v_fma_f32 v172, v244, v172, v244
    v_exp_f32 v166, v166
    v_mfma_f32_16x16x32_bf16 v[180:183], a[248:251], a[180:183], v[180:183]
    s_mov_b32 s49, 73728
    buffer_load_dwordx4 v[144:147], v248, s[4:7], s49 offen offset:0 sc1
    v_add_f32 v246, 1.0, v166
    v_mfma_f32_16x16x32_bf16 v[180:183], a[128:131], a[176:179], v[180:183]
    v_exp_f32 v174, v174
    v_mfma_f32_16x16x32_bf16 v[184:187], a[128:131], a[96:99], v[184:187]
    v_fma_f32 v173, v245, v173, v245
    v_exp_f32 v167, v167
    v_mfma_f32_16x16x32_bf16 v[184:187], a[248:251], a[100:103], v[184:187]
    buffer_load_dwordx4 v[148:151], v248, s[4:7], s49 offen offset:1024 sc1
    v_add_f32 v247, 1.0, v167
    v_mfma_f32_16x16x32_bf16 v[216:219], a[252:255], a[100:103], v[216:219]
    v_exp_f32 v175, v175
    v_mfma_f32_16x16x32_bf16 v[216:219], a[132:135], a[96:99], v[216:219]
    v_fma_f32 v174, v246, v174, v246
    v_fma_f32 v175, v247, v175, v247
    v_mfma_f32_16x16x32_bf16 v[220:223], a[132:135], a[104:107], v[220:223]
    buffer_load_dwordx4 v[152:155], v248, s[4:7], s49 offen offset:2048 sc1
    v_rcp_f32 v172, v172
    v_mfma_f32_16x16x32_bf16 v[220:223], a[252:255], a[108:111], v[220:223]
    v_rcp_f32 v173, v173
    v_mfma_f32_16x16x32_bf16 v[188:191], a[248:251], a[108:111], v[188:191]
    v_rcp_f32 v174, v174
    v_mfma_f32_16x16x32_bf16 v[188:191], a[128:131], a[104:107], v[188:191]
    v_fma_f32 v164, -v164, v172, v172
    v_rcp_f32 v175, v175
    v_mfma_f32_16x16x32_bf16 v[192:195], a[128:131], a[112:115], v[192:195]
    buffer_load_dwordx4 v[156:159], v248, s[4:7], s49 offen offset:3072 sc1
    v_fma_f32 v165, -v165, v173, v173
    v_mfma_f32_16x16x32_bf16 v[192:195], a[248:251], a[116:119], v[192:195]
    v_fma_f32 v166, -v166, v174, v174
    v_fma_f32 v167, -v167, v175, v175
    v_mfma_f32_16x16x32_bf16 v[224:227], a[252:255], a[116:119], v[224:227]
    v_cvt_pk_bf16_f32 v14, v164, v165
    v_cvt_pk_bf16_f32 v15, v166, v167
    v_mfma_f32_16x16x32_bf16 v[224:227], a[132:135], a[112:115], v[224:227]
    s_mov_b32 s49, 77824
    buffer_load_dwordx4 a[184:187], v248, s[4:7], s49 offen offset:0 sc1
    v_mfma_f32_16x16x32_bf16 v[228:231], a[132:135], a[120:123], v[228:231]
    ds_write_b128 v250, v[12:15] offset:8192
    v_mfma_f32_16x16x32_bf16 v[228:231], a[252:255], a[124:127], v[228:231]
    v_min_f32 v80, s35, v80
    v_min_f32 v81, s35, v81
    v_mfma_f32_16x16x32_bf16 v[196:199], a[248:251], a[124:127], v[196:199]
    buffer_load_dwordx4 a[188:191], v248, s[4:7], s49 offen offset:1024 sc1
    v_min_f32 v82, s35, v82
    v_mfma_f32_16x16x32_bf16 v[196:199], a[128:131], a[120:123], v[196:199]
    v_exp_f32 v80, v80
    s_waitcnt vmcnt(22) lgkmcnt(0)
    s_barrier
    v_mfma_f32_16x16x32_bf16 v[200:203], a[128:131], a[0:3], v[200:203]
    s_add_u32 m0, s56, 96768
    ds_read_b64_tr_b16 a[64:65], v253 offset:0
    v_min_f32 v83, s35, v83
    v_mfma_f32_16x16x32_bf16 v[200:203], a[248:251], a[4:7], v[200:203]
    buffer_load_dwordx4 v249, s[16:19], s60 offen offset:1536 sc1 lds
    ds_read_b64_tr_b16 a[66:67], v253 offset:1024
    v_mfma_f32_16x16x32_bf16 v[232:235], a[252:255], a[4:7], v[232:235]
    s_add_u32 m0, s56, 100864
    ds_read_b64_tr_b16 a[68:69], v253 offset:4096
    v_add_f32 v240, 1.0, v80
    v_mfma_f32_16x16x32_bf16 v[232:235], a[132:135], a[0:3], v[232:235]
    ds_read_b64_tr_b16 a[70:71], v253 offset:5120
    v_exp_f32 v88, v88
    v_mfma_f32_16x16x32_bf16 v[236:239], a[132:135], a[8:11], v[236:239]
    buffer_load_dwordx4 v249, s[16:19], s61 offen offset:1536 sc1 lds
    ds_read_b64_tr_b16 a[72:73], v253 offset:8192
    v_mfma_f32_16x16x32_bf16 v[236:239], a[252:255], a[12:15], v[236:239]
    s_add_u32 m0, s56, 104960
    ds_read_b64_tr_b16 a[74:75], v253 offset:9216
    v_fma_f32 v88, v240, v88, v240
    v_mfma_f32_16x16x32_bf16 v[204:207], a[248:251], a[12:15], v[204:207]
    ds_read_b64_tr_b16 a[76:77], v253 offset:12288
    v_exp_f32 v81, v81
    v_mfma_f32_16x16x32_bf16 v[204:207], a[128:131], a[8:11], v[204:207]
    s_waitcnt lgkmcnt(5)
    ds_read_b64_tr_b16 a[78:79], v253 offset:13312
    v_add_f32 v241, 1.0, v81
    v_mfma_f32_32x32x16_bf16 v[160:175], a[64:67], a[216:219], 0
    s_waitcnt lgkmcnt(4)
    buffer_load_dwordx4 v249, s[16:19], s62 offen offset:1536 sc1 lds
    ds_read_b64_tr_b16 a[80:81], v253 offset:16384
    ds_read_b64_tr_b16 a[82:83], v253 offset:17408
    v_min_f32 v84, s35, v84
    v_exp_f32 v89, v89
    v_mfma_f32_32x32x16_bf16 v[160:175], a[68:71], a[220:223], v[160:175]
    s_waitcnt lgkmcnt(4)
    s_add_u32 m0, s56, 109056
    ds_read_b64_tr_b16 a[84:85], v253 offset:20480
    buffer_load_dwordx4 v249, s[16:19], s63 offen offset:1536 sc1 lds
    ds_read_b64_tr_b16 a[86:87], v253 offset:21504
    ds_read_b128 a[128:131], v251 offset:8192
    v_fma_f32 v89, v241, v89, v241
    v_exp_f32 v82, v82
    v_mfma_f32_32x32x16_bf16 v[160:175], a[72:75], a[224:227], v[160:175]
    s_waitcnt lgkmcnt(5)
    s_add_u32 m0, s56, 113152
    ds_read_b64_tr_b16 a[88:89], v253 offset:24576
    ds_read_b64_tr_b16 a[90:91], v253 offset:25600
    ds_read_b128 a[248:251], v251 offset:10240
    v_add_f32 v242, 1.0, v82
    v_exp_f32 v90, v90
    v_mfma_f32_32x32x16_bf16 v[160:175], a[76:79], a[228:231], v[160:175]
    s_waitcnt lgkmcnt(6)
    buffer_load_dwordx4 v249, s[16:19], s64 offen offset:1536 sc1 lds
    ds_read_b64_tr_b16 a[92:93], v253 offset:28672
    ds_read_b64_tr_b16 a[94:95], v253 offset:29696
    ds_read_b128 a[252:255], v251 offset:10496
    v_exp_f32 v83, v83
    v_mfma_f32_32x32x16_bf16 v[160:175], a[80:83], a[232:235], v[160:175]
    s_waitcnt lgkmcnt(7)
    s_add_u32 m0, s56, 117248
    s_nop 0
    buffer_load_dwordx4 v249, s[16:19], s65 offen offset:1536 sc1 lds
    ds_read_b128 a[132:135], v251 offset:8448
    v_add_f32 v243, 1.0, v83
    v_exp_f32 v91, v91
    v_fma_f32 v90, v242, v90, v242
    v_fma_f32 v91, v243, v91, v243
    v_mfma_f32_32x32x16_bf16 v[160:175], a[84:87], a[236:239], v[160:175]
    s_waitcnt lgkmcnt(2)
    s_add_u32 m0, s56, 121344
    v_rcp_f32 v88, v88
    v_rcp_f32 v89, v89
    v_rcp_f32 v90, v90
    v_mfma_f32_32x32x16_bf16 v[160:175], a[88:91], a[240:243], v[160:175]
    buffer_load_dwordx4 v249, s[16:19], s66 offen offset:1536 sc1 lds
    v_fma_f32 v80, -v80, v88, v88
    v_rcp_f32 v91, v91
    v_fma_f32 v81, -v81, v89, v89
    v_fma_f32 v82, -v82, v90, v90
    v_mfma_f32_32x32x16_bf16 v[160:175], a[92:95], a[244:247], v[160:175]
    s_waitcnt lgkmcnt(0)
    s_add_u32 m0, s56, 125440
    v_fma_f32 v83, -v83, v91, v91
    v_cvt_pk_bf16_f32 v12, v80, v81
    v_cvt_pk_bf16_f32 v13, v82, v83
    v_min_f32 v85, s35, v85
    v_min_f32 v86, s35, v86
    v_min_f32 v87, s35, v87
    v_mfma_f32_16x16x32_bf16 v[176:179], a[128:131], a[16:19], v[176:179]
    buffer_load_dwordx4 v249, s[16:19], s67 offen offset:1536 sc1 lds
    v_exp_f32 v84, v84
    v_mfma_f32_16x16x32_bf16 v[176:179], a[248:251], a[20:23], v[176:179]
    v_exp_f32 v92, v92
    v_mfma_f32_16x16x32_bf16 v[208:211], a[252:255], a[20:23], v[208:211]
    v_exp_f32 v85, v85
    v_mfma_f32_16x16x32_bf16 v[208:211], a[132:135], a[16:19], v[208:211]
    buffer_load_dwordx4 a[192:195], v248, s[4:7], s49 offen offset:2048 sc1
    v_exp_f32 v93, v93
    v_mfma_f32_16x16x32_bf16 v[212:215], a[132:135], a[24:27], v[212:215]
    v_exp_f32 v86, v86
    v_mfma_f32_16x16x32_bf16 v[212:215], a[252:255], a[28:31], v[212:215]
    v_exp_f32 v94, v94
    v_mfma_f32_16x16x32_bf16 v[180:183], a[248:251], a[28:31], v[180:183]
    buffer_load_dwordx4 a[196:199], v248, s[4:7], s49 offen offset:3072 sc1
    v_exp_f32 v87, v87
    v_mfma_f32_16x16x32_bf16 v[180:183], a[128:131], a[24:27], v[180:183]
    v_exp_f32 v95, v95
    v_mfma_f32_16x16x32_bf16 v[184:187], a[128:131], a[32:35], v[184:187]
    v_add_f32 v244, 1.0, v84
    v_add_f32 v245, 1.0, v85
    v_mfma_f32_16x16x32_bf16 v[184:187], a[248:251], a[36:39], v[184:187]
    s_mov_b32 s49, 81920
    buffer_load_dwordx4 a[200:203], v248, s[4:7], s49 offen offset:0 sc1
    v_add_f32 v246, 1.0, v86
    v_add_f32 v247, 1.0, v87
    v_mfma_f32_16x16x32_bf16 v[216:219], a[252:255], a[36:39], v[216:219]
    v_fma_f32 v92, v244, v92, v244
    v_fma_f32 v93, v245, v93, v245
    v_mfma_f32_16x16x32_bf16 v[216:219], a[132:135], a[32:35], v[216:219]
    v_fma_f32 v94, v246, v94, v246
    v_fma_f32 v95, v247, v95, v247
    v_mfma_f32_16x16x32_bf16 v[220:223], a[132:135], a[40:43], v[220:223]
    buffer_load_dwordx4 a[204:207], v248, s[4:7], s49 offen offset:1024 sc1
    v_rcp_f32 v92, v92
    v_mfma_f32_16x16x32_bf16 v[220:223], a[252:255], a[44:47], v[220:223]
    v_rcp_f32 v93, v93
    v_mfma_f32_16x16x32_bf16 v[188:191], a[248:251], a[44:47], v[188:191]
    v_rcp_f32 v94, v94
    v_mfma_f32_16x16x32_bf16 v[188:191], a[128:131], a[40:43], v[188:191]
    v_rcp_f32 v95, v95
    v_mfma_f32_16x16x32_bf16 v[192:195], a[128:131], a[48:51], v[192:195]
    buffer_load_dwordx4 a[208:211], v248, s[4:7], s49 offen offset:2048 sc1
    v_fma_f32 v84, -v84, v92, v92
    v_fma_f32 v85, -v85, v93, v93
    v_mfma_f32_16x16x32_bf16 v[192:195], a[248:251], a[52:55], v[192:195]
    v_fma_f32 v86, -v86, v94, v94
    v_fma_f32 v87, -v87, v95, v95
    v_mfma_f32_16x16x32_bf16 v[224:227], a[252:255], a[52:55], v[224:227]
    v_cvt_pk_bf16_f32 v14, v84, v85
    v_cvt_pk_bf16_f32 v15, v86, v87
    v_mfma_f32_16x16x32_bf16 v[224:227], a[132:135], a[48:51], v[224:227]
    buffer_load_dwordx4 a[212:215], v248, s[4:7], s49 offen offset:3072 sc1
    v_mfma_f32_16x16x32_bf16 v[228:231], a[132:135], a[56:59], v[228:231]
    ds_write_b128 v250, v[12:15] offset:12288
    v_mfma_f32_16x16x32_bf16 v[228:231], a[252:255], a[60:63], v[228:231]
    v_min_f32 v160, s35, v160
    v_min_f32 v161, s35, v161
    v_mfma_f32_16x16x32_bf16 v[196:199], a[248:251], a[60:63], v[196:199]
    s_mov_b32 s49, 86016
    buffer_load_dwordx4 a[136:139], v248, s[4:7], s49 offen offset:0 sc1
    v_min_f32 v162, s35, v162
    v_mfma_f32_16x16x32_bf16 v[196:199], a[128:131], a[56:59], v[196:199]
    v_exp_f32 v160, v160
    s_waitcnt vmcnt(22) lgkmcnt(0)
    s_barrier
    v_mfma_f32_16x16x32_bf16 v[200:203], a[128:131], v[16:19], v[200:203]
    s_add_u32 m0, s56, 129280
    ds_read_b64_tr_b16 a[64:65], v253 offset:32768
    v_min_f32 v163, s35, v163
    v_mfma_f32_16x16x32_bf16 v[200:203], a[248:251], v[20:23], v[200:203]
    buffer_load_dwordx4 v249, s[16:19], s60 offen offset:1792 sc1 lds
    ds_read_b64_tr_b16 a[66:67], v253 offset:33792
    v_mfma_f32_16x16x32_bf16 v[232:235], a[252:255], v[20:23], v[232:235]
    s_add_u32 m0, s56, 133376
    ds_read_b64_tr_b16 a[68:69], v253 offset:36864
    v_add_f32 v240, 1.0, v160
    v_mfma_f32_16x16x32_bf16 v[232:235], a[132:135], v[16:19], v[232:235]
    ds_read_b64_tr_b16 a[70:71], v253 offset:37888
    v_exp_f32 v168, v168
    v_mfma_f32_16x16x32_bf16 v[236:239], a[132:135], v[24:27], v[236:239]
    buffer_load_dwordx4 v249, s[16:19], s61 offen offset:1792 sc1 lds
    ds_read_b64_tr_b16 a[72:73], v253 offset:40960
    v_mfma_f32_16x16x32_bf16 v[236:239], a[252:255], v[28:31], v[236:239]
    s_add_u32 m0, s56, 137472
    ds_read_b64_tr_b16 a[74:75], v253 offset:41984
    v_fma_f32 v168, v240, v168, v240
    v_mfma_f32_16x16x32_bf16 v[204:207], a[248:251], v[28:31], v[204:207]
    ds_read_b64_tr_b16 a[76:77], v253 offset:45056
    v_exp_f32 v161, v161
    v_mfma_f32_16x16x32_bf16 v[204:207], a[128:131], v[24:27], v[204:207]
    s_waitcnt lgkmcnt(5)
    ds_read_b64_tr_b16 a[78:79], v253 offset:46080
    v_add_f32 v241, 1.0, v161
    v_mfma_f32_32x32x16_bf16 v[80:95], a[64:67], a[216:219], 0
    s_waitcnt lgkmcnt(4)
    buffer_load_dwordx4 v249, s[16:19], s62 offen offset:1792 sc1 lds
    ds_read_b64_tr_b16 a[80:81], v253 offset:49152
    ds_read_b64_tr_b16 a[82:83], v253 offset:50176
    v_min_f32 v164, s35, v164
    v_exp_f32 v169, v169
    v_mfma_f32_32x32x16_bf16 v[80:95], a[68:71], a[220:223], v[80:95]
    s_waitcnt lgkmcnt(4)
    s_add_u32 m0, s56, 141568
    ds_read_b64_tr_b16 a[84:85], v253 offset:53248
    buffer_load_dwordx4 v249, s[16:19], s63 offen offset:1792 sc1 lds
    ds_read_b64_tr_b16 a[86:87], v253 offset:54272
    ds_read_b128 a[128:131], v251 offset:12288
    v_fma_f32 v169, v241, v169, v241
    v_exp_f32 v162, v162
    v_mfma_f32_32x32x16_bf16 v[80:95], a[72:75], a[224:227], v[80:95]
    s_waitcnt lgkmcnt(5)
    s_add_u32 m0, s56, 145664
    ds_read_b64_tr_b16 a[88:89], v253 offset:57344
    ds_read_b64_tr_b16 a[90:91], v253 offset:58368
    ds_read_b128 a[248:251], v251 offset:14336
    v_add_f32 v242, 1.0, v162
    v_exp_f32 v170, v170
    v_mfma_f32_32x32x16_bf16 v[80:95], a[76:79], a[228:231], v[80:95]
    s_waitcnt lgkmcnt(6)
    buffer_load_dwordx4 v249, s[16:19], s64 offen offset:1792 sc1 lds
    ds_read_b64_tr_b16 a[92:93], v253 offset:61440
    ds_read_b64_tr_b16 a[94:95], v253 offset:62464
    ds_read_b128 a[252:255], v251 offset:14592
    v_exp_f32 v163, v163
    v_mfma_f32_32x32x16_bf16 v[80:95], a[80:83], a[232:235], v[80:95]
    s_waitcnt lgkmcnt(7)
    s_add_u32 m0, s56, 149760
    s_nop 0
    buffer_load_dwordx4 v249, s[16:19], s65 offen offset:1792 sc1 lds
    ds_read_b128 a[132:135], v251 offset:12544
    v_add_f32 v243, 1.0, v163
    v_exp_f32 v171, v171
    v_fma_f32 v170, v242, v170, v242
    v_fma_f32 v171, v243, v171, v243
    v_mfma_f32_32x32x16_bf16 v[80:95], a[84:87], a[236:239], v[80:95]
    s_waitcnt lgkmcnt(2)
    s_add_u32 m0, s56, 153856
    v_rcp_f32 v168, v168
    v_rcp_f32 v169, v169
    v_rcp_f32 v170, v170
    v_mfma_f32_32x32x16_bf16 v[80:95], a[88:91], a[240:243], v[80:95]
    buffer_load_dwordx4 v249, s[16:19], s66 offen offset:1792 sc1 lds
    v_fma_f32 v160, -v160, v168, v168
    v_rcp_f32 v171, v171
    v_fma_f32 v161, -v161, v169, v169
    v_fma_f32 v162, -v162, v170, v170
    v_mfma_f32_32x32x16_bf16 v[80:95], a[92:95], a[244:247], v[80:95]
    s_waitcnt lgkmcnt(0)
    s_add_u32 m0, s56, 157952
    v_fma_f32 v163, -v163, v171, v171
    v_cvt_pk_bf16_f32 v12, v160, v161
    v_cvt_pk_bf16_f32 v13, v162, v163
    v_min_f32 v165, s35, v165
    v_min_f32 v166, s35, v166
    v_min_f32 v167, s35, v167
    v_mfma_f32_16x16x32_bf16 v[176:179], a[128:131], v[96:99], v[176:179]
    buffer_load_dwordx4 v249, s[16:19], s67 offen offset:1792 sc1 lds
    v_exp_f32 v164, v164
    v_mfma_f32_16x16x32_bf16 v[176:179], a[248:251], v[100:103], v[176:179]
    v_exp_f32 v172, v172
    v_mfma_f32_16x16x32_bf16 v[208:211], a[252:255], v[100:103], v[208:211]
    v_exp_f32 v165, v165
    v_mfma_f32_16x16x32_bf16 v[208:211], a[132:135], v[96:99], v[208:211]
    buffer_load_dwordx4 a[140:143], v248, s[4:7], s49 offen offset:1024 sc1
    v_exp_f32 v173, v173
    v_mfma_f32_16x16x32_bf16 v[212:215], a[132:135], v[104:107], v[212:215]
    v_exp_f32 v166, v166
    v_mfma_f32_16x16x32_bf16 v[212:215], a[252:255], v[108:111], v[212:215]
    v_exp_f32 v174, v174
    v_mfma_f32_16x16x32_bf16 v[180:183], a[248:251], v[108:111], v[180:183]
    buffer_load_dwordx4 a[144:147], v248, s[4:7], s49 offen offset:2048 sc1
    v_exp_f32 v167, v167
    v_mfma_f32_16x16x32_bf16 v[180:183], a[128:131], v[104:107], v[180:183]
    v_exp_f32 v175, v175
    v_mfma_f32_16x16x32_bf16 v[184:187], a[128:131], v[32:35], v[184:187]
    v_add_f32 v244, 1.0, v164
    v_add_f32 v245, 1.0, v165
    v_mfma_f32_16x16x32_bf16 v[184:187], a[248:251], v[36:39], v[184:187]
    buffer_load_dwordx4 a[148:151], v248, s[4:7], s49 offen offset:3072 sc1
    v_add_f32 v246, 1.0, v166
    v_add_f32 v247, 1.0, v167
    v_mfma_f32_16x16x32_bf16 v[216:219], a[252:255], v[36:39], v[216:219]
    v_fma_f32 v172, v244, v172, v244
    v_fma_f32 v173, v245, v173, v245
    v_mfma_f32_16x16x32_bf16 v[216:219], a[132:135], v[32:35], v[216:219]
    v_fma_f32 v174, v246, v174, v246
    v_fma_f32 v175, v247, v175, v247
    v_mfma_f32_16x16x32_bf16 v[220:223], a[132:135], v[40:43], v[220:223]
    s_mov_b32 s49, 90112
    buffer_load_dwordx4 a[152:155], v248, s[4:7], s49 offen offset:0 sc1
    v_rcp_f32 v172, v172
    v_mfma_f32_16x16x32_bf16 v[220:223], a[252:255], v[44:47], v[220:223]
    v_rcp_f32 v173, v173
    v_mfma_f32_16x16x32_bf16 v[188:191], a[248:251], v[44:47], v[188:191]
    v_rcp_f32 v174, v174
    v_mfma_f32_16x16x32_bf16 v[188:191], a[128:131], v[40:43], v[188:191]
    v_rcp_f32 v175, v175
    v_mfma_f32_16x16x32_bf16 v[192:195], a[128:131], v[112:115], v[192:195]
    buffer_load_dwordx4 a[156:159], v248, s[4:7], s49 offen offset:1024 sc1
    v_fma_f32 v164, -v164, v172, v172
    v_fma_f32 v165, -v165, v173, v173
    v_mfma_f32_16x16x32_bf16 v[192:195], a[248:251], v[116:119], v[192:195]
    v_fma_f32 v166, -v166, v174, v174
    v_fma_f32 v167, -v167, v175, v175
    v_mfma_f32_16x16x32_bf16 v[224:227], a[252:255], v[116:119], v[224:227]
    v_cvt_pk_bf16_f32 v14, v164, v165
    v_cvt_pk_bf16_f32 v15, v166, v167
    v_mfma_f32_16x16x32_bf16 v[224:227], a[132:135], v[112:115], v[224:227]
    buffer_load_dwordx4 a[160:163], v248, s[4:7], s49 offen offset:2048 sc1
    v_mfma_f32_16x16x32_bf16 v[228:231], a[132:135], v[120:123], v[228:231]
    ds_write_b128 v250, v[12:15] offset:16384
    v_mfma_f32_16x16x32_bf16 v[228:231], a[252:255], v[124:127], v[228:231]
    v_min_f32 v80, s35, v80
    v_min_f32 v81, s35, v81
    v_mfma_f32_16x16x32_bf16 v[196:199], a[248:251], v[124:127], v[196:199]
    buffer_load_dwordx4 a[164:167], v248, s[4:7], s49 offen offset:3072 sc1
    v_min_f32 v82, s35, v82
    v_mfma_f32_16x16x32_bf16 v[196:199], a[128:131], v[120:123], v[196:199]
    v_exp_f32 v80, v80
    s_waitcnt vmcnt(22) lgkmcnt(0)
    s_barrier
    v_mfma_f32_16x16x32_bf16 v[200:203], a[128:131], v[48:51], v[200:203]
    ds_read_b64_tr_b16 a[64:65], v1 offset:0
    v_min_f32 v83, s35, v83
    v_mfma_f32_16x16x32_bf16 v[200:203], a[248:251], v[52:55], v[200:203]
    s_mov_b32 s49, 94208
    buffer_load_dwordx4 a[168:171], v248, s[4:7], s49 offen offset:0 sc1
    ds_read_b64_tr_b16 a[66:67], v1 offset:1024
    v_mfma_f32_16x16x32_bf16 v[232:235], a[252:255], v[52:55], v[232:235]
    ds_read_b64_tr_b16 a[68:69], v1 offset:4096
    v_add_f32 v240, 1.0, v80
    v_mfma_f32_16x16x32_bf16 v[232:235], a[132:135], v[48:51], v[232:235]
    ds_read_b64_tr_b16 a[70:71], v1 offset:5120
    v_exp_f32 v88, v88
    v_mfma_f32_16x16x32_bf16 v[236:239], a[132:135], v[56:59], v[236:239]
    ds_read_b64_tr_b16 a[72:73], v1 offset:8192
    v_fma_f32 v88, v240, v88, v240
    v_mfma_f32_16x16x32_bf16 v[236:239], a[252:255], v[60:63], v[236:239]
    buffer_load_dwordx4 a[172:175], v248, s[4:7], s49 offen offset:1024 sc1
    ds_read_b64_tr_b16 a[74:75], v1 offset:9216
    v_mfma_f32_16x16x32_bf16 v[204:207], a[248:251], v[60:63], v[204:207]
    ds_read_b64_tr_b16 a[76:77], v1 offset:12288
    v_min_f32 v84, s35, v84
    v_mfma_f32_16x16x32_bf16 v[204:207], a[128:131], v[56:59], v[204:207]
    s_waitcnt lgkmcnt(5)
    ds_read_b64_tr_b16 a[78:79], v1 offset:13312
    v_exp_f32 v81, v81
    v_mfma_f32_32x32x16_bf16 v[160:175], a[64:67], a[216:219], 0
    s_waitcnt lgkmcnt(4)
    buffer_load_dwordx4 a[176:179], v248, s[4:7], s49 offen offset:2048 sc1
    ds_read_b64_tr_b16 a[80:81], v1 offset:16384
L_pad11:
    s_cbranch_execz L_back
    ds_read_b64_tr_b16 a[82:83], v1 offset:17408
    v_add_f32 v241, 1.0, v81
    v_exp_f32 v89, v89
    v_mfma_f32_32x32x16_bf16 v[160:175], a[68:71], a[220:223], v[160:175]
    s_waitcnt lgkmcnt(4)
    ds_read_b64_tr_b16 a[84:85], v1 offset:20480
    ds_read_b64_tr_b16 a[86:87], v1 offset:21504
    ds_read_b128 a[128:131], v251 offset:16384
    v_fma_f32 v89, v241, v89, v241
    v_exp_f32 v82, v82
    v_mfma_f32_32x32x16_bf16 v[160:175], a[72:75], a[224:227], v[160:175]
    s_waitcnt lgkmcnt(5)
    buffer_load_dwordx4 a[180:183], v248, s[4:7], s49 offen offset:3072 sc1
    ds_read_b64_tr_b16 a[88:89], v1 offset:24576
    ds_read_b64_tr_b16 a[90:91], v1 offset:25600
    ds_read_b128 a[248:251], v251 offset:18432
    v_add_f32 v242, 1.0, v82
    v_exp_f32 v90, v90
    v_mfma_f32_32x32x16_bf16 v[160:175], a[76:79], a[228:231], v[160:175]
    s_waitcnt lgkmcnt(6)
    s_mov_b32 s49, 98304
    buffer_load_dwordx4 a[96:99], v248, s[4:7], s49 offen offset:0 sc1
    ds_read_b64_tr_b16 a[92:93], v1 offset:28672
    ds_read_b64_tr_b16 a[94:95], v1 offset:29696
    ds_read_b128 a[252:255], v251 offset:18688
    v_exp_f32 v83, v83
    v_mfma_f32_32x32x16_bf16 v[160:175], a[80:83], a[232:235], v[160:175]
    s_waitcnt lgkmcnt(7)
    ds_read_b128 a[132:135], v251 offset:16640
    v_add_f32 v243, 1.0, v83
    v_exp_f32 v91, v91
    v_fma_f32 v90, v242, v90, v242
    v_fma_f32 v91, v243, v91, v243
    v_mfma_f32_32x32x16_bf16 v[160:175], a[84:87], a[236:239], v[160:175]
    s_waitcnt lgkmcnt(2)
    buffer_load_dwordx4 a[100:103], v248, s[4:7], s49 offen offset:1024 sc1
    v_rcp_f32 v88, v88
    v_rcp_f32 v89, v89
    v_rcp_f32 v90, v90
    v_mfma_f32_32x32x16_bf16 v[160:175], a[88:91], a[240:243], v[160:175]
    v_rcp_f32 v91, v91
    v_fma_f32 v80, -v80, v88, v88
    v_fma_f32 v81, -v81, v89, v89
    v_fma_f32 v82, -v82, v90, v90
    v_fma_f32 v83, -v83, v91, v91
    v_mfma_f32_32x32x16_bf16 v[160:175], a[92:95], a[244:247], v[160:175]
    s_waitcnt lgkmcnt(0)
    buffer_load_dwordx4 a[104:107], v248, s[4:7], s49 offen offset:2048 sc1
    v_cvt_pk_bf16_f32 v12, v80, v81
    v_cvt_pk_bf16_f32 v13, v82, v83
    v_min_f32 v85, s35, v85
    v_min_f32 v86, s35, v86
    v_min_f32 v87, s35, v87
    v_mfma_f32_16x16x32_bf16 v[176:179], a[128:131], v[128:131], v[176:179]
    v_exp_f32 v84, v84
    v_mfma_f32_16x16x32_bf16 v[176:179], a[248:251], v[132:135], v[176:179]
    buffer_load_dwordx4 a[108:111], v248, s[4:7], s49 offen offset:3072 sc1
    v_exp_f32 v92, v92
    v_mfma_f32_16x16x32_bf16 v[208:211], a[252:255], v[132:135], v[208:211]
    v_exp_f32 v85, v85
    v_mfma_f32_16x16x32_bf16 v[208:211], a[132:135], v[128:131], v[208:211]
    v_exp_f32 v93, v93
    v_mfma_f32_16x16x32_bf16 v[212:215], a[132:135], v[136:139], v[212:215]
    v_add_f32 v244, 1.0, v84
    v_exp_f32 v86, v86
    v_mfma_f32_16x16x32_bf16 v[212:215], a[252:255], v[140:143], v[212:215]
    s_mov_b32 s49, 102400
    buffer_load_dwordx4 a[112:115], v248, s[4:7], s49 offen offset:0 sc1
    v_add_f32 v245, 1.0, v85
    v_mfma_f32_16x16x32_bf16 v[180:183], a[248:251], v[140:143], v[180:183]
    v_exp_f32 v94, v94
    v_mfma_f32_16x16x32_bf16 v[180:183], a[128:131], v[136:139], v[180:183]
    v_exp_f32 v87, v87
    v_mfma_f32_16x16x32_bf16 v[184:187], a[128:131], v[64:67], v[184:187]
    buffer_load_dwordx4 a[116:119], v248, s[4:7], s49 offen offset:1024 sc1
    v_exp_f32 v95, v95
    v_mfma_f32_16x16x32_bf16 v[184:187], a[248:251], v[68:71], v[184:187]
    v_add_f32 v246, 1.0, v86
    v_add_f32 v247, 1.0, v87
    v_mfma_f32_16x16x32_bf16 v[216:219], a[252:255], v[68:71], v[216:219]
    v_fma_f32 v92, v244, v92, v244
    v_fma_f32 v93, v245, v93, v245
    v_mfma_f32_16x16x32_bf16 v[216:219], a[132:135], v[64:67], v[216:219]
    v_fma_f32 v94, v246, v94, v246
    v_fma_f32 v95, v247, v95, v247
    v_mfma_f32_16x16x32_bf16 v[220:223], a[132:135], v[72:75], v[220:223]
    buffer_load_dwordx4 a[120:123], v248, s[4:7], s49 offen offset:2048 sc1
    v_rcp_f32 v92, v92
    v_mfma_f32_16x16x32_bf16 v[220:223], a[252:255], v[76:79], v[220:223]
    v_rcp_f32 v93, v93
    v_mfma_f32_16x16x32_bf16 v[188:191], a[248:251], v[76:79], v[188:191]
    v_rcp_f32 v94, v94
    v_mfma_f32_16x16x32_bf16 v[188:191], a[128:131], v[72:75], v[188:191]
    buffer_load_dwordx4 a[124:127], v248, s[4:7], s49 offen offset:3072 sc1
    v_rcp_f32 v95, v95
    v_mfma_f32_16x16x32_bf16 v[192:195], a[128:131], v[144:147], v[192:195]
    v_fma_f32 v84, -v84, v92, v92
    v_fma_f32 v85, -v85, v93, v93
    v_mfma_f32_16x16x32_bf16 v[192:195], a[248:251], v[148:151], v[192:195]
    v_fma_f32 v86, -v86, v94, v94
    v_fma_f32 v87, -v87, v95, v95
    v_mfma_f32_16x16x32_bf16 v[224:227], a[252:255], v[148:151], v[224:227]
    s_mov_b32 s49, 106496
    buffer_load_dwordx4 a[0:3], v248, s[4:7], s49 offen offset:0 sc1
    v_cvt_pk_bf16_f32 v14, v84, v85
    v_cvt_pk_bf16_f32 v15, v86, v87
    v_mfma_f32_16x16x32_bf16 v[224:227], a[132:135], v[144:147], v[224:227]
    ds_write_b128 v250, v[12:15] offset:20480
    v_mfma_f32_16x16x32_bf16 v[228:231], a[132:135], v[152:155], v[228:231]
    v_min_f32 v160, s35, v160
    v_min_f32 v161, s35, v161
    v_mfma_f32_16x16x32_bf16 v[228:231], a[252:255], v[156:159], v[228:231]
    v_min_f32 v162, s35, v162
    v_min_f32 v163, s35, v163
    v_mfma_f32_16x16x32_bf16 v[196:199], a[248:251], v[156:159], v[196:199]
    buffer_load_dwordx4 a[4:7], v248, s[4:7], s49 offen offset:1024 sc1
    v_min_f32 v164, s35, v164
    v_mfma_f32_16x16x32_bf16 v[196:199], a[128:131], v[152:155], v[196:199]
    v_exp_f32 v160, v160
    s_waitcnt vmcnt(21) lgkmcnt(0)
    s_barrier
    v_mfma_f32_16x16x32_bf16 v[200:203], a[128:131], a[184:187], v[200:203]
    ds_read_b64_tr_b16 a[64:65], v1 offset:32768
    v_add_f32 v240, 1.0, v160
    v_mfma_f32_16x16x32_bf16 v[200:203], a[248:251], a[188:191], v[200:203]
    buffer_load_dwordx4 a[8:11], v248, s[4:7], s49 offen offset:2048 sc1
    ds_read_b64_tr_b16 a[66:67], v1 offset:33792
    v_mfma_f32_16x16x32_bf16 v[232:235], a[252:255], a[188:191], v[232:235]
    ds_read_b64_tr_b16 a[68:69], v1 offset:36864
    v_min_f32 v165, s35, v165
    v_mfma_f32_16x16x32_bf16 v[232:235], a[132:135], a[184:187], v[232:235]
    ds_read_b64_tr_b16 a[70:71], v1 offset:37888
    v_min_f32 v166, s35, v166
    v_mfma_f32_16x16x32_bf16 v[236:239], a[132:135], a[192:195], v[236:239]
    ds_read_b64_tr_b16 a[72:73], v1 offset:40960
    v_exp_f32 v168, v168
    v_mfma_f32_16x16x32_bf16 v[236:239], a[252:255], a[196:199], v[236:239]
    buffer_load_dwordx4 a[12:15], v248, s[4:7], s49 offen offset:3072 sc1
    ds_read_b64_tr_b16 a[74:75], v1 offset:41984
    v_mfma_f32_16x16x32_bf16 v[204:207], a[248:251], a[196:199], v[204:207]
    ds_read_b64_tr_b16 a[76:77], v1 offset:45056
    v_fma_f32 v168, v240, v168, v240
    v_mfma_f32_16x16x32_bf16 v[204:207], a[128:131], a[192:195], v[204:207]
    s_waitcnt lgkmcnt(5)
    ds_read_b64_tr_b16 a[78:79], v1 offset:46080
    v_min_f32 v167, s35, v167
    v_mfma_f32_32x32x16_bf16 v[80:95], a[64:67], a[216:219], 0
    s_waitcnt lgkmcnt(4)
    s_mov_b32 s49, 110592
    buffer_load_dwordx4 a[16:19], v248, s[4:7], s49 offen offset:0 sc1
    ds_read_b64_tr_b16 a[80:81], v1 offset:49152
    ds_read_b64_tr_b16 a[82:83], v1 offset:50176
    v_exp_f32 v161, v161
    v_exp_f32 v169, v169
    v_mfma_f32_32x32x16_bf16 v[80:95], a[68:71], a[220:223], v[80:95]
    s_waitcnt lgkmcnt(4)
    ds_read_b64_tr_b16 a[84:85], v1 offset:53248
    ds_read_b64_tr_b16 a[86:87], v1 offset:54272
    ds_read_b128 a[128:131], v251 offset:20480
    v_add_f32 v241, 1.0, v161
    v_exp_f32 v162, v162
    v_mfma_f32_32x32x16_bf16 v[80:95], a[72:75], a[224:227], v[80:95]
    s_waitcnt lgkmcnt(5)
    buffer_load_dwordx4 a[20:23], v248, s[4:7], s49 offen offset:1024 sc1
    ds_read_b64_tr_b16 a[88:89], v1 offset:57344
    ds_read_b64_tr_b16 a[90:91], v1 offset:58368
    ds_read_b128 a[248:251], v251 offset:22528
    v_exp_f32 v170, v170
    v_mfma_f32_32x32x16_bf16 v[80:95], a[76:79], a[228:231], v[80:95]
    s_waitcnt lgkmcnt(6)
    buffer_load_dwordx4 a[24:27], v248, s[4:7], s49 offen offset:2048 sc1
    ds_read_b64_tr_b16 a[92:93], v1 offset:61440
    ds_read_b64_tr_b16 a[94:95], v1 offset:62464
    ds_read_b128 a[252:255], v251 offset:22784
    v_exp_f32 v163, v163
    v_mfma_f32_32x32x16_bf16 v[80:95], a[80:83], a[232:235], v[80:95]
    s_waitcnt lgkmcnt(7)
    ds_read_b128 a[132:135], v251 offset:20736
    v_add_f32 v242, 1.0, v162
    v_exp_f32 v171, v171
    v_add_f32 v243, 1.0, v163
    v_fma_f32 v169, v241, v169, v241
    v_mfma_f32_32x32x16_bf16 v[80:95], a[84:87], a[236:239], v[80:95]
    s_waitcnt lgkmcnt(2)
    buffer_load_dwordx4 a[28:31], v248, s[4:7], s49 offen offset:3072 sc1
    v_fma_f32 v170, v242, v170, v242
    v_fma_f32 v171, v243, v171, v243
    v_rcp_f32 v168, v168
    v_rcp_f32 v169, v169
    v_mfma_f32_32x32x16_bf16 v[80:95], a[88:91], a[240:243], v[80:95]
    v_rcp_f32 v170, v170
    v_rcp_f32 v171, v171
    v_fma_f32 v160, -v160, v168, v168
    v_fma_f32 v161, -v161, v169, v169
    v_mfma_f32_32x32x16_bf16 v[80:95], a[92:95], a[244:247], v[80:95]
    s_waitcnt lgkmcnt(0)
    s_mov_b32 s49, 114688
    buffer_load_dwordx4 a[32:35], v248, s[4:7], s49 offen offset:0 sc1
    v_fma_f32 v162, -v162, v170, v170
    v_fma_f32 v163, -v163, v171, v171
    v_cvt_pk_bf16_f32 v12, v160, v161
    v_exp_f32 v164, v164
    v_mfma_f32_16x16x32_bf16 v[176:179], a[128:131], a[200:203], v[176:179]
    v_exp_f32 v172, v172
    v_mfma_f32_16x16x32_bf16 v[176:179], a[248:251], a[204:207], v[176:179]
    buffer_load_dwordx4 a[36:39], v248, s[4:7], s49 offen offset:1024 sc1
    v_cvt_pk_bf16_f32 v13, v162, v163
    v_add_f32 v244, 1.0, v164
    v_mfma_f32_16x16x32_bf16 v[208:211], a[252:255], a[204:207], v[208:211]
    v_exp_f32 v165, v165
    v_mfma_f32_16x16x32_bf16 v[208:211], a[132:135], a[200:203], v[208:211]
    v_exp_f32 v173, v173
    v_mfma_f32_16x16x32_bf16 v[212:215], a[132:135], a[208:211], v[212:215]
    v_exp_f32 v166, v166
    v_mfma_f32_16x16x32_bf16 v[212:215], a[252:255], a[212:215], v[212:215]
    buffer_load_dwordx4 a[40:43], v248, s[4:7], s49 offen offset:2048 sc1
    v_exp_f32 v174, v174
    v_mfma_f32_16x16x32_bf16 v[180:183], a[248:251], a[212:215], v[180:183]
    v_exp_f32 v167, v167
    v_mfma_f32_16x16x32_bf16 v[180:183], a[128:131], a[208:211], v[180:183]
    s_waitcnt vmcnt(27)
    v_exp_f32 v175, v175
    v_mfma_f32_16x16x32_bf16 v[184:187], a[128:131], a[136:139], v[184:187]
    buffer_load_dwordx4 a[44:47], v248, s[4:7], s49 offen offset:3072 sc1
    v_add_f32 v245, 1.0, v165
    v_mfma_f32_16x16x32_bf16 v[184:187], a[248:251], a[140:143], v[184:187]
    v_add_f32 v246, 1.0, v166
    v_add_f32 v247, 1.0, v167
    v_mfma_f32_16x16x32_bf16 v[216:219], a[252:255], a[140:143], v[216:219]
    v_fma_f32 v172, v244, v172, v244
    v_fma_f32 v173, v245, v173, v245
    v_fma_f32 v174, v246, v174, v246
    v_mfma_f32_16x16x32_bf16 v[216:219], a[132:135], a[136:139], v[216:219]
    v_rcp_f32 v172, v172
    v_mfma_f32_16x16x32_bf16 v[220:223], a[132:135], a[144:147], v[220:223]
    s_mov_b32 s49, 118784
    buffer_load_dwordx4 a[48:51], v248, s[4:7], s49 offen offset:0 sc1
    v_fma_f32 v175, v247, v175, v247
    v_mfma_f32_16x16x32_bf16 v[220:223], a[252:255], a[148:151], v[220:223]
    v_rcp_f32 v173, v173
    v_mfma_f32_16x16x32_bf16 v[188:191], a[248:251], a[148:151], v[188:191]
    v_fma_f32 v164, -v164, v172, v172
    v_rcp_f32 v174, v174
    v_mfma_f32_16x16x32_bf16 v[188:191], a[128:131], a[144:147], v[188:191]
    s_waitcnt vmcnt(25)
    buffer_load_dwordx4 a[52:55], v248, s[4:7], s49 offen offset:1024 sc1
    v_fma_f32 v165, -v165, v173, v173
    v_mfma_f32_16x16x32_bf16 v[192:195], a[128:131], a[152:155], v[192:195]
    v_rcp_f32 v175, v175
    v_mfma_f32_16x16x32_bf16 v[192:195], a[248:251], a[156:159], v[192:195]
    v_fma_f32 v166, -v166, v174, v174
    v_fma_f32 v167, -v167, v175, v175
    v_mfma_f32_16x16x32_bf16 v[224:227], a[252:255], a[156:159], v[224:227]
    buffer_load_dwordx4 a[56:59], v248, s[4:7], s49 offen offset:2048 sc1
    v_cvt_pk_bf16_f32 v14, v164, v165
    v_cvt_pk_bf16_f32 v15, v166, v167
    v_mfma_f32_16x16x32_bf16 v[224:227], a[132:135], a[152:155], v[224:227]
    ds_write_b128 v250, v[12:15] offset:24576
    v_mfma_f32_16x16x32_bf16 v[228:231], a[132:135], a[160:163], v[228:231]
    v_min_f32 v80, s35, v80
    v_min_f32 v81, s35, v81
    v_mfma_f32_16x16x32_bf16 v[228:231], a[252:255], a[164:167], v[228:231]
    v_min_f32 v82, s35, v82
    v_min_f32 v83, s35, v83
    v_mfma_f32_16x16x32_bf16 v[196:199], a[248:251], a[164:167], v[196:199]
    buffer_load_dwordx4 a[60:63], v248, s[4:7], s49 offen offset:3072 sc1
    v_min_f32 v84, s35, v84
    v_mfma_f32_16x16x32_bf16 v[196:199], a[128:131], a[160:163], v[196:199]
    v_exp_f32 v80, v80
    s_waitcnt lgkmcnt(0)
    s_barrier
    s_waitcnt vmcnt(24)
    v_mfma_f32_16x16x32_bf16 v[200:203], a[128:131], a[168:171], v[200:203]
    ds_read_b128 a[64:67], v251 offset:24576
    v_exp_f32 v88, v88
    v_mfma_f32_16x16x32_bf16 v[200:203], a[248:251], a[172:175], v[200:203]
    ds_read_b128 a[72:75], v251 offset:26624
    v_exp_f32 v81, v81
    v_mfma_f32_16x16x32_bf16 v[232:235], a[252:255], a[172:175], v[232:235]
    s_mov_b32 s49, 122880
    buffer_load_dwordx4 v[16:19], v248, s[4:7], s49 offen offset:0 sc1
    ds_read_b128 a[76:79], v251 offset:26880
    v_add_f32 v240, 1.0, v80
    v_mfma_f32_16x16x32_bf16 v[232:235], a[132:135], a[168:171], v[232:235]
    ds_read_b128 a[68:71], v251 offset:24832
    v_add_f32 v241, 1.0, v81
    v_exp_f32 v89, v89
    v_mfma_f32_16x16x32_bf16 v[236:239], a[132:135], a[176:179], v[236:239]
    v_fma_f32 v88, v240, v88, v240
    v_exp_f32 v82, v82
    v_mfma_f32_16x16x32_bf16 v[236:239], a[252:255], a[180:183], v[236:239]
    v_add_f32 v242, 1.0, v82
    v_exp_f32 v90, v90
    v_mfma_f32_16x16x32_bf16 v[204:207], a[248:251], a[180:183], v[204:207]
    buffer_load_dwordx4 v[20:23], v248, s[4:7], s49 offen offset:1024 sc1
    v_exp_f32 v83, v83
    v_mfma_f32_16x16x32_bf16 v[204:207], a[128:131], a[176:179], v[204:207]
    s_waitcnt vmcnt(22) lgkmcnt(0)
    v_exp_f32 v91, v91
    v_add_f32 v243, 1.0, v83
    v_fma_f32 v89, v241, v89, v241
    v_mfma_f32_16x16x32_bf16 v[176:179], a[64:67], a[96:99], v[176:179]
    v_fma_f32 v90, v242, v90, v242
    v_fma_f32 v91, v243, v91, v243
    v_min_f32 v85, s35, v85
    v_mfma_f32_16x16x32_bf16 v[176:179], a[72:75], a[100:103], v[176:179]
    v_min_f32 v86, s35, v86
    v_rcp_f32 v88, v88
    v_mfma_f32_16x16x32_bf16 v[208:211], a[76:79], a[100:103], v[208:211]
    buffer_load_dwordx4 v[24:27], v248, s[4:7], s49 offen offset:2048 sc1
    v_rcp_f32 v89, v89
    v_mfma_f32_16x16x32_bf16 v[208:211], a[68:71], a[96:99], v[208:211]
    v_rcp_f32 v90, v90
    v_rcp_f32 v91, v91
    v_mfma_f32_16x16x32_bf16 v[212:215], a[68:71], a[104:107], v[212:215]
    v_fma_f32 v80, -v80, v88, v88
    v_fma_f32 v81, -v81, v89, v89
    v_fma_f32 v82, -v82, v90, v90
    v_mfma_f32_16x16x32_bf16 v[212:215], a[76:79], a[108:111], v[212:215]
    v_fma_f32 v83, -v83, v91, v91
    v_cvt_pk_bf16_f32 v12, v80, v81
    v_cvt_pk_bf16_f32 v13, v82, v83
    v_mfma_f32_16x16x32_bf16 v[180:183], a[72:75], a[108:111], v[180:183]
    buffer_load_dwordx4 v[28:31], v248, s[4:7], s49 offen offset:3072 sc1
    v_min_f32 v87, s35, v87
    v_exp_f32 v84, v84
    v_mfma_f32_16x16x32_bf16 v[180:183], a[64:67], a[104:107], v[180:183]
    s_waitcnt vmcnt(20)
    v_add_f32 v244, 1.0, v84
    v_exp_f32 v92, v92
    v_mfma_f32_16x16x32_bf16 v[184:187], a[64:67], a[112:115], v[184:187]
    v_fma_f32 v92, v244, v92, v244
    v_exp_f32 v85, v85
    v_mfma_f32_16x16x32_bf16 v[184:187], a[72:75], a[116:119], v[184:187]
    v_add_f32 v245, 1.0, v85
    v_exp_f32 v93, v93
    v_mfma_f32_16x16x32_bf16 v[216:219], a[76:79], a[116:119], v[216:219]
    s_mov_b32 s49, 126976
    buffer_load_dwordx4 v[96:99], v248, s[4:7], s49 offen offset:0 sc1
    v_fma_f32 v93, v245, v93, v245
    v_exp_f32 v86, v86
    v_mfma_f32_16x16x32_bf16 v[216:219], a[68:71], a[112:115], v[216:219]
    v_add_f32 v246, 1.0, v86
    v_exp_f32 v94, v94
    v_mfma_f32_16x16x32_bf16 v[220:223], a[68:71], a[120:123], v[220:223]
    v_fma_f32 v94, v246, v94, v246
    v_exp_f32 v87, v87
    v_mfma_f32_16x16x32_bf16 v[220:223], a[76:79], a[124:127], v[220:223]
    v_add_f32 v247, 1.0, v87
    v_exp_f32 v95, v95
    v_mfma_f32_16x16x32_bf16 v[188:191], a[72:75], a[124:127], v[188:191]
    buffer_load_dwordx4 v[100:103], v248, s[4:7], s49 offen offset:1024 sc1
    v_fma_f32 v95, v247, v95, v247
    v_rcp_f32 v92, v92
    v_mfma_f32_16x16x32_bf16 v[188:191], a[64:67], a[120:123], v[188:191]
    s_waitcnt vmcnt(18)
    v_fma_f32 v84, -v84, v92, v92
    v_rcp_f32 v93, v93
    v_mfma_f32_16x16x32_bf16 v[192:195], a[64:67], a[0:3], v[192:195]
    v_fma_f32 v85, -v85, v93, v93
    v_rcp_f32 v94, v94
    v_mfma_f32_16x16x32_bf16 v[192:195], a[72:75], a[4:7], v[192:195]
    v_fma_f32 v86, -v86, v94, v94
    v_rcp_f32 v95, v95
    v_mfma_f32_16x16x32_bf16 v[224:227], a[76:79], a[4:7], v[224:227]
    buffer_load_dwordx4 v[104:107], v248, s[4:7], s49 offen offset:2048 sc1
    v_fma_f32 v87, -v87, v95, v95
    v_cvt_pk_bf16_f32 v14, v84, v85
    v_cvt_pk_bf16_f32 v15, v86, v87
    v_mfma_f32_16x16x32_bf16 v[224:227], a[68:71], a[0:3], v[224:227]
    ds_write_b128 v250, v[12:15] offset:28672
    v_mfma_f32_16x16x32_bf16 v[228:231], a[68:71], a[8:11], v[228:231]
    v_mfma_f32_16x16x32_bf16 v[228:231], a[76:79], a[12:15], v[228:231]
    v_mfma_f32_16x16x32_bf16 v[196:199], a[72:75], a[12:15], v[196:199]
    buffer_load_dwordx4 v[108:111], v248, s[4:7], s49 offen offset:3072 sc1
    v_mfma_f32_16x16x32_bf16 v[196:199], a[64:67], a[8:11], v[196:199]
    s_waitcnt lgkmcnt(0)
    s_barrier
    s_waitcnt vmcnt(16)
    v_mfma_f32_16x16x32_bf16 v[200:203], a[64:67], a[16:19], v[200:203]
    ds_read_b128 a[80:83], v251 offset:28672
    v_mfma_f32_16x16x32_bf16 v[200:203], a[72:75], a[20:23], v[200:203]
    ds_read_b128 a[88:91], v251 offset:30720
    v_mfma_f32_16x16x32_bf16 v[232:235], a[76:79], a[20:23], v[232:235]
    ds_read_b128 a[92:95], v251 offset:30976
    v_mfma_f32_16x16x32_bf16 v[232:235], a[68:71], a[16:19], v[232:235]
    ds_read_b128 a[84:87], v251 offset:28928
    v_mfma_f32_16x16x32_bf16 v[236:239], a[68:71], a[24:27], v[236:239]
    v_mfma_f32_16x16x32_bf16 v[236:239], a[76:79], a[28:31], v[236:239]
    v_mfma_f32_16x16x32_bf16 v[204:207], a[72:75], a[28:31], v[204:207]
    v_mfma_f32_16x16x32_bf16 v[204:207], a[64:67], a[24:27], v[204:207]
    s_waitcnt vmcnt(12) lgkmcnt(0)
    v_mfma_f32_16x16x32_bf16 v[176:179], a[80:83], a[32:35], v[176:179]
    v_mfma_f32_16x16x32_bf16 v[176:179], a[88:91], a[36:39], v[176:179]
    v_mfma_f32_16x16x32_bf16 v[208:211], a[92:95], a[36:39], v[208:211]
    v_mfma_f32_16x16x32_bf16 v[208:211], a[84:87], a[32:35], v[208:211]
    v_mfma_f32_16x16x32_bf16 v[212:215], a[84:87], a[40:43], v[212:215]
    v_mfma_f32_16x16x32_bf16 v[212:215], a[92:95], a[44:47], v[212:215]
    v_mfma_f32_16x16x32_bf16 v[180:183], a[88:91], a[44:47], v[180:183]
    v_mfma_f32_16x16x32_bf16 v[180:183], a[80:83], a[40:43], v[180:183]
    s_waitcnt vmcnt(8)
    v_mfma_f32_16x16x32_bf16 v[184:187], a[80:83], a[48:51], v[184:187]
    v_mfma_f32_16x16x32_bf16 v[184:187], a[88:91], a[52:55], v[184:187]
    v_mfma_f32_16x16x32_bf16 v[216:219], a[92:95], a[52:55], v[216:219]
    v_mfma_f32_16x16x32_bf16 v[216:219], a[84:87], a[48:51], v[216:219]
    s_nop 0
    v_cvt_pk_bf16_f32 v64, v208, v212
    v_cvt_pk_bf16_f32 v68, v209, v213
    v_mfma_f32_16x16x32_bf16 v[220:223], a[84:87], a[56:59], v[220:223]
    v_cvt_pk_bf16_f32 v72, v210, v214
    v_cvt_pk_bf16_f32 v76, v211, v215
    v_mfma_f32_16x16x32_bf16 v[220:223], a[92:95], a[60:63], v[220:223]
    v_cvt_pk_bf16_f32 v48, v176, v180
    v_cvt_pk_bf16_f32 v52, v177, v181
    v_mfma_f32_16x16x32_bf16 v[188:191], a[88:91], a[60:63], v[188:191]
    v_cvt_pk_bf16_f32 v56, v178, v182
    v_cvt_pk_bf16_f32 v60, v179, v183
    v_mfma_f32_16x16x32_bf16 v[188:191], a[80:83], a[56:59], v[188:191]
    s_waitcnt vmcnt(4)
    v_mfma_f32_16x16x32_bf16 v[192:195], a[80:83], v[16:19], v[192:195]
    v_mfma_f32_16x16x32_bf16 v[192:195], a[88:91], v[20:23], v[192:195]
    v_mfma_f32_16x16x32_bf16 v[224:227], a[92:95], v[20:23], v[224:227]
    v_mfma_f32_16x16x32_bf16 v[224:227], a[84:87], v[16:19], v[224:227]
    v_cvt_pk_bf16_f32 v65, v216, v220
    v_cvt_pk_bf16_f32 v69, v217, v221
    v_mfma_f32_16x16x32_bf16 v[228:231], a[84:87], v[24:27], v[228:231]
    v_cvt_pk_bf16_f32 v73, v218, v222
    v_cvt_pk_bf16_f32 v77, v219, v223
    v_mfma_f32_16x16x32_bf16 v[228:231], a[92:95], v[28:31], v[228:231]
    v_cvt_pk_bf16_f32 v49, v184, v188
    v_cvt_pk_bf16_f32 v53, v185, v189
    v_mfma_f32_16x16x32_bf16 v[196:199], a[88:91], v[28:31], v[196:199]
    v_cvt_pk_bf16_f32 v57, v186, v190
    v_cvt_pk_bf16_f32 v61, v187, v191
    v_mfma_f32_16x16x32_bf16 v[196:199], a[80:83], v[24:27], v[196:199]
    s_waitcnt vmcnt(0)
    v_mfma_f32_16x16x32_bf16 v[200:203], a[80:83], v[96:99], v[200:203]
    v_mfma_f32_16x16x32_bf16 v[200:203], a[88:91], v[100:103], v[200:203]
    v_mfma_f32_16x16x32_bf16 v[232:235], a[92:95], v[100:103], v[232:235]
    v_mfma_f32_16x16x32_bf16 v[232:235], a[84:87], v[96:99], v[232:235]
    v_cvt_pk_bf16_f32 v66, v224, v228
    v_cvt_pk_bf16_f32 v70, v225, v229
    v_mfma_f32_16x16x32_bf16 v[236:239], a[84:87], v[104:107], v[236:239]
    v_cvt_pk_bf16_f32 v74, v226, v230
    v_cvt_pk_bf16_f32 v78, v227, v231
    v_mfma_f32_16x16x32_bf16 v[236:239], a[92:95], v[108:111], v[236:239]
    v_cvt_pk_bf16_f32 v50, v192, v196
    v_cvt_pk_bf16_f32 v54, v193, v197
    v_mfma_f32_16x16x32_bf16 v[204:207], a[88:91], v[108:111], v[204:207]
    v_cvt_pk_bf16_f32 v58, v194, v198
    v_cvt_pk_bf16_f32 v62, v195, v199
    v_mfma_f32_16x16x32_bf16 v[204:207], a[80:83], v[104:107], v[204:207]
    s_nop 1
    v_cvt_pk_bf16_f32 v67, v232, v236
    v_cvt_pk_bf16_f32 v71, v233, v237
    s_add_u32 s34, s54, 32768
    buffer_store_dwordx4 v[64:67], v252, s[8:11], s34 offen offset:0 sc1 nt
    v_cvt_pk_bf16_f32 v75, v234, v238
    buffer_store_dwordx4 v[68:71], v252, s[8:11], s34 offen offset:2048 sc1 nt
    v_cvt_pk_bf16_f32 v79, v235, v239
    s_add_u32 s34, s54, 36864
    buffer_store_dwordx4 v[72:75], v252, s[8:11], s34 offen offset:0 sc1 nt
    v_cvt_pk_bf16_f32 v51, v200, v204
    buffer_store_dwordx4 v[76:79], v252, s[8:11], s34 offen offset:2048 sc1 nt
    v_cvt_pk_bf16_f32 v55, v201, v205
    s_add_u32 s34, s54, 0
    buffer_store_dwordx4 v[48:51], v252, s[8:11], s34 offen offset:0 sc1 nt
    v_cvt_pk_bf16_f32 v59, v202, v206
    buffer_store_dwordx4 v[52:55], v252, s[8:11], s34 offen offset:2048 sc1 nt
    v_cvt_pk_bf16_f32 v63, v203, v207
    s_add_u32 s34, s54, 4096
    buffer_store_dwordx4 v[56:59], v252, s[8:11], s34 offen offset:0 sc1 nt
    buffer_store_dwordx4 v[60:63], v252, s[8:11], s34 offen offset:2048 sc1 nt
L_fin:
L_end:
    s_endpgm
.section .rodata,"a"
.p2align 6
.amdhsa_kernel standalone__autoregressive_conv_wavenet__speech_kernel
  .amdhsa_next_free_vgpr 512
  .amdhsa_next_free_sgpr 102
  .amdhsa_accum_offset 256
  .amdhsa_group_segment_fixed_size 0
  .amdhsa_kernarg_size 48
  .amdhsa_user_sgpr_count 2
  .amdhsa_user_sgpr_kernarg_segment_ptr 1
  .amdhsa_system_sgpr_workgroup_id_x 1
.end_amdhsa_kernel
.text
```
